```python
import torch

def _softmax(x, axis=-1):
    return torch.softmax(x, dim=axis)
def _gelu(x):
    return torch.nn.functional.gelu(x, approximate="tanh")
def _silu(x):
    return torch.nn.functional.silu(x)
def _sigmoid(x):
    return torch.sigmoid(x)
def _layernorm(x, axis=-1, eps=1e-5):
    m = x.mean(dim=axis, keepdim=True)
    v = x.var(dim=axis, keepdim=True, unbiased=False)
    return (x - m) / torch.sqrt(v + eps)
def _scatter_add(tgt, idx, src, axis=0):
    return tgt.clone().index_add_(axis, idx, src)
def _segment_sum(src, seg, n):
    out = torch.zeros((n,) + src.shape[1:], dtype=src.dtype)
    return out.index_add_(0, seg, src)
def _pad(x, pw):
    flat = tuple(v for pair in reversed(pw) for v in pair)
    return torch.nn.functional.pad(x, flat)

kernel_name = 'standalone__gqa_block_cached__near_ridge'

def setup_inputs():

    _w = (lambda a: (lambda t: t.to(torch.bfloat16) if t.is_floating_point() else t)(torch.as_tensor(a)))
    B, Sq, D = 8, 96, 512
    Hq, Hkv, Sk, Dh = 32, 32, 1024, 128
    assert Hq % Hkv == 0, (Hq, Hkv)
    return {
        "x": _w((lambda *s: torch.randn(*s, dtype=torch.bfloat16) * 0.8)(B, Sq, D)),
        "k_cache": _w((lambda *s: torch.randn(*s, dtype=torch.bfloat16) * 0.8)(B, Hkv, Sk, Dh)),
        "v_cache": _w((lambda *s: torch.randn(*s, dtype=torch.bfloat16) * 0.05)(B, Hkv, Sk, Dh)),
        "wq": _w((lambda *s: torch.randn(*s, dtype=torch.bfloat16) * 0.8)(D, Hq * Dh) * (D ** -0.5)),
        "wo": _w((lambda *s: torch.randn(*s, dtype=torch.bfloat16) * 0.05)(Hq * Dh, D) * ((Hq * Dh) ** -0.5)),
    }

def reference(x, k_cache, v_cache, wq, wo):
    B, Sq, D = x.shape
    Hq, Dh = 32, 128
    Hkv = k_cache.shape[1]
    rep = Hq // Hkv
    q = (lambda x, *d: x.permute(*d))((x @ wq).reshape(B, Sq, Hq, Dh), 0, 2, 1, 3)
    k = (lambda x, n, axis: torch.repeat_interleave(x, n, dim=axis))(k_cache, rep, axis=1)
    v = (lambda x, n, axis: torch.repeat_interleave(x, n, dim=axis))(v_cache, rep, axis=1)
    scores = torch.einsum("bhqd,bhkd->bhqk", q, k) * (Dh ** -0.5)
    p = _softmax(scores, axis=-1)
    o = torch.einsum("bhqk,bhkd->bhqd", p, v)
    return (lambda x, *d: x.permute(*d))(o, 0, 2, 1, 3).reshape(B, Sq, Hq * Dh) @ wo
```

```asm
; @launch grid=(256,1,1) block=(256,1,1) lds=163840
.amdgcn_target "amdgcn-amd-amdhsa--gfx950"
.text
.globl standalone__gqa_block_cached__near_ridge_kernel
.type standalone__gqa_block_cached__near_ridge_kernel,@function
.p2align 8
standalone__gqa_block_cached__near_ridge_kernel:
    s_cmp_ge_u32 s2, 256
    s_cbranch_scc1 K1_END
    s_load_dwordx16 s[4:19], s[0:1], 0
    v_lshrrev_b32 v1, 6, v0
    v_and_b32 v0, 63, v0
    s_nop 0
    v_readfirstlane_b32 s44, v1
    s_and_b32 s80, s2, 7
    s_lshr_b32 s49, s2, 3
    s_and_b32 s81, s49, 3
    s_lshl_b32 s46, s80, 2
    s_add_u32 s46, s46, s81
    s_lshr_b32 s45, s49, 2
    s_add_u32 s62, s45, s46
    s_and_b32 s62, s62, 1
    s_lshl_b32 s85, s2, 7
    s_add_u32 s85, s85, 7340032
    v_lshrrev_b32 v1, 4, v0
    v_and_b32 v2, 15, v0
    v_mov_b32 v18, 155648
    s_cmp_eq_u32 s44, 0
    s_cbranch_scc1 K1_LOADER
    s_sub_u32 s44, s44, 1
    v_xor_b32 v3, v2, v1
    v_xor_b32 v64, 0, v3
    v_lshlrev_b32 v64, 4, v64
    v_lshl_add_u32 v64, v1, 10, v64
    v_xor_b32 v65, 4, v3
    v_lshlrev_b32 v65, 4, v65
    v_lshl_add_u32 v65, v1, 10, v65
    v_xor_b32 v66, 8, v3
    v_lshlrev_b32 v66, 4, v66
    v_lshl_add_u32 v66, v1, 10, v66
    v_xor_b32 v67, 12, v3
    v_lshlrev_b32 v67, 4, v67
    v_lshl_add_u32 v67, v1, 10, v67
    s_mul_i32 s54, s45, 96
    s_lshl_b32 s48, s44, 5
    s_add_u32 s54, s54, s48
    s_lshl_b32 s54, s54, 10
    s_lshl_b32 s56, s44, 13
    s_waitcnt lgkmcnt(0)
    s_barrier
    s_mov_b32 s20, s4
    s_and_b32 s21, s5, 0xffff
    s_mov_b32 s22, 0xc0000
    s_mov_b32 s23, 0x20000
    s_mov_b32 s40, s18
    s_and_b32 s41, s19, 0xffff
    s_mov_b32 s42, 0x10000000
    s_mov_b32 s43, 0x20000
    s_mov_b32 s24, s16
    s_and_b32 s25, s17, 0xffff
    s_mov_b32 s26, 0x100
    s_mov_b32 s27, 0x20000
    s_mov_b32 s28, s14
    s_and_b32 s29, s15, 0xffff
    s_mov_b32 s30, 0xc0000
    s_mov_b32 s31, 0x20000
    v_and_b32 v70, 31, v0
    v_lshlrev_b32 v70, 2, v70
    v_mov_b32 v71, 0
    s_cmp_eq_u32 s44, 0
    s_cbranch_scc0 K1_NOCLR
    buffer_store_dword v71, v70, s[40:43], s85 offen sc1
K1_NOCLR:
    s_cmp_eq_u32 s62, 0
    s_cbranch_scc1 K1_QGO
K1_QW:
    s_sleep 2
    ds_read_b32 v58, v18 offset:8
    s_waitcnt lgkmcnt(0)
    v_readfirstlane_b32 s51, v58
    s_cmp_eq_u32 s51, 0
    s_cbranch_scc1 K1_QW
K1_QGO:
    s_add_u32 s57, s54, 0
    s_add_u32 s60, s56, 40960
    s_mov_b32 m0, s60
    s_nop 0
    buffer_load_dwordx4 v64, s[20:23], s57 offen lds
    s_add_u32 s57, s54, 4096
    s_add_u32 s60, s56, 41984
    s_mov_b32 m0, s60
    s_nop 0
    buffer_load_dwordx4 v65, s[20:23], s57 offen lds
    s_add_u32 s57, s54, 8192
    s_add_u32 s60, s56, 43008
    s_mov_b32 m0, s60
    s_nop 0
    buffer_load_dwordx4 v66, s[20:23], s57 offen lds
    s_add_u32 s57, s54, 12288
    s_add_u32 s60, s56, 44032
    s_mov_b32 m0, s60
    s_nop 0
    buffer_load_dwordx4 v67, s[20:23], s57 offen lds
    s_add_u32 s57, s54, 16384
    s_add_u32 s60, s56, 45056
    s_mov_b32 m0, s60
    s_nop 0
    buffer_load_dwordx4 v64, s[20:23], s57 offen lds
    s_add_u32 s57, s54, 20480
    s_add_u32 s60, s56, 46080
    s_mov_b32 m0, s60
    s_nop 0
    buffer_load_dwordx4 v65, s[20:23], s57 offen lds
    s_add_u32 s57, s54, 24576
    s_add_u32 s60, s56, 47104
    s_mov_b32 m0, s60
    s_nop 0
    buffer_load_dwordx4 v66, s[20:23], s57 offen lds
    s_add_u32 s57, s54, 28672
    s_add_u32 s60, s56, 48128
    s_mov_b32 m0, s60
    s_nop 0
    buffer_load_dwordx4 v67, s[20:23], s57 offen lds
    s_add_u32 s57, s54, 256
    s_add_u32 s60, s56, 106496
    s_mov_b32 m0, s60
    s_nop 0
    buffer_load_dwordx4 v64, s[20:23], s57 offen lds
    s_add_u32 s57, s54, 4352
    s_add_u32 s60, s56, 107520
    s_mov_b32 m0, s60
    s_nop 0
    buffer_load_dwordx4 v65, s[20:23], s57 offen lds
    s_add_u32 s57, s54, 8448
    s_add_u32 s60, s56, 108544
    s_mov_b32 m0, s60
    s_nop 0
    buffer_load_dwordx4 v66, s[20:23], s57 offen lds
    s_add_u32 s57, s54, 12544
    s_add_u32 s60, s56, 109568
    s_mov_b32 m0, s60
    s_nop 0
    buffer_load_dwordx4 v67, s[20:23], s57 offen lds
    s_add_u32 s57, s54, 16640
    s_add_u32 s60, s56, 110592
    s_mov_b32 m0, s60
    s_nop 0
    buffer_load_dwordx4 v64, s[20:23], s57 offen lds
    s_add_u32 s57, s54, 20736
    s_add_u32 s60, s56, 111616
    s_mov_b32 m0, s60
    s_nop 0
    buffer_load_dwordx4 v65, s[20:23], s57 offen lds
    s_add_u32 s57, s54, 24832
    s_add_u32 s60, s56, 112640
    s_mov_b32 m0, s60
    s_nop 0
    buffer_load_dwordx4 v66, s[20:23], s57 offen lds
    s_add_u32 s57, s54, 28928
    s_add_u32 s60, s56, 113664
    s_mov_b32 m0, s60
    s_nop 0
    buffer_load_dwordx4 v67, s[20:23], s57 offen lds
    s_mov_b32 s52, 0x3e0293ee
    s_mov_b32 s53, 0x44800000
    v_and_b32 v3, 31, v0
    v_lshrrev_b32 v19, 5, v0
    v_and_b32 v60, 15, v3
    v_xor_b32 v60, v60, v19
    v_lshlrev_b32 v60, 4, v60
    v_lshl_add_u32 v20, v3, 8, v60
    v_xor_b32 v21, 32, v20
    v_xor_b32 v22, 64, v20
    v_xor_b32 v23, 96, v20
    v_xor_b32 v24, 128, v20
    v_xor_b32 v25, 160, v20
    v_xor_b32 v26, 192, v20
    v_xor_b32 v27, 224, v20
    s_add_u32 s49, s56, 106496
    s_add_u32 s48, s56, 40960
    v_add_u32 v32, s48, v20
    v_add_u32 v40, s49, v20
    v_add_u32 v33, s48, v21
    v_add_u32 v41, s49, v21
    v_add_u32 v34, s48, v22
    v_add_u32 v42, s49, v22
    v_add_u32 v35, s48, v23
    v_add_u32 v43, s49, v23
    v_add_u32 v36, s48, v24
    v_add_u32 v44, s49, v24
    v_add_u32 v37, s48, v25
    v_add_u32 v45, s49, v25
    v_add_u32 v38, s48, v26
    v_add_u32 v46, s49, v26
    v_add_u32 v39, s48, v27
    v_add_u32 v47, s49, v27
    v_lshrrev_b32 v60, 2, v2
    v_and_b32 v61, 1, v1
    v_lshlrev_b32 v61, 5, v61
    v_and_b32 v62, 3, v2
    v_lshlrev_b32 v62, 3, v62
    v_add_u32 v61, v61, v62
    v_xor_b32 v62, 0, v60
    v_lshl_add_u32 v62, v62, 6, v61
    v_lshl_add_u32 v63, v19, 2, v60
    v_lshl_add_u32 v28, v63, 8, v62
    v_add_u32 v28, 65536, v28
    v_lshl_add_u32 v63, v19, 3, v60
    v_lshl_add_u32 v4, v63, 8, v62
    v_add_u32 v8, 65536, v4
    v_add_u32 v12, 131072, v4
    v_xor_b32 v62, 1, v60
    v_lshl_add_u32 v62, v62, 6, v61
    v_lshl_add_u32 v63, v19, 2, v60
    v_lshl_add_u32 v29, v63, 8, v62
    v_add_u32 v29, 65536, v29
    v_lshl_add_u32 v63, v19, 3, v60
    v_lshl_add_u32 v5, v63, 8, v62
    v_add_u32 v9, 65536, v5
    v_add_u32 v13, 131072, v5
    v_xor_b32 v62, 2, v60
    v_lshl_add_u32 v62, v62, 6, v61
    v_lshl_add_u32 v63, v19, 2, v60
    v_lshl_add_u32 v30, v63, 8, v62
    v_add_u32 v30, 65536, v30
    v_lshl_add_u32 v63, v19, 3, v60
    v_lshl_add_u32 v6, v63, 8, v62
    v_add_u32 v10, 65536, v6
    v_add_u32 v14, 131072, v6
    v_xor_b32 v62, 3, v60
    v_lshl_add_u32 v62, v62, 6, v61
    v_lshl_add_u32 v63, v19, 2, v60
    v_lshl_add_u32 v31, v63, 8, v62
    v_add_u32 v31, 65536, v31
    v_lshl_add_u32 v63, v19, 3, v60
    v_lshl_add_u32 v7, v63, 8, v62
    v_add_u32 v11, 65536, v7
    v_add_u32 v15, 131072, v7
    v_lshlrev_b32 v54, 4, v0
    s_lshl_b32 s48, s44, 2
    s_add_u32 s48, s48, 155664
    v_mov_b32 v56, s48
    s_mov_b32 s59, 0
    s_waitcnt vmcnt(8)
    ds_read_b128 a[32:35], v32
    ds_read_b128 a[36:39], v33
    ds_read_b128 a[40:43], v34
    ds_read_b128 a[44:47], v35
    ds_read_b128 a[48:51], v36
    ds_read_b128 a[52:55], v37
    ds_read_b128 a[56:59], v38
    ds_read_b128 a[60:63], v39
    s_waitcnt vmcnt(0)
    ds_read_b128 a[64:67], v40
    ds_read_b128 a[68:71], v41
    ds_read_b128 a[72:75], v42
    ds_read_b128 a[76:79], v43
    ds_read_b128 a[80:83], v44
    ds_read_b128 a[84:87], v45
    ds_read_b128 a[88:91], v46
    ds_read_b128 a[92:95], v47
    s_waitcnt lgkmcnt(0)
    s_add_u32 s57, s54, 512
    s_add_u32 s60, s56, 40960
    s_mov_b32 m0, s60
    s_nop 0
    buffer_load_dwordx4 v64, s[20:23], s57 offen lds
    s_add_u32 s57, s54, 4608
    s_add_u32 s60, s56, 41984
    s_mov_b32 m0, s60
    s_nop 0
    buffer_load_dwordx4 v65, s[20:23], s57 offen lds
    s_add_u32 s57, s54, 8704
    s_add_u32 s60, s56, 43008
    s_mov_b32 m0, s60
    s_nop 0
    buffer_load_dwordx4 v66, s[20:23], s57 offen lds
    s_add_u32 s57, s54, 12800
    s_add_u32 s60, s56, 44032
    s_mov_b32 m0, s60
    s_nop 0
    buffer_load_dwordx4 v67, s[20:23], s57 offen lds
    s_add_u32 s57, s54, 16896
    s_add_u32 s60, s56, 45056
    s_mov_b32 m0, s60
    s_nop 0
    buffer_load_dwordx4 v64, s[20:23], s57 offen lds
    s_add_u32 s57, s54, 20992
    s_add_u32 s60, s56, 46080
    s_mov_b32 m0, s60
    s_nop 0
    buffer_load_dwordx4 v65, s[20:23], s57 offen lds
    s_add_u32 s57, s54, 25088
    s_add_u32 s60, s56, 47104
    s_mov_b32 m0, s60
    s_nop 0
    buffer_load_dwordx4 v66, s[20:23], s57 offen lds
    s_add_u32 s57, s54, 29184
    s_add_u32 s60, s56, 48128
    s_mov_b32 m0, s60
    s_nop 0
    buffer_load_dwordx4 v67, s[20:23], s57 offen lds
    s_add_u32 s57, s54, 768
    s_add_u32 s60, s56, 106496
    s_mov_b32 m0, s60
    s_nop 0
    buffer_load_dwordx4 v64, s[20:23], s57 offen lds
    s_add_u32 s57, s54, 4864
    s_add_u32 s60, s56, 107520
    s_mov_b32 m0, s60
    s_nop 0
    buffer_load_dwordx4 v65, s[20:23], s57 offen lds
    s_add_u32 s57, s54, 8960
    s_add_u32 s60, s56, 108544
    s_mov_b32 m0, s60
    s_nop 0
    buffer_load_dwordx4 v66, s[20:23], s57 offen lds
    s_add_u32 s57, s54, 13056
    s_add_u32 s60, s56, 109568
    s_mov_b32 m0, s60
    s_nop 0
    buffer_load_dwordx4 v67, s[20:23], s57 offen lds
    s_add_u32 s57, s54, 17152
    s_add_u32 s60, s56, 110592
    s_mov_b32 m0, s60
    s_nop 0
    buffer_load_dwordx4 v64, s[20:23], s57 offen lds
    s_add_u32 s57, s54, 21248
    s_add_u32 s60, s56, 111616
    s_mov_b32 m0, s60
    s_nop 0
    buffer_load_dwordx4 v65, s[20:23], s57 offen lds
    s_add_u32 s57, s54, 25344
    s_add_u32 s60, s56, 112640
    s_mov_b32 m0, s60
    s_nop 0
    buffer_load_dwordx4 v66, s[20:23], s57 offen lds
    s_add_u32 s57, s54, 29440
    s_add_u32 s60, s56, 113664
    s_mov_b32 m0, s60
    s_nop 0
    buffer_load_dwordx4 v67, s[20:23], s57 offen lds
    s_cmp_ge_u32 s59, 1
    s_cbranch_scc1 K1_L1_OK
K1_L1:
    ds_read_b32 v58, v18 offset:4
    s_waitcnt lgkmcnt(0)
    v_readfirstlane_b32 s59, v58
    s_cmp_ge_u32 s59, 1
    s_cbranch_scc0 K1_L1
K1_L1_OK:
    ds_read_b64_tr_b16 v[160:161], v12 offset:0
    ds_read_b64_tr_b16 v[162:163], v12 offset:1024
    ds_read_b64_tr_b16 v[164:165], v13 offset:0
    ds_read_b64_tr_b16 v[166:167], v13 offset:1024
    ds_read_b64_tr_b16 v[168:169], v14 offset:0
    ds_read_b64_tr_b16 v[170:171], v14 offset:1024
    ds_read_b64_tr_b16 v[172:173], v15 offset:0
    ds_read_b64_tr_b16 v[174:175], v15 offset:1024
    ds_read_b64_tr_b16 v[176:177], v12 offset:4096
    ds_read_b64_tr_b16 v[178:179], v12 offset:5120
    ds_read_b64_tr_b16 v[180:181], v13 offset:4096
    ds_read_b64_tr_b16 v[182:183], v13 offset:5120
    ds_read_b64_tr_b16 v[184:185], v14 offset:4096
    ds_read_b64_tr_b16 v[186:187], v14 offset:5120
    ds_read_b64_tr_b16 v[188:189], v15 offset:4096
    ds_read_b64_tr_b16 v[190:191], v15 offset:5120
    s_waitcnt lgkmcnt(8)
    v_mfma_f32_32x32x16_bf16 v[96:111], v[160:163], a[32:35], 0
    ds_read_b64_tr_b16 v[192:193], v12 offset:8192
    ds_read_b64_tr_b16 v[194:195], v12 offset:9216
    v_mfma_f32_32x32x16_bf16 v[112:127], v[164:167], a[32:35], 0
    ds_read_b64_tr_b16 v[196:197], v13 offset:8192
    ds_read_b64_tr_b16 v[198:199], v13 offset:9216
    v_mfma_f32_32x32x16_bf16 v[128:143], v[168:171], a[32:35], 0
    ds_read_b64_tr_b16 v[200:201], v14 offset:8192
    ds_read_b64_tr_b16 v[202:203], v14 offset:9216
    v_mfma_f32_32x32x16_bf16 v[144:159], v[172:175], a[32:35], 0
    ds_read_b64_tr_b16 v[204:205], v15 offset:8192
    ds_read_b64_tr_b16 v[206:207], v15 offset:9216
    s_waitcnt lgkmcnt(8)
    v_mfma_f32_32x32x16_bf16 v[96:111], v[176:179], a[36:39], v[96:111]
    ds_read_b64_tr_b16 v[160:161], v12 offset:12288
    ds_read_b64_tr_b16 v[162:163], v12 offset:13312
    v_mfma_f32_32x32x16_bf16 v[112:127], v[180:183], a[36:39], v[112:127]
    ds_read_b64_tr_b16 v[164:165], v13 offset:12288
    ds_read_b64_tr_b16 v[166:167], v13 offset:13312
    v_mfma_f32_32x32x16_bf16 v[128:143], v[184:187], a[36:39], v[128:143]
    ds_read_b64_tr_b16 v[168:169], v14 offset:12288
    ds_read_b64_tr_b16 v[170:171], v14 offset:13312
    v_mfma_f32_32x32x16_bf16 v[144:159], v[188:191], a[36:39], v[144:159]
    ds_read_b64_tr_b16 v[172:173], v15 offset:12288
    ds_read_b64_tr_b16 v[174:175], v15 offset:13312
    s_waitcnt lgkmcnt(8)
    v_mfma_f32_32x32x16_bf16 v[96:111], v[192:195], a[40:43], v[96:111]
    s_cmp_ge_u32 s59, 2
    s_cbranch_scc1 K1_L2_OK
K1_L2:
    ds_read_b32 v58, v18 offset:4
    s_waitcnt lgkmcnt(0)
    v_readfirstlane_b32 s59, v58
    s_cmp_ge_u32 s59, 2
    s_cbranch_scc0 K1_L2
K1_L2_OK:
    ds_read_b64_tr_b16 v[176:177], v12 offset:16384
    ds_read_b64_tr_b16 v[178:179], v12 offset:17408
    v_mfma_f32_32x32x16_bf16 v[112:127], v[196:199], a[40:43], v[112:127]
    ds_read_b64_tr_b16 v[180:181], v13 offset:16384
    ds_read_b64_tr_b16 v[182:183], v13 offset:17408
    v_mfma_f32_32x32x16_bf16 v[128:143], v[200:203], a[40:43], v[128:143]
    ds_read_b64_tr_b16 v[184:185], v14 offset:16384
    ds_read_b64_tr_b16 v[186:187], v14 offset:17408
    v_mfma_f32_32x32x16_bf16 v[144:159], v[204:207], a[40:43], v[144:159]
    ds_read_b64_tr_b16 v[188:189], v15 offset:16384
    ds_read_b64_tr_b16 v[190:191], v15 offset:17408
    s_waitcnt lgkmcnt(8)
    v_mov_b32 v55, 1
    ds_write_b32 v56, v55
    v_mfma_f32_32x32x16_bf16 v[96:111], v[160:163], a[44:47], v[96:111]
    ds_read_b64_tr_b16 v[192:193], v12 offset:20480
    ds_read_b64_tr_b16 v[194:195], v12 offset:21504
    v_mfma_f32_32x32x16_bf16 v[112:127], v[164:167], a[44:47], v[112:127]
    ds_read_b64_tr_b16 v[196:197], v13 offset:20480
    ds_read_b64_tr_b16 v[198:199], v13 offset:21504
    v_mfma_f32_32x32x16_bf16 v[128:143], v[168:171], a[44:47], v[128:143]
    ds_read_b64_tr_b16 v[200:201], v14 offset:20480
    ds_read_b64_tr_b16 v[202:203], v14 offset:21504
    v_mfma_f32_32x32x16_bf16 v[144:159], v[172:175], a[44:47], v[144:159]
    ds_read_b64_tr_b16 v[204:205], v15 offset:20480
    ds_read_b64_tr_b16 v[206:207], v15 offset:21504
    s_waitcnt lgkmcnt(9)
    v_mfma_f32_32x32x16_bf16 v[96:111], v[176:179], a[48:51], v[96:111]
    ds_read_b64_tr_b16 v[160:161], v8 offset:0
    ds_read_b64_tr_b16 v[162:163], v8 offset:1024
    v_mfma_f32_32x32x16_bf16 v[112:127], v[180:183], a[48:51], v[112:127]
    ds_read_b64_tr_b16 v[164:165], v9 offset:0
    ds_read_b64_tr_b16 v[166:167], v9 offset:1024
    v_mfma_f32_32x32x16_bf16 v[128:143], v[184:187], a[48:51], v[128:143]
    ds_read_b64_tr_b16 v[168:169], v10 offset:0
    ds_read_b64_tr_b16 v[170:171], v10 offset:1024
    v_mfma_f32_32x32x16_bf16 v[144:159], v[188:191], a[48:51], v[144:159]
    ds_read_b64_tr_b16 v[172:173], v11 offset:0
    ds_read_b64_tr_b16 v[174:175], v11 offset:1024
    s_waitcnt lgkmcnt(8)
    v_mfma_f32_32x32x16_bf16 v[96:111], v[192:195], a[52:55], v[96:111]
    ds_read_b64_tr_b16 v[176:177], v8 offset:4096
    ds_read_b64_tr_b16 v[178:179], v8 offset:5120
    v_mfma_f32_32x32x16_bf16 v[112:127], v[196:199], a[52:55], v[112:127]
    ds_read_b64_tr_b16 v[180:181], v9 offset:4096
    ds_read_b64_tr_b16 v[182:183], v9 offset:5120
    v_mfma_f32_32x32x16_bf16 v[128:143], v[200:203], a[52:55], v[128:143]
    ds_read_b64_tr_b16 v[184:185], v10 offset:4096
    ds_read_b64_tr_b16 v[186:187], v10 offset:5120
    v_mfma_f32_32x32x16_bf16 v[144:159], v[204:207], a[52:55], v[144:159]
    ds_read_b64_tr_b16 v[188:189], v11 offset:4096
    ds_read_b64_tr_b16 v[190:191], v11 offset:5120
    s_waitcnt lgkmcnt(8)
    v_mfma_f32_32x32x16_bf16 v[96:111], v[160:163], a[56:59], v[96:111]
    s_cmp_ge_u32 s59, 3
    s_cbranch_scc1 K1_L3_OK
K1_L3:
    ds_read_b32 v58, v18 offset:4
    s_waitcnt lgkmcnt(0)
    v_readfirstlane_b32 s59, v58
    s_cmp_ge_u32 s59, 3
    s_cbranch_scc0 K1_L3
K1_L3_OK:
    ds_read_b64_tr_b16 v[192:193], v4 offset:8192
    ds_read_b64_tr_b16 v[194:195], v4 offset:9216
    v_mfma_f32_32x32x16_bf16 v[112:127], v[164:167], a[56:59], v[112:127]
    ds_read_b64_tr_b16 v[196:197], v5 offset:8192
    ds_read_b64_tr_b16 v[198:199], v5 offset:9216
    v_mfma_f32_32x32x16_bf16 v[128:143], v[168:171], a[56:59], v[128:143]
    ds_read_b64_tr_b16 v[200:201], v6 offset:8192
    ds_read_b64_tr_b16 v[202:203], v6 offset:9216
    v_mfma_f32_32x32x16_bf16 v[144:159], v[172:175], a[56:59], v[144:159]
    ds_read_b64_tr_b16 v[204:205], v7 offset:8192
    ds_read_b64_tr_b16 v[206:207], v7 offset:9216
    s_waitcnt lgkmcnt(8)
    v_mov_b32 v55, 2
    ds_write_b32 v56, v55
    v_mfma_f32_32x32x16_bf16 v[96:111], v[176:179], a[60:63], v[96:111]
    ds_read_b64_tr_b16 v[160:161], v4 offset:12288
    ds_read_b64_tr_b16 v[162:163], v4 offset:13312
    v_mfma_f32_32x32x16_bf16 v[112:127], v[180:183], a[60:63], v[112:127]
    ds_read_b64_tr_b16 v[164:165], v5 offset:12288
    ds_read_b64_tr_b16 v[166:167], v5 offset:13312
    v_mfma_f32_32x32x16_bf16 v[128:143], v[184:187], a[60:63], v[128:143]
    ds_read_b64_tr_b16 v[168:169], v6 offset:12288
    ds_read_b64_tr_b16 v[170:171], v6 offset:13312
    v_mfma_f32_32x32x16_bf16 v[144:159], v[188:191], a[60:63], v[144:159]
    ds_read_b64_tr_b16 v[172:173], v7 offset:12288
    ds_read_b64_tr_b16 v[174:175], v7 offset:13312
    s_waitcnt lgkmcnt(9)
    v_mfma_f32_32x32x16_bf16 v[96:111], v[192:195], a[64:67], v[96:111]
    ds_read_b64_tr_b16 v[176:177], v4 offset:16384
    ds_read_b64_tr_b16 v[178:179], v4 offset:17408
    v_mfma_f32_32x32x16_bf16 v[112:127], v[196:199], a[64:67], v[112:127]
    ds_read_b64_tr_b16 v[180:181], v5 offset:16384
    ds_read_b64_tr_b16 v[182:183], v5 offset:17408
    v_mfma_f32_32x32x16_bf16 v[128:143], v[200:203], a[64:67], v[128:143]
    ds_read_b64_tr_b16 v[184:185], v6 offset:16384
    ds_read_b64_tr_b16 v[186:187], v6 offset:17408
    v_mfma_f32_32x32x16_bf16 v[144:159], v[204:207], a[64:67], v[144:159]
    ds_read_b64_tr_b16 v[188:189], v7 offset:16384
    ds_read_b64_tr_b16 v[190:191], v7 offset:17408
    s_waitcnt lgkmcnt(8)
    s_waitcnt vmcnt(0)
    s_cmp_eq_u32 s44, 0
    s_cbranch_scc0 K1_NORDY
    v_mov_b32 v70, 0
    v_mov_b32 v71, 1
    s_mov_b64 exec, 1
    buffer_store_byte v71, v70, s[24:27], s2 offen sc1
    s_mov_b64 exec, -1
K1_NORDY:
    v_mfma_f32_32x32x16_bf16 v[96:111], v[160:163], a[68:71], v[96:111]
    ds_read_b64_tr_b16 v[192:193], v4 offset:20480
    ds_read_b64_tr_b16 v[194:195], v4 offset:21504
    ds_read_b128 a[96:99], v32
    v_mfma_f32_32x32x16_bf16 v[112:127], v[164:167], a[68:71], v[112:127]
    ds_read_b64_tr_b16 v[196:197], v5 offset:20480
    ds_read_b64_tr_b16 v[198:199], v5 offset:21504
    ds_read_b128 a[100:103], v33
    v_mfma_f32_32x32x16_bf16 v[128:143], v[168:171], a[68:71], v[128:143]
    ds_read_b64_tr_b16 v[200:201], v6 offset:20480
    ds_read_b64_tr_b16 v[202:203], v6 offset:21504
    ds_read_b128 a[104:107], v34
    v_mfma_f32_32x32x16_bf16 v[144:159], v[172:175], a[68:71], v[144:159]
    ds_read_b64_tr_b16 v[204:205], v7 offset:20480
    ds_read_b64_tr_b16 v[206:207], v7 offset:21504
    ds_read_b128 a[108:111], v35
    s_waitcnt lgkmcnt(12)
    v_mfma_f32_32x32x16_bf16 v[96:111], v[176:179], a[72:75], v[96:111]
    s_cmp_ge_u32 s59, 4
    s_cbranch_scc1 K1_L4_OK
K1_L4:
    ds_read_b32 v58, v18 offset:4
    s_waitcnt lgkmcnt(0)
    v_readfirstlane_b32 s59, v58
    s_cmp_ge_u32 s59, 4
    s_cbranch_scc0 K1_L4
K1_L4_OK:
    ds_read_b64_tr_b16 v[160:161], v8 offset:8192
    ds_read_b64_tr_b16 v[162:163], v8 offset:9216
    ds_read_b128 a[112:115], v36
    v_mfma_f32_32x32x16_bf16 v[112:127], v[180:183], a[72:75], v[112:127]
    ds_read_b64_tr_b16 v[164:165], v9 offset:8192
    ds_read_b64_tr_b16 v[166:167], v9 offset:9216
    ds_read_b128 a[116:119], v37
    v_mfma_f32_32x32x16_bf16 v[128:143], v[184:187], a[72:75], v[128:143]
    ds_read_b64_tr_b16 v[168:169], v10 offset:8192
    ds_read_b64_tr_b16 v[170:171], v10 offset:9216
    ds_read_b128 a[120:123], v38
    v_mfma_f32_32x32x16_bf16 v[144:159], v[188:191], a[72:75], v[144:159]
    ds_read_b64_tr_b16 v[172:173], v11 offset:8192
    ds_read_b64_tr_b16 v[174:175], v11 offset:9216
    ds_read_b128 a[124:127], v39
    s_waitcnt lgkmcnt(13)
    v_mov_b32 v55, 3
    ds_write_b32 v56, v55
    v_mfma_f32_32x32x16_bf16 v[96:111], v[192:195], a[76:79], v[96:111]
    ds_read_b64_tr_b16 v[176:177], v8 offset:12288
    ds_read_b64_tr_b16 v[178:179], v8 offset:13312
    ds_read_b128 a[128:131], v40
    v_mfma_f32_32x32x16_bf16 v[112:127], v[196:199], a[76:79], v[112:127]
    ds_read_b64_tr_b16 v[180:181], v9 offset:12288
    ds_read_b64_tr_b16 v[182:183], v9 offset:13312
    ds_read_b128 a[132:135], v41
    v_mfma_f32_32x32x16_bf16 v[128:143], v[200:203], a[76:79], v[128:143]
    ds_read_b64_tr_b16 v[184:185], v10 offset:12288
    ds_read_b64_tr_b16 v[186:187], v10 offset:13312
    ds_read_b128 a[136:139], v42
    v_mfma_f32_32x32x16_bf16 v[144:159], v[204:207], a[76:79], v[144:159]
    ds_read_b64_tr_b16 v[188:189], v11 offset:12288
    ds_read_b64_tr_b16 v[190:191], v11 offset:13312
    ds_read_b128 a[140:143], v43
    s_waitcnt lgkmcnt(14)
    v_mfma_f32_32x32x16_bf16 v[96:111], v[160:163], a[80:83], v[96:111]
    ds_read_b64_tr_b16 v[192:193], v8 offset:16384
    ds_read_b64_tr_b16 v[194:195], v8 offset:17408
    ds_read_b128 a[144:147], v44
    v_mfma_f32_32x32x16_bf16 v[112:127], v[164:167], a[80:83], v[112:127]
    ds_read_b64_tr_b16 v[196:197], v9 offset:16384
    ds_read_b64_tr_b16 v[198:199], v9 offset:17408
    ds_read_b128 a[148:151], v45
    v_mfma_f32_32x32x16_bf16 v[128:143], v[168:171], a[80:83], v[128:143]
    ds_read_b64_tr_b16 v[200:201], v10 offset:16384
    ds_read_b64_tr_b16 v[202:203], v10 offset:17408
    ds_read_b128 a[152:155], v46
    v_mfma_f32_32x32x16_bf16 v[144:159], v[172:175], a[80:83], v[144:159]
    ds_read_b64_tr_b16 v[204:205], v11 offset:16384
    ds_read_b64_tr_b16 v[206:207], v11 offset:17408
    ds_read_b128 a[156:159], v47
    s_waitcnt lgkmcnt(13)
    v_mfma_f32_32x32x16_bf16 v[96:111], v[176:179], a[84:87], v[96:111]
    ds_read_b64_tr_b16 v[160:161], v8 offset:20480
    ds_read_b64_tr_b16 v[162:163], v8 offset:21504
    v_mfma_f32_32x32x16_bf16 v[112:127], v[180:183], a[84:87], v[112:127]
    ds_read_b64_tr_b16 v[164:165], v9 offset:20480
    ds_read_b64_tr_b16 v[166:167], v9 offset:21504
    v_mfma_f32_32x32x16_bf16 v[128:143], v[184:187], a[84:87], v[128:143]
    ds_read_b64_tr_b16 v[168:169], v10 offset:20480
    ds_read_b64_tr_b16 v[170:171], v10 offset:21504
    v_mfma_f32_32x32x16_bf16 v[144:159], v[188:191], a[84:87], v[144:159]
    ds_read_b64_tr_b16 v[172:173], v11 offset:20480
    ds_read_b64_tr_b16 v[174:175], v11 offset:21504
    s_waitcnt lgkmcnt(9)
    v_mfma_f32_32x32x16_bf16 v[96:111], v[192:195], a[88:91], v[96:111]
    s_cmp_ge_u32 s59, 5
    s_cbranch_scc1 K1_L5_OK
K1_L5:
    ds_read_b32 v58, v18 offset:4
    s_waitcnt lgkmcnt(0)
    v_readfirstlane_b32 s59, v58
    s_cmp_ge_u32 s59, 5
    s_cbranch_scc0 K1_L5
K1_L5_OK:
    ds_read_b64_tr_b16 v[176:177], v4 offset:24576
    ds_read_b64_tr_b16 v[178:179], v4 offset:25600
    v_mfma_f32_32x32x16_bf16 v[112:127], v[196:199], a[88:91], v[112:127]
    ds_read_b64_tr_b16 v[180:181], v5 offset:24576
    ds_read_b64_tr_b16 v[182:183], v5 offset:25600
    v_mfma_f32_32x32x16_bf16 v[128:143], v[200:203], a[88:91], v[128:143]
    ds_read_b64_tr_b16 v[184:185], v6 offset:24576
    ds_read_b64_tr_b16 v[186:187], v6 offset:25600
    v_mfma_f32_32x32x16_bf16 v[144:159], v[204:207], a[88:91], v[144:159]
    ds_read_b64_tr_b16 v[188:189], v7 offset:24576
    ds_read_b64_tr_b16 v[190:191], v7 offset:25600
    s_waitcnt lgkmcnt(8)
    v_mov_b32 v55, 4
    ds_write_b32 v56, v55
    v_mfma_f32_32x32x16_bf16 v[96:111], v[160:163], a[92:95], v[96:111]
    ds_read_b64_tr_b16 v[192:193], v4 offset:28672
    ds_read_b64_tr_b16 v[194:195], v4 offset:29696
    v_mfma_f32_32x32x16_bf16 v[112:127], v[164:167], a[92:95], v[112:127]
    ds_read_b64_tr_b16 v[196:197], v5 offset:28672
    ds_read_b64_tr_b16 v[198:199], v5 offset:29696
    v_mfma_f32_32x32x16_bf16 v[128:143], v[168:171], a[92:95], v[128:143]
    ds_read_b64_tr_b16 v[200:201], v6 offset:28672
    ds_read_b64_tr_b16 v[202:203], v6 offset:29696
    v_mfma_f32_32x32x16_bf16 v[144:159], v[172:175], a[92:95], v[144:159]
    ds_read_b64_tr_b16 v[204:205], v7 offset:28672
    ds_read_b64_tr_b16 v[206:207], v7 offset:29696
    s_waitcnt lgkmcnt(9)
    v_mfma_f32_32x32x16_bf16 v[96:111], v[176:179], a[96:99], v[96:111]
    ds_read_b64_tr_b16 v[160:161], v4 offset:32768
    ds_read_b64_tr_b16 v[162:163], v4 offset:33792
    v_mfma_f32_32x32x16_bf16 v[112:127], v[180:183], a[96:99], v[112:127]
    ds_read_b64_tr_b16 v[164:165], v5 offset:32768
    ds_read_b64_tr_b16 v[166:167], v5 offset:33792
    v_mfma_f32_32x32x16_bf16 v[128:143], v[184:187], a[96:99], v[128:143]
    ds_read_b64_tr_b16 v[168:169], v6 offset:32768
    ds_read_b64_tr_b16 v[170:171], v6 offset:33792
    v_mfma_f32_32x32x16_bf16 v[144:159], v[188:191], a[96:99], v[144:159]
    ds_read_b64_tr_b16 v[172:173], v7 offset:32768
    ds_read_b64_tr_b16 v[174:175], v7 offset:33792
    s_waitcnt lgkmcnt(8)
    v_mfma_f32_32x32x16_bf16 v[96:111], v[192:195], a[100:103], v[96:111]
    ds_read_b64_tr_b16 v[176:177], v4 offset:36864
    ds_read_b64_tr_b16 v[178:179], v4 offset:37888
    v_mfma_f32_32x32x16_bf16 v[112:127], v[196:199], a[100:103], v[112:127]
    ds_read_b64_tr_b16 v[180:181], v5 offset:36864
    ds_read_b64_tr_b16 v[182:183], v5 offset:37888
    v_mfma_f32_32x32x16_bf16 v[128:143], v[200:203], a[100:103], v[128:143]
    ds_read_b64_tr_b16 v[184:185], v6 offset:36864
    ds_read_b64_tr_b16 v[186:187], v6 offset:37888
    v_mfma_f32_32x32x16_bf16 v[144:159], v[204:207], a[100:103], v[144:159]
    ds_read_b64_tr_b16 v[188:189], v7 offset:36864
    ds_read_b64_tr_b16 v[190:191], v7 offset:37888
    s_waitcnt lgkmcnt(8)
    v_mfma_f32_32x32x16_bf16 v[96:111], v[160:163], a[104:107], v[96:111]
    s_cmp_ge_u32 s59, 6
    s_cbranch_scc1 K1_L6_OK
K1_L6:
    ds_read_b32 v58, v18 offset:4
    s_waitcnt lgkmcnt(0)
    v_readfirstlane_b32 s59, v58
    s_cmp_ge_u32 s59, 6
    s_cbranch_scc0 K1_L6
K1_L6_OK:
    ds_read_b64_tr_b16 v[192:193], v8 offset:24576
    ds_read_b64_tr_b16 v[194:195], v8 offset:25600
    v_mfma_f32_32x32x16_bf16 v[112:127], v[164:167], a[104:107], v[112:127]
    ds_read_b64_tr_b16 v[196:197], v9 offset:24576
    ds_read_b64_tr_b16 v[198:199], v9 offset:25600
    v_mfma_f32_32x32x16_bf16 v[128:143], v[168:171], a[104:107], v[128:143]
    ds_read_b64_tr_b16 v[200:201], v10 offset:24576
    ds_read_b64_tr_b16 v[202:203], v10 offset:25600
    v_mfma_f32_32x32x16_bf16 v[144:159], v[172:175], a[104:107], v[144:159]
    ds_read_b64_tr_b16 v[204:205], v11 offset:24576
    ds_read_b64_tr_b16 v[206:207], v11 offset:25600
    s_waitcnt lgkmcnt(8)
    v_mov_b32 v55, 5
    ds_write_b32 v56, v55
    v_mfma_f32_32x32x16_bf16 v[96:111], v[176:179], a[108:111], v[96:111]
    ds_read_b64_tr_b16 v[160:161], v8 offset:28672
    ds_read_b64_tr_b16 v[162:163], v8 offset:29696
    v_mfma_f32_32x32x16_bf16 v[112:127], v[180:183], a[108:111], v[112:127]
    ds_read_b64_tr_b16 v[164:165], v9 offset:28672
    ds_read_b64_tr_b16 v[166:167], v9 offset:29696
    v_mfma_f32_32x32x16_bf16 v[128:143], v[184:187], a[108:111], v[128:143]
    ds_read_b64_tr_b16 v[168:169], v10 offset:28672
    ds_read_b64_tr_b16 v[170:171], v10 offset:29696
    v_mfma_f32_32x32x16_bf16 v[144:159], v[188:191], a[108:111], v[144:159]
    ds_read_b64_tr_b16 v[172:173], v11 offset:28672
    ds_read_b64_tr_b16 v[174:175], v11 offset:29696
    s_waitcnt lgkmcnt(9)
    v_mfma_f32_32x32x16_bf16 v[96:111], v[192:195], a[112:115], v[96:111]
    ds_read_b64_tr_b16 v[176:177], v8 offset:32768
    ds_read_b64_tr_b16 v[178:179], v8 offset:33792
    v_mfma_f32_32x32x16_bf16 v[112:127], v[196:199], a[112:115], v[112:127]
    ds_read_b64_tr_b16 v[180:181], v9 offset:32768
    ds_read_b64_tr_b16 v[182:183], v9 offset:33792
    v_mfma_f32_32x32x16_bf16 v[128:143], v[200:203], a[112:115], v[128:143]
    ds_read_b64_tr_b16 v[184:185], v10 offset:32768
    ds_read_b64_tr_b16 v[186:187], v10 offset:33792
    v_mfma_f32_32x32x16_bf16 v[144:159], v[204:207], a[112:115], v[144:159]
    ds_read_b64_tr_b16 v[188:189], v11 offset:32768
    ds_read_b64_tr_b16 v[190:191], v11 offset:33792
    s_waitcnt lgkmcnt(8)
    v_mfma_f32_32x32x16_bf16 v[96:111], v[160:163], a[116:119], v[96:111]
    ds_read_b64_tr_b16 v[192:193], v8 offset:36864
    ds_read_b64_tr_b16 v[194:195], v8 offset:37888
    v_mfma_f32_32x32x16_bf16 v[112:127], v[164:167], a[116:119], v[112:127]
    ds_read_b64_tr_b16 v[196:197], v9 offset:36864
    ds_read_b64_tr_b16 v[198:199], v9 offset:37888
    v_mfma_f32_32x32x16_bf16 v[128:143], v[168:171], a[116:119], v[128:143]
    ds_read_b64_tr_b16 v[200:201], v10 offset:36864
    ds_read_b64_tr_b16 v[202:203], v10 offset:37888
    v_mfma_f32_32x32x16_bf16 v[144:159], v[172:175], a[116:119], v[144:159]
    ds_read_b64_tr_b16 v[204:205], v11 offset:36864
    ds_read_b64_tr_b16 v[206:207], v11 offset:37888
    s_waitcnt lgkmcnt(8)
    v_mfma_f32_32x32x16_bf16 v[96:111], v[176:179], a[120:123], v[96:111]
    s_cmp_ge_u32 s59, 7
    s_cbranch_scc1 K1_L7_OK
K1_L7:
    ds_read_b32 v58, v18 offset:4
    s_waitcnt lgkmcnt(0)
    v_readfirstlane_b32 s59, v58
    s_cmp_ge_u32 s59, 7
    s_cbranch_scc0 K1_L7
K1_L7_OK:
    ds_read_b64_tr_b16 v[160:161], v12 offset:0
    ds_read_b64_tr_b16 v[162:163], v12 offset:1024
    v_mfma_f32_32x32x16_bf16 v[112:127], v[180:183], a[120:123], v[112:127]
    ds_read_b64_tr_b16 v[164:165], v13 offset:0
    ds_read_b64_tr_b16 v[166:167], v13 offset:1024
    v_mfma_f32_32x32x16_bf16 v[128:143], v[184:187], a[120:123], v[128:143]
    ds_read_b64_tr_b16 v[168:169], v14 offset:0
    ds_read_b64_tr_b16 v[170:171], v14 offset:1024
    v_mfma_f32_32x32x16_bf16 v[144:159], v[188:191], a[120:123], v[144:159]
    ds_read_b64_tr_b16 v[172:173], v15 offset:0
    ds_read_b64_tr_b16 v[174:175], v15 offset:1024
    s_waitcnt lgkmcnt(8)
    v_mov_b32 v55, 6
    ds_write_b32 v56, v55
    v_mfma_f32_32x32x16_bf16 v[96:111], v[192:195], a[124:127], v[96:111]
    ds_read_b64_tr_b16 v[176:177], v12 offset:4096
    ds_read_b64_tr_b16 v[178:179], v12 offset:5120
    v_mfma_f32_32x32x16_bf16 v[112:127], v[196:199], a[124:127], v[112:127]
    ds_read_b64_tr_b16 v[180:181], v13 offset:4096
    ds_read_b64_tr_b16 v[182:183], v13 offset:5120
    v_mfma_f32_32x32x16_bf16 v[128:143], v[200:203], a[124:127], v[128:143]
    ds_read_b64_tr_b16 v[184:185], v14 offset:4096
    ds_read_b64_tr_b16 v[186:187], v14 offset:5120
    v_mfma_f32_32x32x16_bf16 v[144:159], v[204:207], a[124:127], v[144:159]
    ds_read_b64_tr_b16 v[188:189], v15 offset:4096
    ds_read_b64_tr_b16 v[190:191], v15 offset:5120
    s_waitcnt lgkmcnt(9)
    v_mfma_f32_32x32x16_bf16 v[96:111], v[160:163], a[128:131], v[96:111]
    ds_read_b64_tr_b16 v[192:193], v12 offset:8192
    ds_read_b64_tr_b16 v[194:195], v12 offset:9216
    v_mfma_f32_32x32x16_bf16 v[112:127], v[164:167], a[128:131], v[112:127]
    ds_read_b64_tr_b16 v[196:197], v13 offset:8192
    ds_read_b64_tr_b16 v[198:199], v13 offset:9216
    v_mfma_f32_32x32x16_bf16 v[128:143], v[168:171], a[128:131], v[128:143]
    ds_read_b64_tr_b16 v[200:201], v14 offset:8192
    ds_read_b64_tr_b16 v[202:203], v14 offset:9216
    v_mfma_f32_32x32x16_bf16 v[144:159], v[172:175], a[128:131], v[144:159]
    ds_read_b64_tr_b16 v[204:205], v15 offset:8192
    ds_read_b64_tr_b16 v[206:207], v15 offset:9216
    s_waitcnt lgkmcnt(8)
    v_mfma_f32_32x32x16_bf16 v[96:111], v[176:179], a[132:135], v[96:111]
    ds_read_b64_tr_b16 v[160:161], v12 offset:12288
    ds_read_b64_tr_b16 v[162:163], v12 offset:13312
    v_mfma_f32_32x32x16_bf16 v[112:127], v[180:183], a[132:135], v[112:127]
    ds_read_b64_tr_b16 v[164:165], v13 offset:12288
    ds_read_b64_tr_b16 v[166:167], v13 offset:13312
    v_mfma_f32_32x32x16_bf16 v[128:143], v[184:187], a[132:135], v[128:143]
    ds_read_b64_tr_b16 v[168:169], v14 offset:12288
    ds_read_b64_tr_b16 v[170:171], v14 offset:13312
    v_mfma_f32_32x32x16_bf16 v[144:159], v[188:191], a[132:135], v[144:159]
    ds_read_b64_tr_b16 v[172:173], v15 offset:12288
    ds_read_b64_tr_b16 v[174:175], v15 offset:13312
    s_waitcnt lgkmcnt(8)
    v_mfma_f32_32x32x16_bf16 v[96:111], v[192:195], a[136:139], v[96:111]
    s_cmp_ge_u32 s59, 8
    s_cbranch_scc1 K1_L8_OK
K1_L8:
    ds_read_b32 v58, v18 offset:4
    s_waitcnt lgkmcnt(0)
    v_readfirstlane_b32 s59, v58
    s_cmp_ge_u32 s59, 8
    s_cbranch_scc0 K1_L8
K1_L8_OK:
    ds_read_b64_tr_b16 v[176:177], v12 offset:16384
    ds_read_b64_tr_b16 v[178:179], v12 offset:17408
    v_mfma_f32_32x32x16_bf16 v[112:127], v[196:199], a[136:139], v[112:127]
    ds_read_b64_tr_b16 v[180:181], v13 offset:16384
    ds_read_b64_tr_b16 v[182:183], v13 offset:17408
    v_mfma_f32_32x32x16_bf16 v[128:143], v[200:203], a[136:139], v[128:143]
    ds_read_b64_tr_b16 v[184:185], v14 offset:16384
    ds_read_b64_tr_b16 v[186:187], v14 offset:17408
    v_mfma_f32_32x32x16_bf16 v[144:159], v[204:207], a[136:139], v[144:159]
    ds_read_b64_tr_b16 v[188:189], v15 offset:16384
    ds_read_b64_tr_b16 v[190:191], v15 offset:17408
    s_waitcnt lgkmcnt(8)
    v_mov_b32 v55, 7
    ds_write_b32 v56, v55
    v_mfma_f32_32x32x16_bf16 v[96:111], v[160:163], a[140:143], v[96:111]
    ds_read_b64_tr_b16 v[192:193], v12 offset:20480
    ds_read_b64_tr_b16 v[194:195], v12 offset:21504
    v_mfma_f32_32x32x16_bf16 v[112:127], v[164:167], a[140:143], v[112:127]
    ds_read_b64_tr_b16 v[196:197], v13 offset:20480
    ds_read_b64_tr_b16 v[198:199], v13 offset:21504
    v_mfma_f32_32x32x16_bf16 v[128:143], v[168:171], a[140:143], v[128:143]
    ds_read_b64_tr_b16 v[200:201], v14 offset:20480
    ds_read_b64_tr_b16 v[202:203], v14 offset:21504
    v_mfma_f32_32x32x16_bf16 v[144:159], v[172:175], a[140:143], v[144:159]
    ds_read_b64_tr_b16 v[204:205], v15 offset:20480
    ds_read_b64_tr_b16 v[206:207], v15 offset:21504
    s_waitcnt lgkmcnt(9)
    v_mfma_f32_32x32x16_bf16 v[96:111], v[176:179], a[144:147], v[96:111]
    ds_read_b64_tr_b16 v[160:161], v8 offset:0
    ds_read_b64_tr_b16 v[162:163], v8 offset:1024
    v_mfma_f32_32x32x16_bf16 v[112:127], v[180:183], a[144:147], v[112:127]
    ds_read_b64_tr_b16 v[164:165], v9 offset:0
    ds_read_b64_tr_b16 v[166:167], v9 offset:1024
    v_mfma_f32_32x32x16_bf16 v[128:143], v[184:187], a[144:147], v[128:143]
    ds_read_b64_tr_b16 v[168:169], v10 offset:0
    ds_read_b64_tr_b16 v[170:171], v10 offset:1024
    v_mfma_f32_32x32x16_bf16 v[144:159], v[188:191], a[144:147], v[144:159]
    ds_read_b64_tr_b16 v[172:173], v11 offset:0
    ds_read_b64_tr_b16 v[174:175], v11 offset:1024
    s_waitcnt lgkmcnt(8)
    v_mfma_f32_32x32x16_bf16 v[96:111], v[192:195], a[148:151], v[96:111]
    ds_read_b64_tr_b16 v[176:177], v8 offset:4096
    ds_read_b64_tr_b16 v[178:179], v8 offset:5120
    v_mfma_f32_32x32x16_bf16 v[112:127], v[196:199], a[148:151], v[112:127]
    ds_read_b64_tr_b16 v[180:181], v9 offset:4096
    ds_read_b64_tr_b16 v[182:183], v9 offset:5120
    v_mfma_f32_32x32x16_bf16 v[128:143], v[200:203], a[148:151], v[128:143]
    ds_read_b64_tr_b16 v[184:185], v10 offset:4096
    ds_read_b64_tr_b16 v[186:187], v10 offset:5120
    v_mfma_f32_32x32x16_bf16 v[144:159], v[204:207], a[148:151], v[144:159]
    ds_read_b64_tr_b16 v[188:189], v11 offset:4096
    ds_read_b64_tr_b16 v[190:191], v11 offset:5120
    s_waitcnt lgkmcnt(8)
    v_mfma_f32_32x32x16_bf16 v[96:111], v[160:163], a[152:155], v[96:111]
    v_mfma_f32_32x32x16_bf16 v[112:127], v[164:167], a[152:155], v[112:127]
    v_mfma_f32_32x32x16_bf16 v[128:143], v[168:171], a[152:155], v[128:143]
    v_mfma_f32_32x32x16_bf16 v[144:159], v[172:175], a[152:155], v[144:159]
    s_waitcnt lgkmcnt(0)
    v_mov_b32 v55, 8
    ds_write_b32 v56, v55
    v_mfma_f32_32x32x16_bf16 v[96:111], v[176:179], a[156:159], v[96:111]
    v_mfma_f32_32x32x16_bf16 v[112:127], v[180:183], a[156:159], v[112:127]
    v_mfma_f32_32x32x16_bf16 v[128:143], v[184:187], a[156:159], v[128:143]
    v_mfma_f32_32x32x16_bf16 v[144:159], v[188:191], a[156:159], v[144:159]
    s_mov_b32 s59, 0
    s_mov_b32 s58, 1
    s_cmp_ge_u32 s59, s58
    s_cbranch_scc1 K1_L9_OK
K1_L9:
    ds_read_b32 v58, v18 offset:0
    s_waitcnt lgkmcnt(0)
    v_readfirstlane_b32 s59, v58
    s_cmp_ge_u32 s59, s58
    s_cbranch_scc0 K1_L9
K1_L9_OK:
    s_add_u32 s58, s58, 1
    ds_read_b128 v[216:219], v20 offset:0
    ds_read_b128 v[220:223], v21 offset:0
    ds_read_b128 v[224:227], v22 offset:0
    ds_read_b128 v[228:231], v23 offset:0
    ds_read_b128 v[232:235], v24 offset:0
    ds_read_b128 v[236:239], v25 offset:0
    ds_read_b128 v[240:243], v26 offset:0
    ds_read_b128 v[244:247], v27 offset:0
    s_nop 7
    v_cvt_pk_bf16_f32 v64, v96, v97
    v_cvt_pk_bf16_f32 v65, v98, v99
    v_cvt_pk_bf16_f32 v66, v100, v101
    v_cvt_pk_bf16_f32 v67, v102, v103
    s_nop 1
    v_permlane32_swap_b32 v64, v66
    v_permlane32_swap_b32 v65, v67
    v_cvt_pk_bf16_f32 v68, v104, v105
    v_cvt_pk_bf16_f32 v69, v106, v107
    v_cvt_pk_bf16_f32 v70, v108, v109
    v_cvt_pk_bf16_f32 v71, v110, v111
    s_nop 1
    v_permlane32_swap_b32 v68, v70
    v_permlane32_swap_b32 v69, v71
    v_cvt_pk_bf16_f32 v72, v112, v113
    v_cvt_pk_bf16_f32 v73, v114, v115
    v_cvt_pk_bf16_f32 v74, v116, v117
    v_cvt_pk_bf16_f32 v75, v118, v119
    s_nop 1
    v_permlane32_swap_b32 v72, v74
    v_permlane32_swap_b32 v73, v75
    v_cvt_pk_bf16_f32 v76, v120, v121
    v_cvt_pk_bf16_f32 v77, v122, v123
    v_cvt_pk_bf16_f32 v78, v124, v125
    v_cvt_pk_bf16_f32 v79, v126, v127
    s_nop 1
    v_permlane32_swap_b32 v76, v78
    v_permlane32_swap_b32 v77, v79
    v_cvt_pk_bf16_f32 v80, v128, v129
    v_cvt_pk_bf16_f32 v81, v130, v131
    v_cvt_pk_bf16_f32 v82, v132, v133
    v_cvt_pk_bf16_f32 v83, v134, v135
    s_nop 1
    v_permlane32_swap_b32 v80, v82
    v_permlane32_swap_b32 v81, v83
    v_cvt_pk_bf16_f32 v84, v136, v137
    v_cvt_pk_bf16_f32 v85, v138, v139
    v_cvt_pk_bf16_f32 v86, v140, v141
    v_cvt_pk_bf16_f32 v87, v142, v143
    s_nop 1
    v_permlane32_swap_b32 v84, v86
    v_permlane32_swap_b32 v85, v87
    v_cvt_pk_bf16_f32 v88, v144, v145
    v_cvt_pk_bf16_f32 v89, v146, v147
    v_cvt_pk_bf16_f32 v90, v148, v149
    v_cvt_pk_bf16_f32 v91, v150, v151
    s_nop 1
    v_permlane32_swap_b32 v88, v90
    v_permlane32_swap_b32 v89, v91
    v_cvt_pk_bf16_f32 v92, v152, v153
    v_cvt_pk_bf16_f32 v93, v154, v155
    v_cvt_pk_bf16_f32 v94, v156, v157
    v_cvt_pk_bf16_f32 v95, v158, v159
    s_nop 1
    v_permlane32_swap_b32 v92, v94
    v_permlane32_swap_b32 v93, v95
    s_waitcnt lgkmcnt(0)
    v_mfma_f32_32x32x16_bf16 v[160:175], v[216:219], v[64:67], 0
    v_mov_b32 v96, 0
    v_mov_b32 v97, 0
    v_mov_b32 v98, 0
    v_mov_b32 v99, 0
    v_mov_b32 v100, 0
    v_mov_b32 v101, 0
    v_mov_b32 v102, 0
    v_mov_b32 v103, 0
    v_mfma_f32_32x32x16_bf16 v[160:175], v[220:223], v[68:71], v[160:175]
    v_mov_b32 v104, 0
    v_mov_b32 v105, 0
    v_mov_b32 v106, 0
    v_mov_b32 v107, 0
    v_mov_b32 v108, 0
    v_mov_b32 v109, 0
    v_mov_b32 v110, 0
    v_mov_b32 v111, 0
    v_mov_b32 v112, 0
    v_mfma_f32_32x32x16_bf16 v[160:175], v[224:227], v[72:75], v[160:175]
    v_mov_b32 v113, 0
    v_mov_b32 v114, 0
    v_mov_b32 v115, 0
    v_mov_b32 v116, 0
    v_mov_b32 v117, 0
    v_mov_b32 v118, 0
    v_mov_b32 v119, 0
    v_mov_b32 v120, 0
    v_mfma_f32_32x32x16_bf16 v[160:175], v[228:231], v[76:79], v[160:175]
    v_mov_b32 v121, 0
    v_mov_b32 v122, 0
    v_mov_b32 v123, 0
    v_mov_b32 v124, 0
    v_mov_b32 v125, 0
    v_mov_b32 v126, 0
    v_mov_b32 v127, 0
    v_mov_b32 v128, 0
    v_mfma_f32_32x32x16_bf16 v[160:175], v[232:235], v[80:83], v[160:175]
    v_mov_b32 v129, 0
    v_mov_b32 v130, 0
    v_mov_b32 v131, 0
    v_mov_b32 v132, 0
    v_mov_b32 v133, 0
    v_mov_b32 v134, 0
    v_mov_b32 v135, 0
    v_mov_b32 v136, 0
    v_mfma_f32_32x32x16_bf16 v[160:175], v[236:239], v[84:87], v[160:175]
    v_mov_b32 v137, 0
    v_mov_b32 v138, 0
    v_mov_b32 v139, 0
    v_mov_b32 v140, 0
    v_mov_b32 v141, 0
    v_mov_b32 v142, 0
    v_mov_b32 v143, 0
    v_mov_b32 v144, 0
    v_mov_b32 v145, 0
    v_mfma_f32_32x32x16_bf16 v[160:175], v[240:243], v[88:91], v[160:175]
    v_mov_b32 v146, 0
    v_mov_b32 v147, 0
    v_mov_b32 v148, 0
    v_mov_b32 v149, 0
    v_mov_b32 v150, 0
    v_mov_b32 v151, 0
    v_mov_b32 v152, 0
    v_mov_b32 v153, 0
    v_mfma_f32_32x32x16_bf16 v[160:175], v[244:247], v[92:95], v[160:175]
    v_mov_b32 v154, 0
    v_mov_b32 v155, 0
    v_mov_b32 v156, 0
    v_mov_b32 v157, 0
    v_mov_b32 v158, 0
    v_mov_b32 v159, 0
    v_mov_b32 v48, 0x7f800000
    v_mov_b32 v49, 0
    v_add_u32 v55, 1, v55
    ds_write_b32 v56, v55
    s_cmp_ge_u32 s59, s58
    s_cbranch_scc1 K1_L10_OK
K1_L10:
    ds_read_b32 v58, v18 offset:0
    s_waitcnt lgkmcnt(0)
    v_readfirstlane_b32 s59, v58
    s_cmp_ge_u32 s59, s58
    s_cbranch_scc0 K1_L10
K1_L10_OK:
    s_add_u32 s58, s58, 1
    ds_read_b128 v[216:219], v20 offset:8192
    ds_read_b128 v[220:223], v21 offset:8192
    ds_read_b128 v[224:227], v22 offset:8192
    ds_read_b128 v[228:231], v23 offset:8192
    ds_read_b128 v[232:235], v24 offset:8192
    ds_read_b128 v[236:239], v25 offset:8192
    ds_read_b128 v[240:243], v26 offset:8192
    ds_read_b128 v[244:247], v27 offset:8192
    s_nop 7
    v_fma_f32 v192, v160, s52, v48
    v_fma_f32 v193, v161, s52, v48
    v_fma_f32 v194, v162, s52, v48
    v_fma_f32 v195, v163, s52, v48
    v_exp_f32 v192, v192
    v_fma_f32 v196, v164, s52, v48
    v_exp_f32 v193, v193
    v_fma_f32 v197, v165, s52, v48
    v_exp_f32 v194, v194
    v_fma_f32 v198, v166, s52, v48
    v_exp_f32 v195, v195
    v_fma_f32 v199, v167, s52, v48
    v_exp_f32 v196, v196
    v_fma_f32 v200, v168, s52, v48
    v_exp_f32 v197, v197
    v_fma_f32 v201, v169, s52, v48
    v_exp_f32 v198, v198
    v_fma_f32 v202, v170, s52, v48
    v_exp_f32 v199, v199
    v_fma_f32 v203, v171, s52, v48
    v_exp_f32 v200, v200
    v_fma_f32 v204, v172, s52, v48
    v_exp_f32 v201, v201
    v_fma_f32 v205, v173, s52, v48
    v_fma_f32 v206, v174, s52, v48
    v_fma_f32 v207, v175, s52, v48
K1_LOOP:
    s_waitcnt lgkmcnt(0)
    v_mfma_f32_32x32x16_bf16 v[176:191], v[216:219], v[64:67], 0
    ds_read_b64_tr_b16 a[0:1], v28 offset:8192
    ds_read_b64_tr_b16 a[2:3], v28 offset:10240
    v_exp_f32 v202, v202
    ds_read_b64_tr_b16 a[4:5], v29 offset:8192
    ds_read_b64_tr_b16 a[6:7], v29 offset:10240
    v_mfma_f32_32x32x16_bf16 v[176:191], v[220:223], v[68:71], v[176:191]
    v_exp_f32 v203, v203
    ds_read_b64_tr_b16 a[8:9], v30 offset:8192
    ds_read_b64_tr_b16 a[10:11], v30 offset:10240
    v_exp_f32 v204, v204
    v_mfma_f32_32x32x16_bf16 v[176:191], v[224:227], v[72:75], v[176:191]
    ds_read_b64_tr_b16 a[12:13], v31 offset:8192
    ds_read_b64_tr_b16 a[14:15], v31 offset:10240
    v_exp_f32 v205, v205
    ds_read_b64_tr_b16 a[16:17], v28 offset:12288
    ds_read_b64_tr_b16 a[18:19], v28 offset:14336
    v_mfma_f32_32x32x16_bf16 v[176:191], v[228:231], v[76:79], v[176:191]
    v_exp_f32 v206, v206
    ds_read_b64_tr_b16 a[20:21], v29 offset:12288
    ds_read_b64_tr_b16 a[22:23], v29 offset:14336
    v_exp_f32 v207, v207
    v_mfma_f32_32x32x16_bf16 v[176:191], v[232:235], v[80:83], v[176:191]
    ds_read_b64_tr_b16 a[24:25], v30 offset:12288
    ds_read_b64_tr_b16 a[26:27], v30 offset:14336
    s_nop 0
    v_add_f32 v50, v192, v193
    v_add_f32 v51, v194, v195
    ds_read_b64_tr_b16 a[28:29], v31 offset:12288
    v_mfma_f32_32x32x16_bf16 v[176:191], v[236:239], v[84:87], v[176:191]
    ds_read_b64_tr_b16 a[30:31], v31 offset:14336
    v_add_f32 v50, v50, v196
    v_add_f32 v51, v51, v197
    v_add_f32 v50, v50, v198
    v_add_f32 v51, v51, v199
    v_add_f32 v50, v50, v200
    v_add_f32 v51, v51, v201
    v_add_f32 v50, v50, v202
    v_mfma_f32_32x32x16_bf16 v[176:191], v[240:243], v[88:91], v[176:191]
    v_add_f32 v51, v51, v203
    v_add_f32 v50, v50, v204
    v_add_f32 v51, v51, v205
    v_add_f32 v50, v50, v206
    v_add_f32 v51, v51, v207
    v_add_f32 v50, v50, v51
    v_cmp_nge_f32 vcc, s53, v50
    s_cbranch_vccnz K1_RARE0
K1_CK0:
    v_mfma_f32_32x32x16_bf16 v[176:191], v[244:247], v[92:95], v[176:191]
    v_add_f32 v49, v49, v50
    v_cvt_pk_bf16_f32 v208, v192, v193
    v_cvt_pk_bf16_f32 v209, v194, v195
    v_cvt_pk_bf16_f32 v210, v196, v197
    v_cvt_pk_bf16_f32 v211, v198, v199
    v_cvt_pk_bf16_f32 v212, v200, v201
    v_cvt_pk_bf16_f32 v213, v202, v203
    v_cvt_pk_bf16_f32 v214, v204, v205
    v_cvt_pk_bf16_f32 v215, v206, v207
    s_waitcnt lgkmcnt(0)
    v_add_u32 v55, 1, v55
    ds_write_b32 v56, v55
    v_mfma_f32_32x32x16_bf16 v[96:111], a[0:3], v[208:211], v[96:111]
    s_nop 3
    v_fma_f32 v192, v176, s52, v48
    v_fma_f32 v193, v177, s52, v48
    v_fma_f32 v194, v178, s52, v48
    v_fma_f32 v195, v179, s52, v48
    v_exp_f32 v192, v192
    v_mfma_f32_32x32x16_bf16 v[112:127], a[4:7], v[208:211], v[112:127]
    v_fma_f32 v196, v180, s52, v48
    v_exp_f32 v193, v193
    v_fma_f32 v197, v181, s52, v48
    v_exp_f32 v194, v194
    v_fma_f32 v198, v182, s52, v48
    v_mfma_f32_32x32x16_bf16 v[128:143], a[8:11], v[208:211], v[128:143]
    s_cmp_ge_u32 s59, s58
    s_cbranch_scc1 K1_L11_OK
K1_L11:
    ds_read_b32 v58, v18 offset:0
    s_waitcnt lgkmcnt(0)
    v_readfirstlane_b32 s59, v58
    s_cmp_ge_u32 s59, s58
    s_cbranch_scc0 K1_L11
K1_L11_OK:
    s_add_u32 s58, s58, 1
    ds_read_b128 v[216:219], v20 offset:16384
    ds_read_b128 v[220:223], v21 offset:16384
    v_mfma_f32_32x32x16_bf16 v[144:159], a[12:15], v[208:211], v[144:159]
    v_exp_f32 v195, v195
    v_fma_f32 v199, v183, s52, v48
    ds_read_b128 v[224:227], v22 offset:16384
    ds_read_b128 v[228:231], v23 offset:16384
    v_mfma_f32_32x32x16_bf16 v[96:111], a[16:19], v[212:215], v[96:111]
    v_exp_f32 v196, v196
    v_fma_f32 v200, v184, s52, v48
    ds_read_b128 v[232:235], v24 offset:16384
    ds_read_b128 v[236:239], v25 offset:16384
    v_mfma_f32_32x32x16_bf16 v[112:127], a[20:23], v[212:215], v[112:127]
    v_exp_f32 v197, v197
    v_fma_f32 v201, v185, s52, v48
    ds_read_b128 v[240:243], v26 offset:16384
    ds_read_b128 v[244:247], v27 offset:16384
    v_mfma_f32_32x32x16_bf16 v[128:143], a[24:27], v[212:215], v[128:143]
    v_exp_f32 v198, v198
    v_fma_f32 v202, v186, s52, v48
    v_exp_f32 v199, v199
    v_fma_f32 v203, v187, s52, v48
    v_exp_f32 v200, v200
    v_mfma_f32_32x32x16_bf16 v[144:159], a[28:31], v[212:215], v[144:159]
    v_fma_f32 v204, v188, s52, v48
    v_exp_f32 v201, v201
    v_fma_f32 v205, v189, s52, v48
    v_fma_f32 v206, v190, s52, v48
    v_fma_f32 v207, v191, s52, v48
    s_waitcnt lgkmcnt(0)
    v_mfma_f32_32x32x16_bf16 v[160:175], v[216:219], v[64:67], 0
    ds_read_b64_tr_b16 a[0:1], v28 offset:16384
    ds_read_b64_tr_b16 a[2:3], v28 offset:18432
    v_exp_f32 v202, v202
    ds_read_b64_tr_b16 a[4:5], v29 offset:16384
    ds_read_b64_tr_b16 a[6:7], v29 offset:18432
    v_mfma_f32_32x32x16_bf16 v[160:175], v[220:223], v[68:71], v[160:175]
    v_exp_f32 v203, v203
    ds_read_b64_tr_b16 a[8:9], v30 offset:16384
    ds_read_b64_tr_b16 a[10:11], v30 offset:18432
    v_exp_f32 v204, v204
    v_mfma_f32_32x32x16_bf16 v[160:175], v[224:227], v[72:75], v[160:175]
    ds_read_b64_tr_b16 a[12:13], v31 offset:16384
    ds_read_b64_tr_b16 a[14:15], v31 offset:18432
    v_exp_f32 v205, v205
    ds_read_b64_tr_b16 a[16:17], v28 offset:20480
    ds_read_b64_tr_b16 a[18:19], v28 offset:22528
    v_mfma_f32_32x32x16_bf16 v[160:175], v[228:231], v[76:79], v[160:175]
    v_exp_f32 v206, v206
    ds_read_b64_tr_b16 a[20:21], v29 offset:20480
    ds_read_b64_tr_b16 a[22:23], v29 offset:22528
    v_exp_f32 v207, v207
    v_mfma_f32_32x32x16_bf16 v[160:175], v[232:235], v[80:83], v[160:175]
    ds_read_b64_tr_b16 a[24:25], v30 offset:20480
    ds_read_b64_tr_b16 a[26:27], v30 offset:22528
    s_nop 0
    v_add_f32 v50, v192, v193
    v_add_f32 v51, v194, v195
    ds_read_b64_tr_b16 a[28:29], v31 offset:20480
    v_mfma_f32_32x32x16_bf16 v[160:175], v[236:239], v[84:87], v[160:175]
    ds_read_b64_tr_b16 a[30:31], v31 offset:22528
    v_add_f32 v50, v50, v196
    v_add_f32 v51, v51, v197
    v_add_f32 v50, v50, v198
    v_add_f32 v51, v51, v199
    v_add_f32 v50, v50, v200
    v_add_f32 v51, v51, v201
    v_add_f32 v50, v50, v202
    v_mfma_f32_32x32x16_bf16 v[160:175], v[240:243], v[88:91], v[160:175]
    v_add_f32 v51, v51, v203
    v_add_f32 v50, v50, v204
    v_add_f32 v51, v51, v205
    v_add_f32 v50, v50, v206
    v_add_f32 v51, v51, v207
    v_add_f32 v50, v50, v51
    v_cmp_nge_f32 vcc, s53, v50
    s_cbranch_vccnz K1_RARE1
K1_CK1:
    v_mfma_f32_32x32x16_bf16 v[160:175], v[244:247], v[92:95], v[160:175]
    v_add_f32 v49, v49, v50
    v_cvt_pk_bf16_f32 v208, v192, v193
    v_cvt_pk_bf16_f32 v209, v194, v195
    v_cvt_pk_bf16_f32 v210, v196, v197
    v_cvt_pk_bf16_f32 v211, v198, v199
    v_cvt_pk_bf16_f32 v212, v200, v201
    v_cvt_pk_bf16_f32 v213, v202, v203
    v_cvt_pk_bf16_f32 v214, v204, v205
    v_cvt_pk_bf16_f32 v215, v206, v207
    s_waitcnt lgkmcnt(0)
    v_add_u32 v55, 1, v55
    ds_write_b32 v56, v55
    v_mfma_f32_32x32x16_bf16 v[96:111], a[0:3], v[208:211], v[96:111]
    s_nop 3
    v_fma_f32 v192, v160, s52, v48
    v_fma_f32 v193, v161, s52, v48
    v_fma_f32 v194, v162, s52, v48
    v_fma_f32 v195, v163, s52, v48
    v_exp_f32 v192, v192
    v_mfma_f32_32x32x16_bf16 v[112:127], a[4:7], v[208:211], v[112:127]
    v_fma_f32 v196, v164, s52, v48
    v_exp_f32 v193, v193
    v_fma_f32 v197, v165, s52, v48
    v_exp_f32 v194, v194
    v_fma_f32 v198, v166, s52, v48
    v_mfma_f32_32x32x16_bf16 v[128:143], a[8:11], v[208:211], v[128:143]
    s_cmp_ge_u32 s59, s58
    s_cbranch_scc1 K1_L12_OK
K1_L12:
    ds_read_b32 v58, v18 offset:0
    s_waitcnt lgkmcnt(0)
    v_readfirstlane_b32 s59, v58
    s_cmp_ge_u32 s59, s58
    s_cbranch_scc0 K1_L12
K1_L12_OK:
    s_add_u32 s58, s58, 1
    ds_read_b128 v[216:219], v20 offset:24576
    ds_read_b128 v[220:223], v21 offset:24576
    v_mfma_f32_32x32x16_bf16 v[144:159], a[12:15], v[208:211], v[144:159]
    v_exp_f32 v195, v195
    v_fma_f32 v199, v167, s52, v48
    ds_read_b128 v[224:227], v22 offset:24576
    ds_read_b128 v[228:231], v23 offset:24576
    v_mfma_f32_32x32x16_bf16 v[96:111], a[16:19], v[212:215], v[96:111]
    v_exp_f32 v196, v196
    v_fma_f32 v200, v168, s52, v48
    ds_read_b128 v[232:235], v24 offset:24576
    ds_read_b128 v[236:239], v25 offset:24576
    v_mfma_f32_32x32x16_bf16 v[112:127], a[20:23], v[212:215], v[112:127]
    v_exp_f32 v197, v197
    v_fma_f32 v201, v169, s52, v48
    ds_read_b128 v[240:243], v26 offset:24576
    ds_read_b128 v[244:247], v27 offset:24576
    v_mfma_f32_32x32x16_bf16 v[128:143], a[24:27], v[212:215], v[128:143]
    v_exp_f32 v198, v198
    v_fma_f32 v202, v170, s52, v48
    v_exp_f32 v199, v199
    v_fma_f32 v203, v171, s52, v48
    v_exp_f32 v200, v200
    v_mfma_f32_32x32x16_bf16 v[144:159], a[28:31], v[212:215], v[144:159]
    v_fma_f32 v204, v172, s52, v48
    v_exp_f32 v201, v201
    v_fma_f32 v205, v173, s52, v48
    v_fma_f32 v206, v174, s52, v48
    v_fma_f32 v207, v175, s52, v48
    s_waitcnt lgkmcnt(0)
    v_mfma_f32_32x32x16_bf16 v[176:191], v[216:219], v[64:67], 0
    ds_read_b64_tr_b16 a[0:1], v28 offset:24576
    ds_read_b64_tr_b16 a[2:3], v28 offset:26624
    v_exp_f32 v202, v202
    ds_read_b64_tr_b16 a[4:5], v29 offset:24576
    ds_read_b64_tr_b16 a[6:7], v29 offset:26624
    v_mfma_f32_32x32x16_bf16 v[176:191], v[220:223], v[68:71], v[176:191]
    v_exp_f32 v203, v203
    ds_read_b64_tr_b16 a[8:9], v30 offset:24576
    ds_read_b64_tr_b16 a[10:11], v30 offset:26624
    v_exp_f32 v204, v204
    v_mfma_f32_32x32x16_bf16 v[176:191], v[224:227], v[72:75], v[176:191]
    ds_read_b64_tr_b16 a[12:13], v31 offset:24576
    ds_read_b64_tr_b16 a[14:15], v31 offset:26624
    v_exp_f32 v205, v205
    ds_read_b64_tr_b16 a[16:17], v28 offset:28672
    ds_read_b64_tr_b16 a[18:19], v28 offset:30720
    v_mfma_f32_32x32x16_bf16 v[176:191], v[228:231], v[76:79], v[176:191]
    v_exp_f32 v206, v206
    ds_read_b64_tr_b16 a[20:21], v29 offset:28672
    ds_read_b64_tr_b16 a[22:23], v29 offset:30720
    v_exp_f32 v207, v207
    v_mfma_f32_32x32x16_bf16 v[176:191], v[232:235], v[80:83], v[176:191]
    ds_read_b64_tr_b16 a[24:25], v30 offset:28672
    ds_read_b64_tr_b16 a[26:27], v30 offset:30720
    s_nop 0
    v_add_f32 v50, v192, v193
    v_add_f32 v51, v194, v195
    ds_read_b64_tr_b16 a[28:29], v31 offset:28672
    v_mfma_f32_32x32x16_bf16 v[176:191], v[236:239], v[84:87], v[176:191]
    ds_read_b64_tr_b16 a[30:31], v31 offset:30720
    v_add_f32 v50, v50, v196
    v_add_f32 v51, v51, v197
    v_add_f32 v50, v50, v198
    v_add_f32 v51, v51, v199
    v_add_f32 v50, v50, v200
    v_add_f32 v51, v51, v201
    v_add_f32 v50, v50, v202
    v_mfma_f32_32x32x16_bf16 v[176:191], v[240:243], v[88:91], v[176:191]
    v_add_f32 v51, v51, v203
    v_add_f32 v50, v50, v204
    v_add_f32 v51, v51, v205
    v_add_f32 v50, v50, v206
    v_add_f32 v51, v51, v207
    v_add_f32 v50, v50, v51
    v_cmp_nge_f32 vcc, s53, v50
    s_cbranch_vccnz K1_RARE2
K1_CK2:
    v_mfma_f32_32x32x16_bf16 v[176:191], v[244:247], v[92:95], v[176:191]
    v_add_f32 v49, v49, v50
    v_cvt_pk_bf16_f32 v208, v192, v193
    v_cvt_pk_bf16_f32 v209, v194, v195
    v_cvt_pk_bf16_f32 v210, v196, v197
    v_cvt_pk_bf16_f32 v211, v198, v199
    v_cvt_pk_bf16_f32 v212, v200, v201
    v_cvt_pk_bf16_f32 v213, v202, v203
    v_cvt_pk_bf16_f32 v214, v204, v205
    v_cvt_pk_bf16_f32 v215, v206, v207
    s_waitcnt lgkmcnt(0)
    v_add_u32 v55, 1, v55
    ds_write_b32 v56, v55
    v_mfma_f32_32x32x16_bf16 v[96:111], a[0:3], v[208:211], v[96:111]
    s_nop 3
    v_fma_f32 v192, v176, s52, v48
    v_fma_f32 v193, v177, s52, v48
    v_fma_f32 v194, v178, s52, v48
    v_fma_f32 v195, v179, s52, v48
    v_exp_f32 v192, v192
    v_mfma_f32_32x32x16_bf16 v[112:127], a[4:7], v[208:211], v[112:127]
    v_fma_f32 v196, v180, s52, v48
    v_exp_f32 v193, v193
    v_fma_f32 v197, v181, s52, v48
    v_exp_f32 v194, v194
    v_fma_f32 v198, v182, s52, v48
    v_mfma_f32_32x32x16_bf16 v[128:143], a[8:11], v[208:211], v[128:143]
    s_cmp_ge_u32 s59, s58
    s_cbranch_scc1 K1_L13_OK
K1_L13:
    ds_read_b32 v58, v18 offset:0
    s_waitcnt lgkmcnt(0)
    v_readfirstlane_b32 s59, v58
    s_cmp_ge_u32 s59, s58
    s_cbranch_scc0 K1_L13
K1_L13_OK:
    s_add_u32 s58, s58, 1
    ds_read_b128 v[216:219], v20 offset:32768
    ds_read_b128 v[220:223], v21 offset:32768
    v_mfma_f32_32x32x16_bf16 v[144:159], a[12:15], v[208:211], v[144:159]
    v_exp_f32 v195, v195
    v_fma_f32 v199, v183, s52, v48
    ds_read_b128 v[224:227], v22 offset:32768
    ds_read_b128 v[228:231], v23 offset:32768
    v_mfma_f32_32x32x16_bf16 v[96:111], a[16:19], v[212:215], v[96:111]
    v_exp_f32 v196, v196
    v_fma_f32 v200, v184, s52, v48
    ds_read_b128 v[232:235], v24 offset:32768
    ds_read_b128 v[236:239], v25 offset:32768
    v_mfma_f32_32x32x16_bf16 v[112:127], a[20:23], v[212:215], v[112:127]
    v_exp_f32 v197, v197
    v_fma_f32 v201, v185, s52, v48
    ds_read_b128 v[240:243], v26 offset:32768
    ds_read_b128 v[244:247], v27 offset:32768
    v_mfma_f32_32x32x16_bf16 v[128:143], a[24:27], v[212:215], v[128:143]
    v_exp_f32 v198, v198
    v_fma_f32 v202, v186, s52, v48
    v_exp_f32 v199, v199
    v_fma_f32 v203, v187, s52, v48
    v_exp_f32 v200, v200
    v_mfma_f32_32x32x16_bf16 v[144:159], a[28:31], v[212:215], v[144:159]
    v_fma_f32 v204, v188, s52, v48
    v_exp_f32 v201, v201
    v_fma_f32 v205, v189, s52, v48
    v_fma_f32 v206, v190, s52, v48
    v_fma_f32 v207, v191, s52, v48
    s_waitcnt lgkmcnt(0)
    v_mfma_f32_32x32x16_bf16 v[160:175], v[216:219], v[64:67], 0
    ds_read_b64_tr_b16 a[0:1], v28 offset:32768
    ds_read_b64_tr_b16 a[2:3], v28 offset:34816
    v_exp_f32 v202, v202
    ds_read_b64_tr_b16 a[4:5], v29 offset:32768
    ds_read_b64_tr_b16 a[6:7], v29 offset:34816
    v_mfma_f32_32x32x16_bf16 v[160:175], v[220:223], v[68:71], v[160:175]
    v_exp_f32 v203, v203
    ds_read_b64_tr_b16 a[8:9], v30 offset:32768
    ds_read_b64_tr_b16 a[10:11], v30 offset:34816
    v_exp_f32 v204, v204
    v_mfma_f32_32x32x16_bf16 v[160:175], v[224:227], v[72:75], v[160:175]
    ds_read_b64_tr_b16 a[12:13], v31 offset:32768
    ds_read_b64_tr_b16 a[14:15], v31 offset:34816
    v_exp_f32 v205, v205
    ds_read_b64_tr_b16 a[16:17], v28 offset:36864
    ds_read_b64_tr_b16 a[18:19], v28 offset:38912
    v_mfma_f32_32x32x16_bf16 v[160:175], v[228:231], v[76:79], v[160:175]
    v_exp_f32 v206, v206
    ds_read_b64_tr_b16 a[20:21], v29 offset:36864
    ds_read_b64_tr_b16 a[22:23], v29 offset:38912
    v_exp_f32 v207, v207
    v_mfma_f32_32x32x16_bf16 v[160:175], v[232:235], v[80:83], v[160:175]
    ds_read_b64_tr_b16 a[24:25], v30 offset:36864
    ds_read_b64_tr_b16 a[26:27], v30 offset:38912
    s_nop 0
    v_add_f32 v50, v192, v193
    v_add_f32 v51, v194, v195
    ds_read_b64_tr_b16 a[28:29], v31 offset:36864
    v_mfma_f32_32x32x16_bf16 v[160:175], v[236:239], v[84:87], v[160:175]
    ds_read_b64_tr_b16 a[30:31], v31 offset:38912
    v_add_f32 v50, v50, v196
    v_add_f32 v51, v51, v197
    v_add_f32 v50, v50, v198
    v_add_f32 v51, v51, v199
    v_add_f32 v50, v50, v200
    v_add_f32 v51, v51, v201
    v_add_f32 v50, v50, v202
    v_mfma_f32_32x32x16_bf16 v[160:175], v[240:243], v[88:91], v[160:175]
    v_add_f32 v51, v51, v203
    v_add_f32 v50, v50, v204
    v_add_f32 v51, v51, v205
    v_add_f32 v50, v50, v206
    v_add_f32 v51, v51, v207
    v_add_f32 v50, v50, v51
    v_cmp_nge_f32 vcc, s53, v50
    s_cbranch_vccnz K1_RARE3
K1_CK3:
    v_mfma_f32_32x32x16_bf16 v[160:175], v[244:247], v[92:95], v[160:175]
    v_add_f32 v49, v49, v50
    v_cvt_pk_bf16_f32 v208, v192, v193
    v_cvt_pk_bf16_f32 v209, v194, v195
    v_cvt_pk_bf16_f32 v210, v196, v197
    v_cvt_pk_bf16_f32 v211, v198, v199
    v_cvt_pk_bf16_f32 v212, v200, v201
    v_cvt_pk_bf16_f32 v213, v202, v203
    v_cvt_pk_bf16_f32 v214, v204, v205
    v_cvt_pk_bf16_f32 v215, v206, v207
    s_waitcnt lgkmcnt(0)
    v_add_u32 v55, 1, v55
    ds_write_b32 v56, v55
    v_mfma_f32_32x32x16_bf16 v[96:111], a[0:3], v[208:211], v[96:111]
    s_nop 3
    v_fma_f32 v192, v160, s52, v48
    v_fma_f32 v193, v161, s52, v48
    v_fma_f32 v194, v162, s52, v48
    v_fma_f32 v195, v163, s52, v48
    v_exp_f32 v192, v192
    v_mfma_f32_32x32x16_bf16 v[112:127], a[4:7], v[208:211], v[112:127]
    v_fma_f32 v196, v164, s52, v48
    v_exp_f32 v193, v193
    v_fma_f32 v197, v165, s52, v48
    v_exp_f32 v194, v194
    v_fma_f32 v198, v166, s52, v48
    v_mfma_f32_32x32x16_bf16 v[128:143], a[8:11], v[208:211], v[128:143]
    s_cmp_ge_u32 s59, s58
    s_cbranch_scc1 K1_L14_OK
K1_L14:
    ds_read_b32 v58, v18 offset:0
    s_waitcnt lgkmcnt(0)
    v_readfirstlane_b32 s59, v58
    s_cmp_ge_u32 s59, s58
    s_cbranch_scc0 K1_L14
K1_L14_OK:
    s_add_u32 s58, s58, 1
    ds_read_b128 v[216:219], v20 offset:40960
    ds_read_b128 v[220:223], v21 offset:40960
    v_mfma_f32_32x32x16_bf16 v[144:159], a[12:15], v[208:211], v[144:159]
    v_exp_f32 v195, v195
    v_fma_f32 v199, v167, s52, v48
    ds_read_b128 v[224:227], v22 offset:40960
    ds_read_b128 v[228:231], v23 offset:40960
    v_mfma_f32_32x32x16_bf16 v[96:111], a[16:19], v[212:215], v[96:111]
    v_exp_f32 v196, v196
    v_fma_f32 v200, v168, s52, v48
    ds_read_b128 v[232:235], v24 offset:40960
    ds_read_b128 v[236:239], v25 offset:40960
    v_mfma_f32_32x32x16_bf16 v[112:127], a[20:23], v[212:215], v[112:127]
    v_exp_f32 v197, v197
    v_fma_f32 v201, v169, s52, v48
    ds_read_b128 v[240:243], v26 offset:40960
    ds_read_b128 v[244:247], v27 offset:40960
    v_mfma_f32_32x32x16_bf16 v[128:143], a[24:27], v[212:215], v[128:143]
    v_exp_f32 v198, v198
    v_fma_f32 v202, v170, s52, v48
    v_exp_f32 v199, v199
    v_fma_f32 v203, v171, s52, v48
    v_exp_f32 v200, v200
    v_mfma_f32_32x32x16_bf16 v[144:159], a[28:31], v[212:215], v[144:159]
    v_fma_f32 v204, v172, s52, v48
    v_exp_f32 v201, v201
    v_fma_f32 v205, v173, s52, v48
    v_fma_f32 v206, v174, s52, v48
    v_fma_f32 v207, v175, s52, v48
    s_waitcnt lgkmcnt(0)
    v_mfma_f32_32x32x16_bf16 v[176:191], v[216:219], v[64:67], 0
    ds_read_b64_tr_b16 a[0:1], v28 offset:40960
    ds_read_b64_tr_b16 a[2:3], v28 offset:43008
    v_exp_f32 v202, v202
    ds_read_b64_tr_b16 a[4:5], v29 offset:40960
    ds_read_b64_tr_b16 a[6:7], v29 offset:43008
    v_mfma_f32_32x32x16_bf16 v[176:191], v[220:223], v[68:71], v[176:191]
    v_exp_f32 v203, v203
    ds_read_b64_tr_b16 a[8:9], v30 offset:40960
    ds_read_b64_tr_b16 a[10:11], v30 offset:43008
    v_exp_f32 v204, v204
    v_mfma_f32_32x32x16_bf16 v[176:191], v[224:227], v[72:75], v[176:191]
    ds_read_b64_tr_b16 a[12:13], v31 offset:40960
    ds_read_b64_tr_b16 a[14:15], v31 offset:43008
    v_exp_f32 v205, v205
    ds_read_b64_tr_b16 a[16:17], v28 offset:45056
    ds_read_b64_tr_b16 a[18:19], v28 offset:47104
    v_mfma_f32_32x32x16_bf16 v[176:191], v[228:231], v[76:79], v[176:191]
    v_exp_f32 v206, v206
    ds_read_b64_tr_b16 a[20:21], v29 offset:45056
    ds_read_b64_tr_b16 a[22:23], v29 offset:47104
    v_exp_f32 v207, v207
    v_mfma_f32_32x32x16_bf16 v[176:191], v[232:235], v[80:83], v[176:191]
    ds_read_b64_tr_b16 a[24:25], v30 offset:45056
    ds_read_b64_tr_b16 a[26:27], v30 offset:47104
    s_nop 0
    v_add_f32 v50, v192, v193
    v_add_f32 v51, v194, v195
    ds_read_b64_tr_b16 a[28:29], v31 offset:45056
    v_mfma_f32_32x32x16_bf16 v[176:191], v[236:239], v[84:87], v[176:191]
    ds_read_b64_tr_b16 a[30:31], v31 offset:47104
    v_add_f32 v50, v50, v196
    v_add_f32 v51, v51, v197
    v_add_f32 v50, v50, v198
    v_add_f32 v51, v51, v199
    v_add_f32 v50, v50, v200
    v_add_f32 v51, v51, v201
    v_add_f32 v50, v50, v202
    v_mfma_f32_32x32x16_bf16 v[176:191], v[240:243], v[88:91], v[176:191]
    v_add_f32 v51, v51, v203
    v_add_f32 v50, v50, v204
    v_add_f32 v51, v51, v205
    v_add_f32 v50, v50, v206
    v_add_f32 v51, v51, v207
    v_add_f32 v50, v50, v51
    v_cmp_nge_f32 vcc, s53, v50
    s_cbranch_vccnz K1_RARE4
K1_CK4:
    v_mfma_f32_32x32x16_bf16 v[176:191], v[244:247], v[92:95], v[176:191]
    v_add_f32 v49, v49, v50
    v_cvt_pk_bf16_f32 v208, v192, v193
    v_cvt_pk_bf16_f32 v209, v194, v195
    v_cvt_pk_bf16_f32 v210, v196, v197
    v_cvt_pk_bf16_f32 v211, v198, v199
    v_cvt_pk_bf16_f32 v212, v200, v201
    v_cvt_pk_bf16_f32 v213, v202, v203
    v_cvt_pk_bf16_f32 v214, v204, v205
    v_cvt_pk_bf16_f32 v215, v206, v207
    s_waitcnt lgkmcnt(0)
    v_add_u32 v55, 1, v55
    ds_write_b32 v56, v55
    v_mfma_f32_32x32x16_bf16 v[96:111], a[0:3], v[208:211], v[96:111]
    s_nop 3
    v_fma_f32 v192, v176, s52, v48
    v_fma_f32 v193, v177, s52, v48
    v_fma_f32 v194, v178, s52, v48
    v_fma_f32 v195, v179, s52, v48
    v_exp_f32 v192, v192
    v_mfma_f32_32x32x16_bf16 v[112:127], a[4:7], v[208:211], v[112:127]
    v_fma_f32 v196, v180, s52, v48
    v_exp_f32 v193, v193
    v_fma_f32 v197, v181, s52, v48
    v_exp_f32 v194, v194
    v_fma_f32 v198, v182, s52, v48
    v_mfma_f32_32x32x16_bf16 v[128:143], a[8:11], v[208:211], v[128:143]
    s_cmp_ge_u32 s59, s58
    s_cbranch_scc1 K1_L15_OK
K1_L15:
    ds_read_b32 v58, v18 offset:0
    s_waitcnt lgkmcnt(0)
    v_readfirstlane_b32 s59, v58
    s_cmp_ge_u32 s59, s58
    s_cbranch_scc0 K1_L15
K1_L15_OK:
    s_add_u32 s58, s58, 1
    ds_read_b128 v[216:219], v20 offset:49152
    ds_read_b128 v[220:223], v21 offset:49152
    v_mfma_f32_32x32x16_bf16 v[144:159], a[12:15], v[208:211], v[144:159]
    v_exp_f32 v195, v195
    v_fma_f32 v199, v183, s52, v48
    ds_read_b128 v[224:227], v22 offset:49152
    ds_read_b128 v[228:231], v23 offset:49152
    v_mfma_f32_32x32x16_bf16 v[96:111], a[16:19], v[212:215], v[96:111]
    v_exp_f32 v196, v196
    v_fma_f32 v200, v184, s52, v48
    ds_read_b128 v[232:235], v24 offset:49152
    ds_read_b128 v[236:239], v25 offset:49152
    v_mfma_f32_32x32x16_bf16 v[112:127], a[20:23], v[212:215], v[112:127]
    v_exp_f32 v197, v197
    v_fma_f32 v201, v185, s52, v48
    ds_read_b128 v[240:243], v26 offset:49152
    ds_read_b128 v[244:247], v27 offset:49152
    v_mfma_f32_32x32x16_bf16 v[128:143], a[24:27], v[212:215], v[128:143]
    v_exp_f32 v198, v198
    v_fma_f32 v202, v186, s52, v48
    v_exp_f32 v199, v199
    v_fma_f32 v203, v187, s52, v48
    v_exp_f32 v200, v200
    v_mfma_f32_32x32x16_bf16 v[144:159], a[28:31], v[212:215], v[144:159]
    v_fma_f32 v204, v188, s52, v48
    v_exp_f32 v201, v201
    v_fma_f32 v205, v189, s52, v48
    v_fma_f32 v206, v190, s52, v48
    v_fma_f32 v207, v191, s52, v48
    s_waitcnt lgkmcnt(0)
    v_mfma_f32_32x32x16_bf16 v[160:175], v[216:219], v[64:67], 0
    ds_read_b64_tr_b16 a[0:1], v28 offset:49152
    ds_read_b64_tr_b16 a[2:3], v28 offset:51200
    v_exp_f32 v202, v202
    ds_read_b64_tr_b16 a[4:5], v29 offset:49152
    ds_read_b64_tr_b16 a[6:7], v29 offset:51200
    v_mfma_f32_32x32x16_bf16 v[160:175], v[220:223], v[68:71], v[160:175]
    v_exp_f32 v203, v203
    ds_read_b64_tr_b16 a[8:9], v30 offset:49152
    ds_read_b64_tr_b16 a[10:11], v30 offset:51200
    v_exp_f32 v204, v204
    v_mfma_f32_32x32x16_bf16 v[160:175], v[224:227], v[72:75], v[160:175]
    ds_read_b64_tr_b16 a[12:13], v31 offset:49152
    ds_read_b64_tr_b16 a[14:15], v31 offset:51200
    v_exp_f32 v205, v205
    ds_read_b64_tr_b16 a[16:17], v28 offset:53248
    ds_read_b64_tr_b16 a[18:19], v28 offset:55296
    v_mfma_f32_32x32x16_bf16 v[160:175], v[228:231], v[76:79], v[160:175]
    v_exp_f32 v206, v206
    ds_read_b64_tr_b16 a[20:21], v29 offset:53248
    ds_read_b64_tr_b16 a[22:23], v29 offset:55296
    v_exp_f32 v207, v207
    v_mfma_f32_32x32x16_bf16 v[160:175], v[232:235], v[80:83], v[160:175]
    ds_read_b64_tr_b16 a[24:25], v30 offset:53248
    ds_read_b64_tr_b16 a[26:27], v30 offset:55296
    s_nop 0
    v_add_f32 v50, v192, v193
    v_add_f32 v51, v194, v195
    ds_read_b64_tr_b16 a[28:29], v31 offset:53248
    v_mfma_f32_32x32x16_bf16 v[160:175], v[236:239], v[84:87], v[160:175]
    ds_read_b64_tr_b16 a[30:31], v31 offset:55296
    v_add_f32 v50, v50, v196
    v_add_f32 v51, v51, v197
    v_add_f32 v50, v50, v198
    v_add_f32 v51, v51, v199
    v_add_f32 v50, v50, v200
    v_add_f32 v51, v51, v201
    v_add_f32 v50, v50, v202
    v_mfma_f32_32x32x16_bf16 v[160:175], v[240:243], v[88:91], v[160:175]
    v_add_f32 v51, v51, v203
    v_add_f32 v50, v50, v204
    v_add_f32 v51, v51, v205
    v_add_f32 v50, v50, v206
    v_add_f32 v51, v51, v207
    v_add_f32 v50, v50, v51
    v_cmp_nge_f32 vcc, s53, v50
    s_cbranch_vccnz K1_RARE5
K1_CK5:
    v_mfma_f32_32x32x16_bf16 v[160:175], v[244:247], v[92:95], v[160:175]
    v_add_f32 v49, v49, v50
    v_cvt_pk_bf16_f32 v208, v192, v193
    v_cvt_pk_bf16_f32 v209, v194, v195
    v_cvt_pk_bf16_f32 v210, v196, v197
    v_cvt_pk_bf16_f32 v211, v198, v199
    v_cvt_pk_bf16_f32 v212, v200, v201
    v_cvt_pk_bf16_f32 v213, v202, v203
    v_cvt_pk_bf16_f32 v214, v204, v205
    v_cvt_pk_bf16_f32 v215, v206, v207
    s_waitcnt lgkmcnt(0)
    v_add_u32 v55, 1, v55
    ds_write_b32 v56, v55
    v_mfma_f32_32x32x16_bf16 v[96:111], a[0:3], v[208:211], v[96:111]
    s_nop 3
    v_fma_f32 v192, v160, s52, v48
    v_fma_f32 v193, v161, s52, v48
    v_fma_f32 v194, v162, s52, v48
    v_fma_f32 v195, v163, s52, v48
    v_exp_f32 v192, v192
    v_mfma_f32_32x32x16_bf16 v[112:127], a[4:7], v[208:211], v[112:127]
    v_fma_f32 v196, v164, s52, v48
    v_exp_f32 v193, v193
    v_fma_f32 v197, v165, s52, v48
    v_exp_f32 v194, v194
    v_fma_f32 v198, v166, s52, v48
    v_mfma_f32_32x32x16_bf16 v[128:143], a[8:11], v[208:211], v[128:143]
    s_cmp_ge_u32 s59, s58
    s_cbranch_scc1 K1_L16_OK
K1_L16:
    ds_read_b32 v58, v18 offset:0
    s_waitcnt lgkmcnt(0)
    v_readfirstlane_b32 s59, v58
    s_cmp_ge_u32 s59, s58
    s_cbranch_scc0 K1_L16
K1_L16_OK:
    s_add_u32 s58, s58, 1
    ds_read_b128 v[216:219], v20 offset:57344
    ds_read_b128 v[220:223], v21 offset:57344
    v_mfma_f32_32x32x16_bf16 v[144:159], a[12:15], v[208:211], v[144:159]
    v_exp_f32 v195, v195
    v_fma_f32 v199, v167, s52, v48
    ds_read_b128 v[224:227], v22 offset:57344
    ds_read_b128 v[228:231], v23 offset:57344
    v_mfma_f32_32x32x16_bf16 v[96:111], a[16:19], v[212:215], v[96:111]
    v_exp_f32 v196, v196
    v_fma_f32 v200, v168, s52, v48
    ds_read_b128 v[232:235], v24 offset:57344
    ds_read_b128 v[236:239], v25 offset:57344
    v_mfma_f32_32x32x16_bf16 v[112:127], a[20:23], v[212:215], v[112:127]
    v_exp_f32 v197, v197
    v_fma_f32 v201, v169, s52, v48
    ds_read_b128 v[240:243], v26 offset:57344
    ds_read_b128 v[244:247], v27 offset:57344
    v_mfma_f32_32x32x16_bf16 v[128:143], a[24:27], v[212:215], v[128:143]
    v_exp_f32 v198, v198
    v_fma_f32 v202, v170, s52, v48
    v_exp_f32 v199, v199
    v_fma_f32 v203, v171, s52, v48
    v_exp_f32 v200, v200
    v_mfma_f32_32x32x16_bf16 v[144:159], a[28:31], v[212:215], v[144:159]
    v_fma_f32 v204, v172, s52, v48
    v_exp_f32 v201, v201
    v_fma_f32 v205, v173, s52, v48
    v_fma_f32 v206, v174, s52, v48
    v_fma_f32 v207, v175, s52, v48
    s_waitcnt lgkmcnt(0)
    v_mfma_f32_32x32x16_bf16 v[176:191], v[216:219], v[64:67], 0
    ds_read_b64_tr_b16 a[0:1], v28 offset:57344
    ds_read_b64_tr_b16 a[2:3], v28 offset:59392
    v_exp_f32 v202, v202
    ds_read_b64_tr_b16 a[4:5], v29 offset:57344
    ds_read_b64_tr_b16 a[6:7], v29 offset:59392
    v_mfma_f32_32x32x16_bf16 v[176:191], v[220:223], v[68:71], v[176:191]
    v_exp_f32 v203, v203
    ds_read_b64_tr_b16 a[8:9], v30 offset:57344
    ds_read_b64_tr_b16 a[10:11], v30 offset:59392
    v_exp_f32 v204, v204
    v_mfma_f32_32x32x16_bf16 v[176:191], v[224:227], v[72:75], v[176:191]
    ds_read_b64_tr_b16 a[12:13], v31 offset:57344
    ds_read_b64_tr_b16 a[14:15], v31 offset:59392
    v_exp_f32 v205, v205
    ds_read_b64_tr_b16 a[16:17], v28 offset:61440
    ds_read_b64_tr_b16 a[18:19], v28 offset:63488
    v_mfma_f32_32x32x16_bf16 v[176:191], v[228:231], v[76:79], v[176:191]
    v_exp_f32 v206, v206
    ds_read_b64_tr_b16 a[20:21], v29 offset:61440
    ds_read_b64_tr_b16 a[22:23], v29 offset:63488
    v_exp_f32 v207, v207
    v_mfma_f32_32x32x16_bf16 v[176:191], v[232:235], v[80:83], v[176:191]
    ds_read_b64_tr_b16 a[24:25], v30 offset:61440
    ds_read_b64_tr_b16 a[26:27], v30 offset:63488
    s_nop 0
    v_add_f32 v50, v192, v193
    v_add_f32 v51, v194, v195
    ds_read_b64_tr_b16 a[28:29], v31 offset:61440
    v_mfma_f32_32x32x16_bf16 v[176:191], v[236:239], v[84:87], v[176:191]
    ds_read_b64_tr_b16 a[30:31], v31 offset:63488
    v_add_f32 v50, v50, v196
    v_add_f32 v51, v51, v197
    v_add_f32 v50, v50, v198
    v_add_f32 v51, v51, v199
    v_add_f32 v50, v50, v200
    v_add_f32 v51, v51, v201
    v_add_f32 v50, v50, v202
    v_mfma_f32_32x32x16_bf16 v[176:191], v[240:243], v[88:91], v[176:191]
    v_add_f32 v51, v51, v203
    v_add_f32 v50, v50, v204
    v_add_f32 v51, v51, v205
    v_add_f32 v50, v50, v206
    v_add_f32 v51, v51, v207
    v_add_f32 v50, v50, v51
    v_cmp_nge_f32 vcc, s53, v50
    s_cbranch_vccnz K1_RARE6
K1_CK6:
    v_mfma_f32_32x32x16_bf16 v[176:191], v[244:247], v[92:95], v[176:191]
    v_add_f32 v49, v49, v50
    v_cvt_pk_bf16_f32 v208, v192, v193
    v_cvt_pk_bf16_f32 v209, v194, v195
    v_cvt_pk_bf16_f32 v210, v196, v197
    v_cvt_pk_bf16_f32 v211, v198, v199
    v_cvt_pk_bf16_f32 v212, v200, v201
    v_cvt_pk_bf16_f32 v213, v202, v203
    v_cvt_pk_bf16_f32 v214, v204, v205
    v_cvt_pk_bf16_f32 v215, v206, v207
    s_waitcnt lgkmcnt(0)
    v_add_u32 v55, 1, v55
    ds_write_b32 v56, v55
    v_mfma_f32_32x32x16_bf16 v[96:111], a[0:3], v[208:211], v[96:111]
    s_nop 3
    v_fma_f32 v192, v176, s52, v48
    v_fma_f32 v193, v177, s52, v48
    v_fma_f32 v194, v178, s52, v48
    v_fma_f32 v195, v179, s52, v48
    v_exp_f32 v192, v192
    v_mfma_f32_32x32x16_bf16 v[112:127], a[4:7], v[208:211], v[112:127]
    v_fma_f32 v196, v180, s52, v48
    v_exp_f32 v193, v193
    v_fma_f32 v197, v181, s52, v48
    v_exp_f32 v194, v194
    v_fma_f32 v198, v182, s52, v48
    v_mfma_f32_32x32x16_bf16 v[128:143], a[8:11], v[208:211], v[128:143]
    s_cmp_ge_u32 s59, s58
    s_cbranch_scc1 K1_L17_OK
K1_L17:
    ds_read_b32 v58, v18 offset:0
    s_waitcnt lgkmcnt(0)
    v_readfirstlane_b32 s59, v58
    s_cmp_ge_u32 s59, s58
    s_cbranch_scc0 K1_L17
K1_L17_OK:
    s_add_u32 s58, s58, 1
    ds_read_b128 v[216:219], v20 offset:0
    ds_read_b128 v[220:223], v21 offset:0
    v_mfma_f32_32x32x16_bf16 v[144:159], a[12:15], v[208:211], v[144:159]
    v_exp_f32 v195, v195
    v_fma_f32 v199, v183, s52, v48
    ds_read_b128 v[224:227], v22 offset:0
    ds_read_b128 v[228:231], v23 offset:0
    v_mfma_f32_32x32x16_bf16 v[96:111], a[16:19], v[212:215], v[96:111]
    v_exp_f32 v196, v196
    v_fma_f32 v200, v184, s52, v48
    ds_read_b128 v[232:235], v24 offset:0
    ds_read_b128 v[236:239], v25 offset:0
    v_mfma_f32_32x32x16_bf16 v[112:127], a[20:23], v[212:215], v[112:127]
    v_exp_f32 v197, v197
    v_fma_f32 v201, v185, s52, v48
    ds_read_b128 v[240:243], v26 offset:0
    ds_read_b128 v[244:247], v27 offset:0
    v_mfma_f32_32x32x16_bf16 v[128:143], a[24:27], v[212:215], v[128:143]
    v_exp_f32 v198, v198
    v_fma_f32 v202, v186, s52, v48
    v_exp_f32 v199, v199
    v_fma_f32 v203, v187, s52, v48
    v_exp_f32 v200, v200
    v_mfma_f32_32x32x16_bf16 v[144:159], a[28:31], v[212:215], v[144:159]
    v_fma_f32 v204, v188, s52, v48
    v_exp_f32 v201, v201
    v_fma_f32 v205, v189, s52, v48
    v_fma_f32 v206, v190, s52, v48
    v_fma_f32 v207, v191, s52, v48
    s_cmp_eq_u32 s58, 34
    s_cbranch_scc1 K1_LAST
    s_waitcnt lgkmcnt(0)
    v_mfma_f32_32x32x16_bf16 v[160:175], v[216:219], v[64:67], 0
    ds_read_b64_tr_b16 a[0:1], v28 offset:0
    ds_read_b64_tr_b16 a[2:3], v28 offset:2048
    v_exp_f32 v202, v202
    ds_read_b64_tr_b16 a[4:5], v29 offset:0
    ds_read_b64_tr_b16 a[6:7], v29 offset:2048
    v_mfma_f32_32x32x16_bf16 v[160:175], v[220:223], v[68:71], v[160:175]
    v_exp_f32 v203, v203
    ds_read_b64_tr_b16 a[8:9], v30 offset:0
    ds_read_b64_tr_b16 a[10:11], v30 offset:2048
    v_exp_f32 v204, v204
    v_mfma_f32_32x32x16_bf16 v[160:175], v[224:227], v[72:75], v[160:175]
    ds_read_b64_tr_b16 a[12:13], v31 offset:0
    ds_read_b64_tr_b16 a[14:15], v31 offset:2048
    v_exp_f32 v205, v205
    ds_read_b64_tr_b16 a[16:17], v28 offset:4096
    ds_read_b64_tr_b16 a[18:19], v28 offset:6144
    v_mfma_f32_32x32x16_bf16 v[160:175], v[228:231], v[76:79], v[160:175]
    v_exp_f32 v206, v206
    ds_read_b64_tr_b16 a[20:21], v29 offset:4096
    ds_read_b64_tr_b16 a[22:23], v29 offset:6144
    v_exp_f32 v207, v207
    v_mfma_f32_32x32x16_bf16 v[160:175], v[232:235], v[80:83], v[160:175]
    ds_read_b64_tr_b16 a[24:25], v30 offset:4096
    ds_read_b64_tr_b16 a[26:27], v30 offset:6144
    s_nop 0
    v_add_f32 v50, v192, v193
    v_add_f32 v51, v194, v195
    ds_read_b64_tr_b16 a[28:29], v31 offset:4096
    v_mfma_f32_32x32x16_bf16 v[160:175], v[236:239], v[84:87], v[160:175]
    ds_read_b64_tr_b16 a[30:31], v31 offset:6144
    v_add_f32 v50, v50, v196
    v_add_f32 v51, v51, v197
    v_add_f32 v50, v50, v198
    v_add_f32 v51, v51, v199
    v_add_f32 v50, v50, v200
    v_add_f32 v51, v51, v201
    v_add_f32 v50, v50, v202
    v_mfma_f32_32x32x16_bf16 v[160:175], v[240:243], v[88:91], v[160:175]
    v_add_f32 v51, v51, v203
    v_add_f32 v50, v50, v204
    v_add_f32 v51, v51, v205
    v_add_f32 v50, v50, v206
    v_add_f32 v51, v51, v207
    v_add_f32 v50, v50, v51
    v_cmp_nge_f32 vcc, s53, v50
    s_cbranch_vccnz K1_RARE7
K1_CK7:
    v_mfma_f32_32x32x16_bf16 v[160:175], v[244:247], v[92:95], v[160:175]
    v_add_f32 v49, v49, v50
    v_cvt_pk_bf16_f32 v208, v192, v193
    v_cvt_pk_bf16_f32 v209, v194, v195
    v_cvt_pk_bf16_f32 v210, v196, v197
    v_cvt_pk_bf16_f32 v211, v198, v199
    v_cvt_pk_bf16_f32 v212, v200, v201
    v_cvt_pk_bf16_f32 v213, v202, v203
    v_cvt_pk_bf16_f32 v214, v204, v205
    v_cvt_pk_bf16_f32 v215, v206, v207
    s_waitcnt lgkmcnt(0)
    v_add_u32 v55, 1, v55
    ds_write_b32 v56, v55
    v_mfma_f32_32x32x16_bf16 v[96:111], a[0:3], v[208:211], v[96:111]
    s_nop 3
    v_fma_f32 v192, v160, s52, v48
    v_fma_f32 v193, v161, s52, v48
    v_fma_f32 v194, v162, s52, v48
    v_fma_f32 v195, v163, s52, v48
    v_exp_f32 v192, v192
    v_mfma_f32_32x32x16_bf16 v[112:127], a[4:7], v[208:211], v[112:127]
    v_fma_f32 v196, v164, s52, v48
    v_exp_f32 v193, v193
    v_fma_f32 v197, v165, s52, v48
    v_exp_f32 v194, v194
    v_fma_f32 v198, v166, s52, v48
    v_mfma_f32_32x32x16_bf16 v[128:143], a[8:11], v[208:211], v[128:143]
    s_cmp_ge_u32 s59, s58
    s_cbranch_scc1 K1_L18_OK
K1_L18:
    ds_read_b32 v58, v18 offset:0
    s_waitcnt lgkmcnt(0)
    v_readfirstlane_b32 s59, v58
    s_cmp_ge_u32 s59, s58
    s_cbranch_scc0 K1_L18
K1_L18_OK:
    s_add_u32 s58, s58, 1
    ds_read_b128 v[216:219], v20 offset:8192
    ds_read_b128 v[220:223], v21 offset:8192
    v_mfma_f32_32x32x16_bf16 v[144:159], a[12:15], v[208:211], v[144:159]
    v_exp_f32 v195, v195
    v_fma_f32 v199, v167, s52, v48
    ds_read_b128 v[224:227], v22 offset:8192
    ds_read_b128 v[228:231], v23 offset:8192
    v_mfma_f32_32x32x16_bf16 v[96:111], a[16:19], v[212:215], v[96:111]
    v_exp_f32 v196, v196
    v_fma_f32 v200, v168, s52, v48
    ds_read_b128 v[232:235], v24 offset:8192
    ds_read_b128 v[236:239], v25 offset:8192
    v_mfma_f32_32x32x16_bf16 v[112:127], a[20:23], v[212:215], v[112:127]
    v_exp_f32 v197, v197
    v_fma_f32 v201, v169, s52, v48
    ds_read_b128 v[240:243], v26 offset:8192
    ds_read_b128 v[244:247], v27 offset:8192
    v_mfma_f32_32x32x16_bf16 v[128:143], a[24:27], v[212:215], v[128:143]
    v_exp_f32 v198, v198
    v_fma_f32 v202, v170, s52, v48
    v_exp_f32 v199, v199
    v_fma_f32 v203, v171, s52, v48
    v_exp_f32 v200, v200
    v_mfma_f32_32x32x16_bf16 v[144:159], a[28:31], v[212:215], v[144:159]
    v_fma_f32 v204, v172, s52, v48
    v_exp_f32 v201, v201
    v_fma_f32 v205, v173, s52, v48
    v_fma_f32 v206, v174, s52, v48
    v_fma_f32 v207, v175, s52, v48
    s_branch K1_LOOP
K1_LAST:
    s_waitcnt lgkmcnt(0)
    ds_read_b64_tr_b16 a[0:1], v28 offset:0
    ds_read_b64_tr_b16 a[2:3], v28 offset:2048
    v_exp_f32 v202, v202
    ds_read_b64_tr_b16 a[4:5], v29 offset:0
    ds_read_b64_tr_b16 a[6:7], v29 offset:2048
    v_exp_f32 v203, v203
    ds_read_b64_tr_b16 a[8:9], v30 offset:0
    ds_read_b64_tr_b16 a[10:11], v30 offset:2048
    v_exp_f32 v204, v204
    ds_read_b64_tr_b16 a[12:13], v31 offset:0
    ds_read_b64_tr_b16 a[14:15], v31 offset:2048
    v_exp_f32 v205, v205
    ds_read_b64_tr_b16 a[16:17], v28 offset:4096
    ds_read_b64_tr_b16 a[18:19], v28 offset:6144
    v_exp_f32 v206, v206
    ds_read_b64_tr_b16 a[20:21], v29 offset:4096
    ds_read_b64_tr_b16 a[22:23], v29 offset:6144
    v_exp_f32 v207, v207
    ds_read_b64_tr_b16 a[24:25], v30 offset:4096
    ds_read_b64_tr_b16 a[26:27], v30 offset:6144
    s_nop 0
    v_add_f32 v50, v192, v193
    v_add_f32 v51, v194, v195
    ds_read_b64_tr_b16 a[28:29], v31 offset:4096
    ds_read_b64_tr_b16 a[30:31], v31 offset:6144
    v_add_f32 v50, v50, v196
    v_add_f32 v51, v51, v197
    v_add_f32 v50, v50, v198
    v_add_f32 v51, v51, v199
    v_add_f32 v50, v50, v200
    v_add_f32 v51, v51, v201
    v_add_f32 v50, v50, v202
    v_add_f32 v51, v51, v203
    v_add_f32 v50, v50, v204
    v_add_f32 v51, v51, v205
    v_add_f32 v50, v50, v206
    v_add_f32 v51, v51, v207
    v_add_f32 v50, v50, v51
    v_cmp_nge_f32 vcc, s53, v50
    s_cbranch_vccnz K1_RARE8
K1_CK8:
    v_add_f32 v49, v49, v50
    v_cvt_pk_bf16_f32 v208, v192, v193
    v_cvt_pk_bf16_f32 v209, v194, v195
    v_cvt_pk_bf16_f32 v210, v196, v197
    v_cvt_pk_bf16_f32 v211, v198, v199
    v_cvt_pk_bf16_f32 v212, v200, v201
    v_cvt_pk_bf16_f32 v213, v202, v203
    v_cvt_pk_bf16_f32 v214, v204, v205
    v_cvt_pk_bf16_f32 v215, v206, v207
    s_waitcnt lgkmcnt(0)
    s_nop 0
    s_nop 0
    v_mfma_f32_32x32x16_bf16 v[96:111], a[0:3], v[208:211], v[96:111]
    v_mfma_f32_32x32x16_bf16 v[112:127], a[4:7], v[208:211], v[112:127]
    v_mfma_f32_32x32x16_bf16 v[128:143], a[8:11], v[208:211], v[128:143]
    v_mfma_f32_32x32x16_bf16 v[144:159], a[12:15], v[208:211], v[144:159]
    v_mfma_f32_32x32x16_bf16 v[96:111], a[16:19], v[212:215], v[96:111]
    v_mfma_f32_32x32x16_bf16 v[112:127], a[20:23], v[212:215], v[112:127]
    v_mfma_f32_32x32x16_bf16 v[128:143], a[24:27], v[212:215], v[128:143]
    v_mfma_f32_32x32x16_bf16 v[144:159], a[28:31], v[212:215], v[144:159]
    v_mov_b32 v51, v49
    s_nop 1
    v_permlane32_swap_b32 v49, v51
    v_add_f32 v49, v49, v51
    v_rcp_f32 v53, v49
    s_lshl_b32 s88, s45, 5
    s_lshl_b32 s48, s80, 2
    s_add_u32 s88, s88, s48
    s_mul_i32 s88, s88, 24576
    s_add_u32 s88, s88, s56
    s_mul_i32 s48, s81, 24576
    s_add_u32 s48, s48, s88
    s_add_u32 s49, s48, 4096
    s_nop 3
    s_lshl_b32 s50, s81, 2
    s_lshl_b32 s83, 1, s50
    s_xor_b32 s83, s83, 0x1111
    v_mul_f32 v96, v96, v53
    v_mul_f32 v97, v97, v53
    v_mul_f32 v98, v98, v53
    v_mul_f32 v99, v99, v53
    v_mul_f32 v100, v100, v53
    v_mul_f32 v101, v101, v53
    v_mul_f32 v102, v102, v53
    v_mul_f32 v103, v103, v53
    v_cvt_pk_bf16_f32 v216, v96, v97
    v_cvt_pk_bf16_f32 v217, v98, v99
    v_cvt_pk_bf16_f32 v218, v100, v101
    v_cvt_pk_bf16_f32 v219, v102, v103
    buffer_store_dwordx4 v[216:219], v54, s[40:43], s48 offen offset:0 sc1
    v_mul_f32 v104, v104, v53
    v_mul_f32 v105, v105, v53
    v_mul_f32 v106, v106, v53
    v_mul_f32 v107, v107, v53
    v_mul_f32 v108, v108, v53
    v_mul_f32 v109, v109, v53
    v_mul_f32 v110, v110, v53
    v_mul_f32 v111, v111, v53
    v_cvt_pk_bf16_f32 v220, v104, v105
    v_cvt_pk_bf16_f32 v221, v106, v107
    v_cvt_pk_bf16_f32 v222, v108, v109
    v_cvt_pk_bf16_f32 v223, v110, v111
    buffer_store_dwordx4 v[220:223], v54, s[40:43], s48 offen offset:1024 sc1
    v_mul_f32 v112, v112, v53
    v_mul_f32 v113, v113, v53
    v_mul_f32 v114, v114, v53
    v_mul_f32 v115, v115, v53
    v_mul_f32 v116, v116, v53
    v_mul_f32 v117, v117, v53
    v_mul_f32 v118, v118, v53
    v_mul_f32 v119, v119, v53
    v_cvt_pk_bf16_f32 v224, v112, v113
    v_cvt_pk_bf16_f32 v225, v114, v115
    v_cvt_pk_bf16_f32 v226, v116, v117
    v_cvt_pk_bf16_f32 v227, v118, v119
    buffer_store_dwordx4 v[224:227], v54, s[40:43], s48 offen offset:2048 sc1
    v_mul_f32 v120, v120, v53
    v_mul_f32 v121, v121, v53
    v_mul_f32 v122, v122, v53
    v_mul_f32 v123, v123, v53
    v_mul_f32 v124, v124, v53
    v_mul_f32 v125, v125, v53
    v_mul_f32 v126, v126, v53
    v_mul_f32 v127, v127, v53
    v_cvt_pk_bf16_f32 v228, v120, v121
    v_cvt_pk_bf16_f32 v229, v122, v123
    v_cvt_pk_bf16_f32 v230, v124, v125
    v_cvt_pk_bf16_f32 v231, v126, v127
    buffer_store_dwordx4 v[228:231], v54, s[40:43], s48 offen offset:3072 sc1
    v_mul_f32 v128, v128, v53
    v_mul_f32 v129, v129, v53
    v_mul_f32 v130, v130, v53
    v_mul_f32 v131, v131, v53
    v_mul_f32 v132, v132, v53
    v_mul_f32 v133, v133, v53
    v_mul_f32 v134, v134, v53
    v_mul_f32 v135, v135, v53
    v_cvt_pk_bf16_f32 v232, v128, v129
    v_cvt_pk_bf16_f32 v233, v130, v131
    v_cvt_pk_bf16_f32 v234, v132, v133
    v_cvt_pk_bf16_f32 v235, v134, v135
    buffer_store_dwordx4 v[232:235], v54, s[40:43], s49 offen offset:0 sc1
    v_mul_f32 v136, v136, v53
    v_mul_f32 v137, v137, v53
    v_mul_f32 v138, v138, v53
    v_mul_f32 v139, v139, v53
    v_mul_f32 v140, v140, v53
    v_mul_f32 v141, v141, v53
    v_mul_f32 v142, v142, v53
    v_mul_f32 v143, v143, v53
    v_cvt_pk_bf16_f32 v236, v136, v137
    v_cvt_pk_bf16_f32 v237, v138, v139
    v_cvt_pk_bf16_f32 v238, v140, v141
    v_cvt_pk_bf16_f32 v239, v142, v143
    buffer_store_dwordx4 v[236:239], v54, s[40:43], s49 offen offset:1024 sc1
    v_mul_f32 v144, v144, v53
    v_mul_f32 v145, v145, v53
    v_mul_f32 v146, v146, v53
    v_mul_f32 v147, v147, v53
    v_mul_f32 v148, v148, v53
    v_mul_f32 v149, v149, v53
    v_mul_f32 v150, v150, v53
    v_mul_f32 v151, v151, v53
    v_cvt_pk_bf16_f32 v240, v144, v145
    v_cvt_pk_bf16_f32 v241, v146, v147
    v_cvt_pk_bf16_f32 v242, v148, v149
    v_cvt_pk_bf16_f32 v243, v150, v151
    buffer_store_dwordx4 v[240:243], v54, s[40:43], s49 offen offset:2048 sc1
    v_mul_f32 v152, v152, v53
    v_mul_f32 v153, v153, v53
    v_mul_f32 v154, v154, v53
    v_mul_f32 v155, v155, v53
    v_mul_f32 v156, v156, v53
    v_mul_f32 v157, v157, v53
    v_mul_f32 v158, v158, v53
    v_mul_f32 v159, v159, v53
    v_cvt_pk_bf16_f32 v244, v152, v153
    v_cvt_pk_bf16_f32 v245, v154, v155
    v_cvt_pk_bf16_f32 v246, v156, v157
    v_cvt_pk_bf16_f32 v247, v158, v159
    buffer_store_dwordx4 v[244:247], v54, s[40:43], s49 offen offset:3072 sc1
    v_add_u32 v55, 1, v55
    ds_write_b32 v56, v55
    s_mov_b32 s59, 0
    s_cmp_ge_u32 s59, 1
    s_cbranch_scc1 K1_L19_OK
K1_L19:
    ds_read_b32 v58, v18 offset:44
    s_waitcnt lgkmcnt(0)
    v_readfirstlane_b32 s59, v58
    s_cmp_ge_u32 s59, 1
    s_cbranch_scc0 K1_L19
K1_L19_OK:
    s_mov_b32 s59, 0
    v_and_b32 v10, 3, v0
    v_lshlrev_b32 v10, 2, v10
    v_and_b32 v11, 7, v0
    v_lshlrev_b32 v11, 2, v11
    v_add_u32 v11, 32, v11
    v_mov_b32 v12, 1
    s_mov_b32 s89, 0
    v_and_b32 v16, 3, v0
    v_lshlrev_b32 v16, 10, v16
    s_lshl_b32 s48, s45, 5
    s_add_u32 s48, s48, s80
    s_lshl_b32 s48, s48, 7
    s_lshl_b32 s49, s81, 2
    s_add_u32 s48, s48, s49
    s_add_u32 s48, s48, 7340032
    s_add_u32 s48, s48, s44
    s_waitcnt vmcnt(0)
    s_mov_b64 exec, 15
    buffer_store_byte v12, v16, s[40:43], s48 offen sc1
    s_mov_b64 exec, -1
    ds_read_b32 v58, v18 offset:48
    s_waitcnt lgkmcnt(0)
    v_readfirstlane_b32 s82, v58
    s_nop 0
    s_lshr_b32 s82, s82, s44
    s_cmp_eq_u32 s89, 0
    s_cbranch_scc0 K1_T20
    s_and_b32 s50, s82, s83
    s_cbranch_scc0 K1_T20
    s_ff1_i32_b32 s84, s50
    s_bitset0_b32 s83, s84
    s_lshr_b32 s84, s84, 2
    s_mul_i32 s48, s84, 24576
    s_add_u32 s48, s48, s88
    s_add_u32 s49, s48, 4096
    buffer_load_dwordx4 a[0:3], v54, s[40:43], s48 offen offset:0 sc1
    buffer_load_dwordx4 a[4:7], v54, s[40:43], s48 offen offset:1024 sc1
    buffer_load_dwordx4 a[8:11], v54, s[40:43], s48 offen offset:2048 sc1
    buffer_load_dwordx4 a[12:15], v54, s[40:43], s48 offen offset:3072 sc1
    buffer_load_dwordx4 a[16:19], v54, s[40:43], s49 offen offset:0 sc1
    buffer_load_dwordx4 a[20:23], v54, s[40:43], s49 offen offset:1024 sc1
    buffer_load_dwordx4 a[24:27], v54, s[40:43], s49 offen offset:2048 sc1
    buffer_load_dwordx4 a[28:31], v54, s[40:43], s49 offen offset:3072 sc1
    s_sub_u32 s90, s84, s81
    s_and_b32 s90, s90, 3
    s_lshl_b32 s90, s90, 14
    s_mov_b32 s89, 1
K1_T20:
    s_cmp_eq_u32 s89, 1
    s_cbranch_scc0 K1_T21
    s_and_b32 s50, s82, s83
    s_cbranch_scc0 K1_T21
    s_ff1_i32_b32 s84, s50
    s_bitset0_b32 s83, s84
    s_lshr_b32 s84, s84, 2
    s_mul_i32 s48, s84, 24576
    s_add_u32 s48, s48, s88
    s_add_u32 s49, s48, 4096
    buffer_load_dwordx4 a[32:35], v54, s[40:43], s48 offen offset:0 sc1
    buffer_load_dwordx4 a[36:39], v54, s[40:43], s48 offen offset:1024 sc1
    buffer_load_dwordx4 a[40:43], v54, s[40:43], s48 offen offset:2048 sc1
    buffer_load_dwordx4 a[44:47], v54, s[40:43], s48 offen offset:3072 sc1
    buffer_load_dwordx4 a[48:51], v54, s[40:43], s49 offen offset:0 sc1
    buffer_load_dwordx4 a[52:55], v54, s[40:43], s49 offen offset:1024 sc1
    buffer_load_dwordx4 a[56:59], v54, s[40:43], s49 offen offset:2048 sc1
    buffer_load_dwordx4 a[60:63], v54, s[40:43], s49 offen offset:3072 sc1
    s_sub_u32 s91, s84, s81
    s_and_b32 s91, s91, 3
    s_lshl_b32 s91, s91, 14
    s_mov_b32 s89, 2
K1_T21:
    s_cmp_eq_u32 s89, 2
    s_cbranch_scc0 K1_T22
    s_and_b32 s50, s82, s83
    s_cbranch_scc0 K1_T22
    s_ff1_i32_b32 s84, s50
    s_bitset0_b32 s83, s84
    s_lshr_b32 s84, s84, 2
    s_mul_i32 s48, s84, 24576
    s_add_u32 s48, s48, s88
    s_add_u32 s49, s48, 4096
    buffer_load_dwordx4 a[64:67], v54, s[40:43], s48 offen offset:0 sc1
    buffer_load_dwordx4 a[68:71], v54, s[40:43], s48 offen offset:1024 sc1
    buffer_load_dwordx4 a[72:75], v54, s[40:43], s48 offen offset:2048 sc1
    buffer_load_dwordx4 a[76:79], v54, s[40:43], s48 offen offset:3072 sc1
    buffer_load_dwordx4 a[80:83], v54, s[40:43], s49 offen offset:0 sc1
    buffer_load_dwordx4 a[84:87], v54, s[40:43], s49 offen offset:1024 sc1
    buffer_load_dwordx4 a[88:91], v54, s[40:43], s49 offen offset:2048 sc1
    buffer_load_dwordx4 a[92:95], v54, s[40:43], s49 offen offset:3072 sc1
    s_sub_u32 s92, s84, s81
    s_and_b32 s92, s92, 3
    s_lshl_b32 s92, s92, 14
    s_mov_b32 s89, 3
K1_T22:
    s_mov_b32 s87, 0
    s_sub_u32 s48, s87, 81920
    s_add_u32 s49, s87, 65536
    v_add_u32 v4, s48, v28
    v_add_u32 v20, s49, v28
    v_add_u32 v5, s48, v29
    v_add_u32 v21, s49, v29
    v_add_u32 v6, s48, v30
    v_add_u32 v22, s49, v30
    v_add_u32 v7, s48, v31
    v_add_u32 v23, s49, v31
    s_cmp_ge_u32 s59, 1
    s_cbranch_scc1 K1_L23_OK
K1_L23:
    ds_read_b32 v58, v18 offset:36
    s_waitcnt lgkmcnt(0)
    v_readfirstlane_b32 s59, v58
    s_cmp_ge_u32 s59, 1
    s_cbranch_scc0 K1_L23
K1_L23_OK:
    ds_read_b64_tr_b16 v[160:161], v20 offset:0
    ds_read_b64_tr_b16 v[162:163], v20 offset:2048
    ds_read_b64_tr_b16 v[164:165], v21 offset:0
    ds_read_b64_tr_b16 v[166:167], v21 offset:2048
    ds_read_b64_tr_b16 v[168:169], v22 offset:0
    ds_read_b64_tr_b16 v[170:171], v22 offset:2048
    ds_read_b64_tr_b16 v[172:173], v23 offset:0
    ds_read_b64_tr_b16 v[174:175], v23 offset:2048
    ds_read_b64_tr_b16 v[176:177], v20 offset:4096
    ds_read_b64_tr_b16 v[178:179], v20 offset:6144
    ds_read_b64_tr_b16 v[180:181], v21 offset:4096
    ds_read_b64_tr_b16 v[182:183], v21 offset:6144
    ds_read_b64_tr_b16 v[184:185], v22 offset:4096
    ds_read_b64_tr_b16 v[186:187], v22 offset:6144
    ds_read_b64_tr_b16 v[188:189], v23 offset:4096
    ds_read_b64_tr_b16 v[190:191], v23 offset:6144
    s_waitcnt lgkmcnt(8)
    v_mfma_f32_32x32x16_bf16 v[96:111], v[160:163], v[216:219], 0
    ds_read_b64_tr_b16 v[192:193], v20 offset:8192
    ds_read_b64_tr_b16 v[194:195], v20 offset:10240
    v_mfma_f32_32x32x16_bf16 v[112:127], v[164:167], v[216:219], 0
    ds_read_b64_tr_b16 v[196:197], v21 offset:8192
    ds_read_b64_tr_b16 v[198:199], v21 offset:10240
    v_mfma_f32_32x32x16_bf16 v[128:143], v[168:171], v[216:219], 0
    ds_read_b64_tr_b16 v[200:201], v22 offset:8192
    ds_read_b64_tr_b16 v[202:203], v22 offset:10240
    v_mfma_f32_32x32x16_bf16 v[144:159], v[172:175], v[216:219], 0
    ds_read_b64_tr_b16 v[204:205], v23 offset:8192
    ds_read_b64_tr_b16 v[206:207], v23 offset:10240
    s_waitcnt lgkmcnt(8)
    v_mfma_f32_32x32x16_bf16 v[96:111], v[176:179], v[220:223], v[96:111]
    ds_read_b64_tr_b16 v[160:161], v20 offset:12288
    ds_read_b64_tr_b16 v[162:163], v20 offset:14336
    v_mfma_f32_32x32x16_bf16 v[112:127], v[180:183], v[220:223], v[112:127]
    ds_read_b64_tr_b16 v[164:165], v21 offset:12288
    ds_read_b64_tr_b16 v[166:167], v21 offset:14336
    v_mfma_f32_32x32x16_bf16 v[128:143], v[184:187], v[220:223], v[128:143]
    ds_read_b64_tr_b16 v[168:169], v22 offset:12288
    ds_read_b64_tr_b16 v[170:171], v22 offset:14336
    v_mfma_f32_32x32x16_bf16 v[144:159], v[188:191], v[220:223], v[144:159]
    ds_read_b64_tr_b16 v[172:173], v23 offset:12288
    ds_read_b64_tr_b16 v[174:175], v23 offset:14336
    s_waitcnt lgkmcnt(8)
    v_mfma_f32_32x32x16_bf16 v[96:111], v[192:195], v[224:227], v[96:111]
    s_cmp_ge_u32 s59, 2
    s_cbranch_scc1 K1_L24_OK
K1_L24:
    ds_read_b32 v58, v18 offset:36
    s_waitcnt lgkmcnt(0)
    v_readfirstlane_b32 s59, v58
    s_cmp_ge_u32 s59, 2
    s_cbranch_scc0 K1_L24
K1_L24_OK:
    ds_read_b64_tr_b16 v[176:177], v4 offset:16384
    ds_read_b64_tr_b16 v[178:179], v4 offset:18432
    v_mfma_f32_32x32x16_bf16 v[112:127], v[196:199], v[224:227], v[112:127]
    ds_read_b64_tr_b16 v[180:181], v5 offset:16384
    ds_read_b64_tr_b16 v[182:183], v5 offset:18432
    v_mfma_f32_32x32x16_bf16 v[128:143], v[200:203], v[224:227], v[128:143]
    ds_read_b64_tr_b16 v[184:185], v6 offset:16384
    ds_read_b64_tr_b16 v[186:187], v6 offset:18432
    v_mfma_f32_32x32x16_bf16 v[144:159], v[204:207], v[224:227], v[144:159]
    ds_read_b64_tr_b16 v[188:189], v7 offset:16384
    ds_read_b64_tr_b16 v[190:191], v7 offset:18432
    s_waitcnt lgkmcnt(8)
    v_mfma_f32_32x32x16_bf16 v[96:111], v[160:163], v[228:231], v[96:111]
    ds_read_b64_tr_b16 v[192:193], v4 offset:20480
    ds_read_b64_tr_b16 v[194:195], v4 offset:22528
    v_mfma_f32_32x32x16_bf16 v[112:127], v[164:167], v[228:231], v[112:127]
    ds_read_b64_tr_b16 v[196:197], v5 offset:20480
    ds_read_b64_tr_b16 v[198:199], v5 offset:22528
    v_mfma_f32_32x32x16_bf16 v[128:143], v[168:171], v[228:231], v[128:143]
    ds_read_b64_tr_b16 v[200:201], v6 offset:20480
    ds_read_b64_tr_b16 v[202:203], v6 offset:22528
    v_mfma_f32_32x32x16_bf16 v[144:159], v[172:175], v[228:231], v[144:159]
    ds_read_b64_tr_b16 v[204:205], v7 offset:20480
    ds_read_b64_tr_b16 v[206:207], v7 offset:22528
    s_waitcnt lgkmcnt(8)
    v_mfma_f32_32x32x16_bf16 v[96:111], v[176:179], v[232:235], v[96:111]
    ds_read_b64_tr_b16 v[160:161], v4 offset:24576
    ds_read_b64_tr_b16 v[162:163], v4 offset:26624
    v_mfma_f32_32x32x16_bf16 v[112:127], v[180:183], v[232:235], v[112:127]
    ds_read_b64_tr_b16 v[164:165], v5 offset:24576
    ds_read_b64_tr_b16 v[166:167], v5 offset:26624
    v_mfma_f32_32x32x16_bf16 v[128:143], v[184:187], v[232:235], v[128:143]
    ds_read_b64_tr_b16 v[168:169], v6 offset:24576
    ds_read_b64_tr_b16 v[170:171], v6 offset:26624
    v_mfma_f32_32x32x16_bf16 v[144:159], v[188:191], v[232:235], v[144:159]
    ds_read_b64_tr_b16 v[172:173], v7 offset:24576
    ds_read_b64_tr_b16 v[174:175], v7 offset:26624
    s_waitcnt lgkmcnt(8)
    v_mfma_f32_32x32x16_bf16 v[96:111], v[192:195], v[236:239], v[96:111]
    ds_read_b64_tr_b16 v[176:177], v4 offset:28672
    ds_read_b64_tr_b16 v[178:179], v4 offset:30720
    v_mfma_f32_32x32x16_bf16 v[112:127], v[196:199], v[236:239], v[112:127]
    ds_read_b64_tr_b16 v[180:181], v5 offset:28672
    ds_read_b64_tr_b16 v[182:183], v5 offset:30720
    v_mfma_f32_32x32x16_bf16 v[128:143], v[200:203], v[236:239], v[128:143]
    ds_read_b64_tr_b16 v[184:185], v6 offset:28672
    ds_read_b64_tr_b16 v[186:187], v6 offset:30720
    v_mfma_f32_32x32x16_bf16 v[144:159], v[204:207], v[236:239], v[144:159]
    ds_read_b64_tr_b16 v[188:189], v7 offset:28672
    ds_read_b64_tr_b16 v[190:191], v7 offset:30720
    s_waitcnt lgkmcnt(8)
    v_mfma_f32_32x32x16_bf16 v[96:111], v[160:163], v[240:243], v[96:111]
    v_mfma_f32_32x32x16_bf16 v[112:127], v[164:167], v[240:243], v[112:127]
    v_mfma_f32_32x32x16_bf16 v[128:143], v[168:171], v[240:243], v[128:143]
    v_mfma_f32_32x32x16_bf16 v[144:159], v[172:175], v[240:243], v[144:159]
    s_waitcnt lgkmcnt(0)
    v_mfma_f32_32x32x16_bf16 v[96:111], v[176:179], v[244:247], v[96:111]
    v_mfma_f32_32x32x16_bf16 v[112:127], v[180:183], v[244:247], v[112:127]
    v_mfma_f32_32x32x16_bf16 v[128:143], v[184:187], v[244:247], v[128:143]
    v_mfma_f32_32x32x16_bf16 v[144:159], v[188:191], v[244:247], v[144:159]
    s_cmp_gt_u32 s89, 0
    s_cbranch_scc1 K1_B25_OK
K1_B25:
    ds_read_b32 v58, v18 offset:48
    s_waitcnt lgkmcnt(0)
    v_readfirstlane_b32 s82, v58
    s_nop 0
    s_lshr_b32 s82, s82, s44
    s_and_b32 s50, s82, s83
    s_cbranch_scc0 K1_B25
    s_ff1_i32_b32 s84, s50
    s_bitset0_b32 s83, s84
    s_lshr_b32 s84, s84, 2
    s_mul_i32 s48, s84, 24576
    s_add_u32 s48, s48, s88
    s_add_u32 s49, s48, 4096
    buffer_load_dwordx4 a[0:3], v54, s[40:43], s48 offen offset:0 sc1
    buffer_load_dwordx4 a[4:7], v54, s[40:43], s48 offen offset:1024 sc1
    buffer_load_dwordx4 a[8:11], v54, s[40:43], s48 offen offset:2048 sc1
    buffer_load_dwordx4 a[12:15], v54, s[40:43], s48 offen offset:3072 sc1
    buffer_load_dwordx4 a[16:19], v54, s[40:43], s49 offen offset:0 sc1
    buffer_load_dwordx4 a[20:23], v54, s[40:43], s49 offen offset:1024 sc1
    buffer_load_dwordx4 a[24:27], v54, s[40:43], s49 offen offset:2048 sc1
    buffer_load_dwordx4 a[28:31], v54, s[40:43], s49 offen offset:3072 sc1
    s_sub_u32 s90, s84, s81
    s_and_b32 s90, s90, 3
    s_lshl_b32 s90, s90, 14
    s_mov_b32 s89, 1
K1_B25_OK:
    ds_read_b32 v58, v18 offset:48
    s_waitcnt lgkmcnt(0)
    v_readfirstlane_b32 s82, v58
    s_nop 0
    s_lshr_b32 s82, s82, s44
    s_cmp_eq_u32 s89, 1
    s_cbranch_scc0 K1_T26
    s_and_b32 s50, s82, s83
    s_cbranch_scc0 K1_T26
    s_ff1_i32_b32 s84, s50
    s_bitset0_b32 s83, s84
    s_lshr_b32 s84, s84, 2
    s_mul_i32 s48, s84, 24576
    s_add_u32 s48, s48, s88
    s_add_u32 s49, s48, 4096
    buffer_load_dwordx4 a[32:35], v54, s[40:43], s48 offen offset:0 sc1
    buffer_load_dwordx4 a[36:39], v54, s[40:43], s48 offen offset:1024 sc1
    buffer_load_dwordx4 a[40:43], v54, s[40:43], s48 offen offset:2048 sc1
    buffer_load_dwordx4 a[44:47], v54, s[40:43], s48 offen offset:3072 sc1
    buffer_load_dwordx4 a[48:51], v54, s[40:43], s49 offen offset:0 sc1
    buffer_load_dwordx4 a[52:55], v54, s[40:43], s49 offen offset:1024 sc1
    buffer_load_dwordx4 a[56:59], v54, s[40:43], s49 offen offset:2048 sc1
    buffer_load_dwordx4 a[60:63], v54, s[40:43], s49 offen offset:3072 sc1
    s_sub_u32 s91, s84, s81
    s_and_b32 s91, s91, 3
    s_lshl_b32 s91, s91, 14
    s_mov_b32 s89, 2
K1_T26:
    s_cmp_eq_u32 s89, 2
    s_cbranch_scc0 K1_T27
    s_and_b32 s50, s82, s83
    s_cbranch_scc0 K1_T27
    s_ff1_i32_b32 s84, s50
    s_bitset0_b32 s83, s84
    s_lshr_b32 s84, s84, 2
    s_mul_i32 s48, s84, 24576
    s_add_u32 s48, s48, s88
    s_add_u32 s49, s48, 4096
    buffer_load_dwordx4 a[64:67], v54, s[40:43], s48 offen offset:0 sc1
    buffer_load_dwordx4 a[68:71], v54, s[40:43], s48 offen offset:1024 sc1
    buffer_load_dwordx4 a[72:75], v54, s[40:43], s48 offen offset:2048 sc1
    buffer_load_dwordx4 a[76:79], v54, s[40:43], s48 offen offset:3072 sc1
    buffer_load_dwordx4 a[80:83], v54, s[40:43], s49 offen offset:0 sc1
    buffer_load_dwordx4 a[84:87], v54, s[40:43], s49 offen offset:1024 sc1
    buffer_load_dwordx4 a[88:91], v54, s[40:43], s49 offen offset:2048 sc1
    buffer_load_dwordx4 a[92:95], v54, s[40:43], s49 offen offset:3072 sc1
    s_sub_u32 s92, s84, s81
    s_and_b32 s92, s92, 3
    s_lshl_b32 s92, s92, 14
    s_mov_b32 s89, 3
K1_T27:
    s_mov_b32 s87, s90
    s_lshr_b32 s51, s87, 13
    s_add_u32 s51, s51, 2
    s_sub_u32 s48, s87, 81920
    s_add_u32 s49, s87, -8192
    v_add_u32 v4, s48, v28
    v_add_u32 v20, s49, v28
    v_add_u32 v5, s48, v29
    v_add_u32 v21, s49, v29
    v_add_u32 v6, s48, v30
    v_add_u32 v22, s49, v30
    v_add_u32 v7, s48, v31
    v_add_u32 v23, s49, v31
    s_cmp_ge_u32 s59, s51
    s_cbranch_scc1 K1_L28_OK
K1_L28:
    ds_read_b32 v58, v18 offset:36
    s_waitcnt lgkmcnt(0)
    v_readfirstlane_b32 s59, v58
    s_cmp_ge_u32 s59, s51
    s_cbranch_scc0 K1_L28
K1_L28_OK:
    ds_read_b64_tr_b16 v[160:161], v20 offset:0
    ds_read_b64_tr_b16 v[162:163], v20 offset:2048
    ds_read_b64_tr_b16 v[164:165], v21 offset:0
    ds_read_b64_tr_b16 v[166:167], v21 offset:2048
    ds_read_b64_tr_b16 v[168:169], v22 offset:0
    ds_read_b64_tr_b16 v[170:171], v22 offset:2048
    ds_read_b64_tr_b16 v[172:173], v23 offset:0
    ds_read_b64_tr_b16 v[174:175], v23 offset:2048
    ds_read_b64_tr_b16 v[176:177], v20 offset:4096
    ds_read_b64_tr_b16 v[178:179], v20 offset:6144
    ds_read_b64_tr_b16 v[180:181], v21 offset:4096
    ds_read_b64_tr_b16 v[182:183], v21 offset:6144
    ds_read_b64_tr_b16 v[184:185], v22 offset:4096
    ds_read_b64_tr_b16 v[186:187], v22 offset:6144
    ds_read_b64_tr_b16 v[188:189], v23 offset:4096
    ds_read_b64_tr_b16 v[190:191], v23 offset:6144
    s_cmp_eq_u32 s89, 3
    s_cbranch_scc0 K1_W29_a
    s_waitcnt vmcnt(16)
    s_branch K1_W29_e
K1_W29_a:
    s_cmp_eq_u32 s89, 2
    s_cbranch_scc0 K1_W29_b
    s_waitcnt vmcnt(8)
    s_branch K1_W29_e
K1_W29_b:
    s_waitcnt vmcnt(0)
K1_W29_e:
    s_waitcnt lgkmcnt(8)
    v_mfma_f32_32x32x16_bf16 v[96:111], v[160:163], a[0:3], v[96:111]
    ds_read_b64_tr_b16 v[192:193], v20 offset:8192
    ds_read_b64_tr_b16 v[194:195], v20 offset:10240
    v_mfma_f32_32x32x16_bf16 v[112:127], v[164:167], a[0:3], v[112:127]
    ds_read_b64_tr_b16 v[196:197], v21 offset:8192
    ds_read_b64_tr_b16 v[198:199], v21 offset:10240
    v_mfma_f32_32x32x16_bf16 v[128:143], v[168:171], a[0:3], v[128:143]
    ds_read_b64_tr_b16 v[200:201], v22 offset:8192
    ds_read_b64_tr_b16 v[202:203], v22 offset:10240
    v_mfma_f32_32x32x16_bf16 v[144:159], v[172:175], a[0:3], v[144:159]
    ds_read_b64_tr_b16 v[204:205], v23 offset:8192
    ds_read_b64_tr_b16 v[206:207], v23 offset:10240
    s_waitcnt lgkmcnt(8)
    v_mfma_f32_32x32x16_bf16 v[96:111], v[176:179], a[4:7], v[96:111]
    ds_read_b64_tr_b16 v[160:161], v20 offset:12288
    ds_read_b64_tr_b16 v[162:163], v20 offset:14336
    v_mfma_f32_32x32x16_bf16 v[112:127], v[180:183], a[4:7], v[112:127]
    ds_read_b64_tr_b16 v[164:165], v21 offset:12288
    ds_read_b64_tr_b16 v[166:167], v21 offset:14336
    v_mfma_f32_32x32x16_bf16 v[128:143], v[184:187], a[4:7], v[128:143]
    ds_read_b64_tr_b16 v[168:169], v22 offset:12288
    ds_read_b64_tr_b16 v[170:171], v22 offset:14336
    v_mfma_f32_32x32x16_bf16 v[144:159], v[188:191], a[4:7], v[144:159]
    ds_read_b64_tr_b16 v[172:173], v23 offset:12288
    ds_read_b64_tr_b16 v[174:175], v23 offset:14336
    s_waitcnt lgkmcnt(8)
    v_mfma_f32_32x32x16_bf16 v[96:111], v[192:195], a[8:11], v[96:111]
    ds_read_b64_tr_b16 v[176:177], v4 offset:16384
    ds_read_b64_tr_b16 v[178:179], v4 offset:18432
    v_mfma_f32_32x32x16_bf16 v[112:127], v[196:199], a[8:11], v[112:127]
    ds_read_b64_tr_b16 v[180:181], v5 offset:16384
    ds_read_b64_tr_b16 v[182:183], v5 offset:18432
    v_mfma_f32_32x32x16_bf16 v[128:143], v[200:203], a[8:11], v[128:143]
    ds_read_b64_tr_b16 v[184:185], v6 offset:16384
    ds_read_b64_tr_b16 v[186:187], v6 offset:18432
    v_mfma_f32_32x32x16_bf16 v[144:159], v[204:207], a[8:11], v[144:159]
    ds_read_b64_tr_b16 v[188:189], v7 offset:16384
    ds_read_b64_tr_b16 v[190:191], v7 offset:18432
    s_waitcnt lgkmcnt(8)
    v_mfma_f32_32x32x16_bf16 v[96:111], v[160:163], a[12:15], v[96:111]
    ds_read_b64_tr_b16 v[192:193], v4 offset:20480
    ds_read_b64_tr_b16 v[194:195], v4 offset:22528
    v_mfma_f32_32x32x16_bf16 v[112:127], v[164:167], a[12:15], v[112:127]
    ds_read_b64_tr_b16 v[196:197], v5 offset:20480
    ds_read_b64_tr_b16 v[198:199], v5 offset:22528
    v_mfma_f32_32x32x16_bf16 v[128:143], v[168:171], a[12:15], v[128:143]
    ds_read_b64_tr_b16 v[200:201], v6 offset:20480
    ds_read_b64_tr_b16 v[202:203], v6 offset:22528
    v_mfma_f32_32x32x16_bf16 v[144:159], v[172:175], a[12:15], v[144:159]
    ds_read_b64_tr_b16 v[204:205], v7 offset:20480
    ds_read_b64_tr_b16 v[206:207], v7 offset:22528
    s_waitcnt lgkmcnt(8)
    v_mfma_f32_32x32x16_bf16 v[96:111], v[176:179], a[16:19], v[96:111]
    ds_read_b64_tr_b16 v[160:161], v4 offset:24576
    ds_read_b64_tr_b16 v[162:163], v4 offset:26624
    v_mfma_f32_32x32x16_bf16 v[112:127], v[180:183], a[16:19], v[112:127]
    ds_read_b64_tr_b16 v[164:165], v5 offset:24576
    ds_read_b64_tr_b16 v[166:167], v5 offset:26624
    v_mfma_f32_32x32x16_bf16 v[128:143], v[184:187], a[16:19], v[128:143]
    ds_read_b64_tr_b16 v[168:169], v6 offset:24576
    ds_read_b64_tr_b16 v[170:171], v6 offset:26624
    v_mfma_f32_32x32x16_bf16 v[144:159], v[188:191], a[16:19], v[144:159]
    ds_read_b64_tr_b16 v[172:173], v7 offset:24576
    ds_read_b64_tr_b16 v[174:175], v7 offset:26624
    s_waitcnt lgkmcnt(8)
    v_mfma_f32_32x32x16_bf16 v[96:111], v[192:195], a[20:23], v[96:111]
    ds_read_b64_tr_b16 v[176:177], v4 offset:28672
    ds_read_b64_tr_b16 v[178:179], v4 offset:30720
    v_mfma_f32_32x32x16_bf16 v[112:127], v[196:199], a[20:23], v[112:127]
    ds_read_b64_tr_b16 v[180:181], v5 offset:28672
    ds_read_b64_tr_b16 v[182:183], v5 offset:30720
    v_mfma_f32_32x32x16_bf16 v[128:143], v[200:203], a[20:23], v[128:143]
    ds_read_b64_tr_b16 v[184:185], v6 offset:28672
    ds_read_b64_tr_b16 v[186:187], v6 offset:30720
    v_mfma_f32_32x32x16_bf16 v[144:159], v[204:207], a[20:23], v[144:159]
    ds_read_b64_tr_b16 v[188:189], v7 offset:28672
    ds_read_b64_tr_b16 v[190:191], v7 offset:30720
    s_waitcnt lgkmcnt(8)
    v_mfma_f32_32x32x16_bf16 v[96:111], v[160:163], a[24:27], v[96:111]
    v_mfma_f32_32x32x16_bf16 v[112:127], v[164:167], a[24:27], v[112:127]
    v_mfma_f32_32x32x16_bf16 v[128:143], v[168:171], a[24:27], v[128:143]
    v_mfma_f32_32x32x16_bf16 v[144:159], v[172:175], a[24:27], v[144:159]
    s_waitcnt lgkmcnt(0)
    v_mfma_f32_32x32x16_bf16 v[96:111], v[176:179], a[28:31], v[96:111]
    v_mfma_f32_32x32x16_bf16 v[112:127], v[180:183], a[28:31], v[112:127]
    v_mfma_f32_32x32x16_bf16 v[128:143], v[184:187], a[28:31], v[128:143]
    v_mfma_f32_32x32x16_bf16 v[144:159], v[188:191], a[28:31], v[144:159]
    s_cmp_gt_u32 s89, 1
    s_cbranch_scc1 K1_B30_OK
K1_B30:
    ds_read_b32 v58, v18 offset:48
    s_waitcnt lgkmcnt(0)
    v_readfirstlane_b32 s82, v58
    s_nop 0
    s_lshr_b32 s82, s82, s44
    s_and_b32 s50, s82, s83
    s_cbranch_scc0 K1_B30
    s_ff1_i32_b32 s84, s50
    s_bitset0_b32 s83, s84
    s_lshr_b32 s84, s84, 2
    s_mul_i32 s48, s84, 24576
    s_add_u32 s48, s48, s88
    s_add_u32 s49, s48, 4096
    buffer_load_dwordx4 a[32:35], v54, s[40:43], s48 offen offset:0 sc1
    buffer_load_dwordx4 a[36:39], v54, s[40:43], s48 offen offset:1024 sc1
    buffer_load_dwordx4 a[40:43], v54, s[40:43], s48 offen offset:2048 sc1
    buffer_load_dwordx4 a[44:47], v54, s[40:43], s48 offen offset:3072 sc1
    buffer_load_dwordx4 a[48:51], v54, s[40:43], s49 offen offset:0 sc1
    buffer_load_dwordx4 a[52:55], v54, s[40:43], s49 offen offset:1024 sc1
    buffer_load_dwordx4 a[56:59], v54, s[40:43], s49 offen offset:2048 sc1
    buffer_load_dwordx4 a[60:63], v54, s[40:43], s49 offen offset:3072 sc1
    s_sub_u32 s91, s84, s81
    s_and_b32 s91, s91, 3
    s_lshl_b32 s91, s91, 14
    s_mov_b32 s89, 2
K1_B30_OK:
    ds_read_b32 v58, v18 offset:48
    s_waitcnt lgkmcnt(0)
    v_readfirstlane_b32 s82, v58
    s_nop 0
    s_lshr_b32 s82, s82, s44
    s_cmp_eq_u32 s89, 2
    s_cbranch_scc0 K1_T31
    s_and_b32 s50, s82, s83
    s_cbranch_scc0 K1_T31
    s_ff1_i32_b32 s84, s50
    s_bitset0_b32 s83, s84
    s_lshr_b32 s84, s84, 2
    s_mul_i32 s48, s84, 24576
    s_add_u32 s48, s48, s88
    s_add_u32 s49, s48, 4096
    buffer_load_dwordx4 a[64:67], v54, s[40:43], s48 offen offset:0 sc1
    buffer_load_dwordx4 a[68:71], v54, s[40:43], s48 offen offset:1024 sc1
    buffer_load_dwordx4 a[72:75], v54, s[40:43], s48 offen offset:2048 sc1
    buffer_load_dwordx4 a[76:79], v54, s[40:43], s48 offen offset:3072 sc1
    buffer_load_dwordx4 a[80:83], v54, s[40:43], s49 offen offset:0 sc1
    buffer_load_dwordx4 a[84:87], v54, s[40:43], s49 offen offset:1024 sc1
    buffer_load_dwordx4 a[88:91], v54, s[40:43], s49 offen offset:2048 sc1
    buffer_load_dwordx4 a[92:95], v54, s[40:43], s49 offen offset:3072 sc1
    s_sub_u32 s92, s84, s81
    s_and_b32 s92, s92, 3
    s_lshl_b32 s92, s92, 14
    s_mov_b32 s89, 3
K1_T31:
    s_mov_b32 s87, s91
    s_lshr_b32 s51, s87, 13
    s_add_u32 s51, s51, 2
    s_sub_u32 s48, s87, 81920
    s_add_u32 s49, s87, -8192
    v_add_u32 v4, s48, v28
    v_add_u32 v20, s49, v28
    v_add_u32 v5, s48, v29
    v_add_u32 v21, s49, v29
    v_add_u32 v6, s48, v30
    v_add_u32 v22, s49, v30
    v_add_u32 v7, s48, v31
    v_add_u32 v23, s49, v31
    s_cmp_ge_u32 s59, s51
    s_cbranch_scc1 K1_L32_OK
K1_L32:
    ds_read_b32 v58, v18 offset:36
    s_waitcnt lgkmcnt(0)
    v_readfirstlane_b32 s59, v58
    s_cmp_ge_u32 s59, s51
    s_cbranch_scc0 K1_L32
K1_L32_OK:
    ds_read_b64_tr_b16 v[160:161], v20 offset:0
    ds_read_b64_tr_b16 v[162:163], v20 offset:2048
    ds_read_b64_tr_b16 v[164:165], v21 offset:0
    ds_read_b64_tr_b16 v[166:167], v21 offset:2048
    ds_read_b64_tr_b16 v[168:169], v22 offset:0
    ds_read_b64_tr_b16 v[170:171], v22 offset:2048
    ds_read_b64_tr_b16 v[172:173], v23 offset:0
    ds_read_b64_tr_b16 v[174:175], v23 offset:2048
    ds_read_b64_tr_b16 v[176:177], v20 offset:4096
    ds_read_b64_tr_b16 v[178:179], v20 offset:6144
    ds_read_b64_tr_b16 v[180:181], v21 offset:4096
    ds_read_b64_tr_b16 v[182:183], v21 offset:6144
    ds_read_b64_tr_b16 v[184:185], v22 offset:4096
    ds_read_b64_tr_b16 v[186:187], v22 offset:6144
    ds_read_b64_tr_b16 v[188:189], v23 offset:4096
    ds_read_b64_tr_b16 v[190:191], v23 offset:6144
    s_cmp_eq_u32 s89, 3
    s_cbranch_scc0 K1_W33_b
    s_waitcnt vmcnt(8)
    s_branch K1_W33_e
K1_W33_b:
    s_waitcnt vmcnt(0)
K1_W33_e:
    s_waitcnt lgkmcnt(8)
    v_mfma_f32_32x32x16_bf16 v[96:111], v[160:163], a[32:35], v[96:111]
    ds_read_b64_tr_b16 v[192:193], v20 offset:8192
    ds_read_b64_tr_b16 v[194:195], v20 offset:10240
    v_mfma_f32_32x32x16_bf16 v[112:127], v[164:167], a[32:35], v[112:127]
    ds_read_b64_tr_b16 v[196:197], v21 offset:8192
    ds_read_b64_tr_b16 v[198:199], v21 offset:10240
    v_mfma_f32_32x32x16_bf16 v[128:143], v[168:171], a[32:35], v[128:143]
    ds_read_b64_tr_b16 v[200:201], v22 offset:8192
    ds_read_b64_tr_b16 v[202:203], v22 offset:10240
    v_mfma_f32_32x32x16_bf16 v[144:159], v[172:175], a[32:35], v[144:159]
    ds_read_b64_tr_b16 v[204:205], v23 offset:8192
    ds_read_b64_tr_b16 v[206:207], v23 offset:10240
    s_waitcnt lgkmcnt(8)
    v_mfma_f32_32x32x16_bf16 v[96:111], v[176:179], a[36:39], v[96:111]
    ds_read_b64_tr_b16 v[160:161], v20 offset:12288
    ds_read_b64_tr_b16 v[162:163], v20 offset:14336
    v_mfma_f32_32x32x16_bf16 v[112:127], v[180:183], a[36:39], v[112:127]
    ds_read_b64_tr_b16 v[164:165], v21 offset:12288
    ds_read_b64_tr_b16 v[166:167], v21 offset:14336
    v_mfma_f32_32x32x16_bf16 v[128:143], v[184:187], a[36:39], v[128:143]
    ds_read_b64_tr_b16 v[168:169], v22 offset:12288
    ds_read_b64_tr_b16 v[170:171], v22 offset:14336
    v_mfma_f32_32x32x16_bf16 v[144:159], v[188:191], a[36:39], v[144:159]
    ds_read_b64_tr_b16 v[172:173], v23 offset:12288
    ds_read_b64_tr_b16 v[174:175], v23 offset:14336
    s_waitcnt lgkmcnt(8)
    v_mfma_f32_32x32x16_bf16 v[96:111], v[192:195], a[40:43], v[96:111]
    ds_read_b64_tr_b16 v[176:177], v4 offset:16384
    ds_read_b64_tr_b16 v[178:179], v4 offset:18432
    v_mfma_f32_32x32x16_bf16 v[112:127], v[196:199], a[40:43], v[112:127]
    ds_read_b64_tr_b16 v[180:181], v5 offset:16384
    ds_read_b64_tr_b16 v[182:183], v5 offset:18432
    v_mfma_f32_32x32x16_bf16 v[128:143], v[200:203], a[40:43], v[128:143]
    ds_read_b64_tr_b16 v[184:185], v6 offset:16384
    ds_read_b64_tr_b16 v[186:187], v6 offset:18432
    v_mfma_f32_32x32x16_bf16 v[144:159], v[204:207], a[40:43], v[144:159]
    ds_read_b64_tr_b16 v[188:189], v7 offset:16384
    ds_read_b64_tr_b16 v[190:191], v7 offset:18432
    s_waitcnt lgkmcnt(8)
    v_mfma_f32_32x32x16_bf16 v[96:111], v[160:163], a[44:47], v[96:111]
    ds_read_b64_tr_b16 v[192:193], v4 offset:20480
    ds_read_b64_tr_b16 v[194:195], v4 offset:22528
    v_mfma_f32_32x32x16_bf16 v[112:127], v[164:167], a[44:47], v[112:127]
    ds_read_b64_tr_b16 v[196:197], v5 offset:20480
    ds_read_b64_tr_b16 v[198:199], v5 offset:22528
    v_mfma_f32_32x32x16_bf16 v[128:143], v[168:171], a[44:47], v[128:143]
    ds_read_b64_tr_b16 v[200:201], v6 offset:20480
    ds_read_b64_tr_b16 v[202:203], v6 offset:22528
    v_mfma_f32_32x32x16_bf16 v[144:159], v[172:175], a[44:47], v[144:159]
    ds_read_b64_tr_b16 v[204:205], v7 offset:20480
    ds_read_b64_tr_b16 v[206:207], v7 offset:22528
    s_waitcnt lgkmcnt(8)
    v_mfma_f32_32x32x16_bf16 v[96:111], v[176:179], a[48:51], v[96:111]
    ds_read_b64_tr_b16 v[160:161], v4 offset:24576
    ds_read_b64_tr_b16 v[162:163], v4 offset:26624
    v_mfma_f32_32x32x16_bf16 v[112:127], v[180:183], a[48:51], v[112:127]
    ds_read_b64_tr_b16 v[164:165], v5 offset:24576
    ds_read_b64_tr_b16 v[166:167], v5 offset:26624
    v_mfma_f32_32x32x16_bf16 v[128:143], v[184:187], a[48:51], v[128:143]
    ds_read_b64_tr_b16 v[168:169], v6 offset:24576
    ds_read_b64_tr_b16 v[170:171], v6 offset:26624
    v_mfma_f32_32x32x16_bf16 v[144:159], v[188:191], a[48:51], v[144:159]
    ds_read_b64_tr_b16 v[172:173], v7 offset:24576
    ds_read_b64_tr_b16 v[174:175], v7 offset:26624
    s_waitcnt lgkmcnt(8)
    v_mfma_f32_32x32x16_bf16 v[96:111], v[192:195], a[52:55], v[96:111]
    ds_read_b64_tr_b16 v[176:177], v4 offset:28672
    ds_read_b64_tr_b16 v[178:179], v4 offset:30720
    v_mfma_f32_32x32x16_bf16 v[112:127], v[196:199], a[52:55], v[112:127]
    ds_read_b64_tr_b16 v[180:181], v5 offset:28672
    ds_read_b64_tr_b16 v[182:183], v5 offset:30720
    v_mfma_f32_32x32x16_bf16 v[128:143], v[200:203], a[52:55], v[128:143]
    ds_read_b64_tr_b16 v[184:185], v6 offset:28672
    ds_read_b64_tr_b16 v[186:187], v6 offset:30720
    v_mfma_f32_32x32x16_bf16 v[144:159], v[204:207], a[52:55], v[144:159]
    ds_read_b64_tr_b16 v[188:189], v7 offset:28672
    ds_read_b64_tr_b16 v[190:191], v7 offset:30720
    s_waitcnt lgkmcnt(8)
    v_mfma_f32_32x32x16_bf16 v[96:111], v[160:163], a[56:59], v[96:111]
    v_mfma_f32_32x32x16_bf16 v[112:127], v[164:167], a[56:59], v[112:127]
    v_mfma_f32_32x32x16_bf16 v[128:143], v[168:171], a[56:59], v[128:143]
    v_mfma_f32_32x32x16_bf16 v[144:159], v[172:175], a[56:59], v[144:159]
    s_waitcnt lgkmcnt(0)
    v_mfma_f32_32x32x16_bf16 v[96:111], v[176:179], a[60:63], v[96:111]
    v_mfma_f32_32x32x16_bf16 v[112:127], v[180:183], a[60:63], v[112:127]
    v_mfma_f32_32x32x16_bf16 v[128:143], v[184:187], a[60:63], v[128:143]
    v_mfma_f32_32x32x16_bf16 v[144:159], v[188:191], a[60:63], v[144:159]
    s_cmp_gt_u32 s89, 2
    s_cbranch_scc1 K1_B34_OK
K1_B34:
    ds_read_b32 v58, v18 offset:48
    s_waitcnt lgkmcnt(0)
    v_readfirstlane_b32 s82, v58
    s_nop 0
    s_lshr_b32 s82, s82, s44
    s_and_b32 s50, s82, s83
    s_cbranch_scc0 K1_B34
    s_ff1_i32_b32 s84, s50
    s_bitset0_b32 s83, s84
    s_lshr_b32 s84, s84, 2
    s_mul_i32 s48, s84, 24576
    s_add_u32 s48, s48, s88
    s_add_u32 s49, s48, 4096
    buffer_load_dwordx4 a[64:67], v54, s[40:43], s48 offen offset:0 sc1
    buffer_load_dwordx4 a[68:71], v54, s[40:43], s48 offen offset:1024 sc1
    buffer_load_dwordx4 a[72:75], v54, s[40:43], s48 offen offset:2048 sc1
    buffer_load_dwordx4 a[76:79], v54, s[40:43], s48 offen offset:3072 sc1
    buffer_load_dwordx4 a[80:83], v54, s[40:43], s49 offen offset:0 sc1
    buffer_load_dwordx4 a[84:87], v54, s[40:43], s49 offen offset:1024 sc1
    buffer_load_dwordx4 a[88:91], v54, s[40:43], s49 offen offset:2048 sc1
    buffer_load_dwordx4 a[92:95], v54, s[40:43], s49 offen offset:3072 sc1
    s_sub_u32 s92, s84, s81
    s_and_b32 s92, s92, 3
    s_lshl_b32 s92, s92, 14
    s_mov_b32 s89, 3
K1_B34_OK:
    s_mov_b32 s87, s92
    s_lshr_b32 s51, s87, 13
    s_add_u32 s51, s51, 2
    s_sub_u32 s48, s87, 81920
    s_add_u32 s49, s87, -8192
    v_add_u32 v4, s48, v28
    v_add_u32 v20, s49, v28
    v_add_u32 v5, s48, v29
    v_add_u32 v21, s49, v29
    v_add_u32 v6, s48, v30
    v_add_u32 v22, s49, v30
    v_add_u32 v7, s48, v31
    v_add_u32 v23, s49, v31
    s_cmp_ge_u32 s59, s51
    s_cbranch_scc1 K1_L35_OK
K1_L35:
    ds_read_b32 v58, v18 offset:36
    s_waitcnt lgkmcnt(0)
    v_readfirstlane_b32 s59, v58
    s_cmp_ge_u32 s59, s51
    s_cbranch_scc0 K1_L35
K1_L35_OK:
    ds_read_b64_tr_b16 v[160:161], v20 offset:0
    ds_read_b64_tr_b16 v[162:163], v20 offset:2048
    ds_read_b64_tr_b16 v[164:165], v21 offset:0
    ds_read_b64_tr_b16 v[166:167], v21 offset:2048
    ds_read_b64_tr_b16 v[168:169], v22 offset:0
    ds_read_b64_tr_b16 v[170:171], v22 offset:2048
    ds_read_b64_tr_b16 v[172:173], v23 offset:0
    ds_read_b64_tr_b16 v[174:175], v23 offset:2048
    ds_read_b64_tr_b16 v[176:177], v20 offset:4096
    ds_read_b64_tr_b16 v[178:179], v20 offset:6144
    ds_read_b64_tr_b16 v[180:181], v21 offset:4096
    ds_read_b64_tr_b16 v[182:183], v21 offset:6144
    ds_read_b64_tr_b16 v[184:185], v22 offset:4096
    ds_read_b64_tr_b16 v[186:187], v22 offset:6144
    ds_read_b64_tr_b16 v[188:189], v23 offset:4096
    ds_read_b64_tr_b16 v[190:191], v23 offset:6144
    s_waitcnt vmcnt(0)
    s_waitcnt lgkmcnt(8)
    v_mfma_f32_32x32x16_bf16 v[96:111], v[160:163], a[64:67], v[96:111]
    ds_read_b64_tr_b16 v[192:193], v20 offset:8192
    ds_read_b64_tr_b16 v[194:195], v20 offset:10240
    v_mfma_f32_32x32x16_bf16 v[112:127], v[164:167], a[64:67], v[112:127]
    ds_read_b64_tr_b16 v[196:197], v21 offset:8192
    ds_read_b64_tr_b16 v[198:199], v21 offset:10240
    v_mfma_f32_32x32x16_bf16 v[128:143], v[168:171], a[64:67], v[128:143]
    ds_read_b64_tr_b16 v[200:201], v22 offset:8192
    ds_read_b64_tr_b16 v[202:203], v22 offset:10240
    v_mfma_f32_32x32x16_bf16 v[144:159], v[172:175], a[64:67], v[144:159]
    ds_read_b64_tr_b16 v[204:205], v23 offset:8192
    ds_read_b64_tr_b16 v[206:207], v23 offset:10240
    s_waitcnt lgkmcnt(8)
    v_mfma_f32_32x32x16_bf16 v[96:111], v[176:179], a[68:71], v[96:111]
    ds_read_b64_tr_b16 v[160:161], v20 offset:12288
    ds_read_b64_tr_b16 v[162:163], v20 offset:14336
    v_mfma_f32_32x32x16_bf16 v[112:127], v[180:183], a[68:71], v[112:127]
    ds_read_b64_tr_b16 v[164:165], v21 offset:12288
    ds_read_b64_tr_b16 v[166:167], v21 offset:14336
    v_mfma_f32_32x32x16_bf16 v[128:143], v[184:187], a[68:71], v[128:143]
    ds_read_b64_tr_b16 v[168:169], v22 offset:12288
    ds_read_b64_tr_b16 v[170:171], v22 offset:14336
    v_mfma_f32_32x32x16_bf16 v[144:159], v[188:191], a[68:71], v[144:159]
    ds_read_b64_tr_b16 v[172:173], v23 offset:12288
    ds_read_b64_tr_b16 v[174:175], v23 offset:14336
    s_waitcnt lgkmcnt(8)
    v_mfma_f32_32x32x16_bf16 v[96:111], v[192:195], a[72:75], v[96:111]
    ds_read_b64_tr_b16 v[176:177], v4 offset:16384
    ds_read_b64_tr_b16 v[178:179], v4 offset:18432
    v_mfma_f32_32x32x16_bf16 v[112:127], v[196:199], a[72:75], v[112:127]
    ds_read_b64_tr_b16 v[180:181], v5 offset:16384
    ds_read_b64_tr_b16 v[182:183], v5 offset:18432
    v_mfma_f32_32x32x16_bf16 v[128:143], v[200:203], a[72:75], v[128:143]
    ds_read_b64_tr_b16 v[184:185], v6 offset:16384
    ds_read_b64_tr_b16 v[186:187], v6 offset:18432
    v_mfma_f32_32x32x16_bf16 v[144:159], v[204:207], a[72:75], v[144:159]
    ds_read_b64_tr_b16 v[188:189], v7 offset:16384
    ds_read_b64_tr_b16 v[190:191], v7 offset:18432
    s_waitcnt lgkmcnt(8)
    v_mfma_f32_32x32x16_bf16 v[96:111], v[160:163], a[76:79], v[96:111]
    ds_read_b64_tr_b16 v[192:193], v4 offset:20480
    ds_read_b64_tr_b16 v[194:195], v4 offset:22528
    v_mfma_f32_32x32x16_bf16 v[112:127], v[164:167], a[76:79], v[112:127]
    ds_read_b64_tr_b16 v[196:197], v5 offset:20480
    ds_read_b64_tr_b16 v[198:199], v5 offset:22528
    v_mfma_f32_32x32x16_bf16 v[128:143], v[168:171], a[76:79], v[128:143]
    ds_read_b64_tr_b16 v[200:201], v6 offset:20480
    ds_read_b64_tr_b16 v[202:203], v6 offset:22528
    v_mfma_f32_32x32x16_bf16 v[144:159], v[172:175], a[76:79], v[144:159]
    ds_read_b64_tr_b16 v[204:205], v7 offset:20480
    ds_read_b64_tr_b16 v[206:207], v7 offset:22528
    s_waitcnt lgkmcnt(8)
    v_mfma_f32_32x32x16_bf16 v[96:111], v[176:179], a[80:83], v[96:111]
    ds_read_b64_tr_b16 v[160:161], v4 offset:24576
    ds_read_b64_tr_b16 v[162:163], v4 offset:26624
    v_mfma_f32_32x32x16_bf16 v[112:127], v[180:183], a[80:83], v[112:127]
    ds_read_b64_tr_b16 v[164:165], v5 offset:24576
    ds_read_b64_tr_b16 v[166:167], v5 offset:26624
    v_mfma_f32_32x32x16_bf16 v[128:143], v[184:187], a[80:83], v[128:143]
    ds_read_b64_tr_b16 v[168:169], v6 offset:24576
    ds_read_b64_tr_b16 v[170:171], v6 offset:26624
    v_mfma_f32_32x32x16_bf16 v[144:159], v[188:191], a[80:83], v[144:159]
    ds_read_b64_tr_b16 v[172:173], v7 offset:24576
    ds_read_b64_tr_b16 v[174:175], v7 offset:26624
    s_waitcnt lgkmcnt(8)
    v_mfma_f32_32x32x16_bf16 v[96:111], v[192:195], a[84:87], v[96:111]
    ds_read_b64_tr_b16 v[176:177], v4 offset:28672
    ds_read_b64_tr_b16 v[178:179], v4 offset:30720
    v_mfma_f32_32x32x16_bf16 v[112:127], v[196:199], a[84:87], v[112:127]
    ds_read_b64_tr_b16 v[180:181], v5 offset:28672
    ds_read_b64_tr_b16 v[182:183], v5 offset:30720
    v_mfma_f32_32x32x16_bf16 v[128:143], v[200:203], a[84:87], v[128:143]
    ds_read_b64_tr_b16 v[184:185], v6 offset:28672
    ds_read_b64_tr_b16 v[186:187], v6 offset:30720
    v_mfma_f32_32x32x16_bf16 v[144:159], v[204:207], a[84:87], v[144:159]
    ds_read_b64_tr_b16 v[188:189], v7 offset:28672
    ds_read_b64_tr_b16 v[190:191], v7 offset:30720
    s_waitcnt lgkmcnt(8)
    v_mfma_f32_32x32x16_bf16 v[96:111], v[160:163], a[88:91], v[96:111]
    v_mfma_f32_32x32x16_bf16 v[112:127], v[164:167], a[88:91], v[112:127]
    v_mfma_f32_32x32x16_bf16 v[128:143], v[168:171], a[88:91], v[128:143]
    v_mfma_f32_32x32x16_bf16 v[144:159], v[172:175], a[88:91], v[144:159]
    s_waitcnt lgkmcnt(0)
    v_mfma_f32_32x32x16_bf16 v[96:111], v[176:179], a[92:95], v[96:111]
    v_mfma_f32_32x32x16_bf16 v[112:127], v[180:183], a[92:95], v[112:127]
    v_mfma_f32_32x32x16_bf16 v[128:143], v[184:187], a[92:95], v[128:143]
    v_mfma_f32_32x32x16_bf16 v[144:159], v[188:191], a[92:95], v[144:159]
K1_TZ:
    s_lshl_b32 s88, s45, 2
    s_add_u32 s88, s88, s81
    s_mul_i32 s88, s88, 196608
    s_add_u32 s88, s88, 33554432
    s_lshl_b32 s49, s44, 10
    s_add_u32 s88, s88, s49
    s_mul_i32 s48, s80, 3072
    s_add_u32 s48, s48, s88
    s_nop 7
    s_nop 3
    v_cvt_pk_bf16_f32 v216, v96, v97
    v_cvt_pk_bf16_f32 v217, v98, v99
    v_cvt_pk_bf16_f32 v218, v100, v101
    v_cvt_pk_bf16_f32 v219, v102, v103
    buffer_store_dwordx4 v[216:219], v54, s[40:43], s48 offen sc1
    s_add_u32 s48, s48, 24576
    v_cvt_pk_bf16_f32 v220, v104, v105
    v_cvt_pk_bf16_f32 v221, v106, v107
    v_cvt_pk_bf16_f32 v222, v108, v109
    v_cvt_pk_bf16_f32 v223, v110, v111
    buffer_store_dwordx4 v[220:223], v54, s[40:43], s48 offen sc1
    s_add_u32 s48, s48, 24576
    v_cvt_pk_bf16_f32 v224, v112, v113
    v_cvt_pk_bf16_f32 v225, v114, v115
    v_cvt_pk_bf16_f32 v226, v116, v117
    v_cvt_pk_bf16_f32 v227, v118, v119
    buffer_store_dwordx4 v[224:227], v54, s[40:43], s48 offen sc1
    s_add_u32 s48, s48, 24576
    v_cvt_pk_bf16_f32 v228, v120, v121
    v_cvt_pk_bf16_f32 v229, v122, v123
    v_cvt_pk_bf16_f32 v230, v124, v125
    v_cvt_pk_bf16_f32 v231, v126, v127
    buffer_store_dwordx4 v[228:231], v54, s[40:43], s48 offen sc1
    s_add_u32 s48, s48, 24576
    v_cvt_pk_bf16_f32 v232, v128, v129
    v_cvt_pk_bf16_f32 v233, v130, v131
    v_cvt_pk_bf16_f32 v234, v132, v133
    v_cvt_pk_bf16_f32 v235, v134, v135
    buffer_store_dwordx4 v[232:235], v54, s[40:43], s48 offen sc1
    s_add_u32 s48, s48, 24576
    v_cvt_pk_bf16_f32 v236, v136, v137
    v_cvt_pk_bf16_f32 v237, v138, v139
    v_cvt_pk_bf16_f32 v238, v140, v141
    v_cvt_pk_bf16_f32 v239, v142, v143
    buffer_store_dwordx4 v[236:239], v54, s[40:43], s48 offen sc1
    s_add_u32 s48, s48, 24576
    v_cvt_pk_bf16_f32 v240, v144, v145
    v_cvt_pk_bf16_f32 v241, v146, v147
    v_cvt_pk_bf16_f32 v242, v148, v149
    v_cvt_pk_bf16_f32 v243, v150, v151
    buffer_store_dwordx4 v[240:243], v54, s[40:43], s48 offen sc1
    s_add_u32 s48, s48, 24576
    v_cvt_pk_bf16_f32 v244, v152, v153
    v_cvt_pk_bf16_f32 v245, v154, v155
    v_cvt_pk_bf16_f32 v246, v156, v157
    v_cvt_pk_bf16_f32 v247, v158, v159
    buffer_store_dwordx4 v[244:247], v54, s[40:43], s48 offen sc1
    s_add_u32 s48, s48, 24576
    v_and_b32 v16, 7, v0
    v_lshlrev_b32 v16, 7, v16
    s_andn2_b32 s48, s2, 7
    s_lshl_b32 s48, s48, 7
    s_lshl_b32 s49, s80, 2
    s_add_u32 s48, s48, s49
    s_add_u32 s48, s48, 7340048
    s_add_u32 s48, s48, s44
    s_waitcnt vmcnt(0)
    s_mov_b64 exec, 255
    buffer_store_byte v12, v16, s[40:43], s48 offen sc1
    s_mov_b64 exec, -1
    s_mul_i32 s48, s80, 24576
    s_add_u32 s88, s88, s48
    s_add_u32 s51, s44, 16
K1_ZP:
    ds_read_b64 v[58:59], v18 offset:48
    s_waitcnt lgkmcnt(0)
    v_readfirstlane_b32 s82, v58
    v_readfirstlane_b32 s83, v59
    s_lshr_b64 s[82:83], s[82:83], s51
    s_and_b32 s50, s82, 0x11111111
    s_cmp_eq_u32 s50, 0x11111111
    s_cbranch_scc0 K1_ZP
K1_ZG:
    buffer_load_dwordx4 v[96:99], v54, s[40:43], s88 offen sc1
    s_add_u32 s88, s88, 3072
    buffer_load_dwordx4 v[100:103], v54, s[40:43], s88 offen sc1
    s_add_u32 s88, s88, 3072
    buffer_load_dwordx4 v[104:107], v54, s[40:43], s88 offen sc1
    s_add_u32 s88, s88, 3072
    buffer_load_dwordx4 v[108:111], v54, s[40:43], s88 offen sc1
    s_add_u32 s88, s88, 3072
    buffer_load_dwordx4 v[112:115], v54, s[40:43], s88 offen sc1
    s_add_u32 s88, s88, 3072
    buffer_load_dwordx4 v[116:119], v54, s[40:43], s88 offen sc1
    s_add_u32 s88, s88, 3072
    buffer_load_dwordx4 v[120:123], v54, s[40:43], s88 offen sc1
    s_add_u32 s88, s88, 3072
    buffer_load_dwordx4 v[124:127], v54, s[40:43], s88 offen sc1
    s_add_u32 s88, s88, 3072
    v_and_b32 v3, 31, v0
    v_lshlrev_b32 v3, 10, v3
    v_lshrrev_b32 v16, 5, v0
    v_lshl_add_u32 v3, v16, 3, v3
    s_lshl_b32 s48, s81, 8
    s_lshl_b32 s49, s80, 5
    s_add_u32 s48, s48, s49
    s_add_u32 s48, s48, s54
    s_mov_b32 s49, 0xffff0000
    s_waitcnt vmcnt(7)
    v_lshlrev_b32 v160, 16, v96
    v_and_b32 v161, s49, v96
    v_lshlrev_b32 v162, 16, v97
    v_and_b32 v163, s49, v97
    v_lshlrev_b32 v164, 16, v98
    v_and_b32 v165, s49, v98
    v_lshlrev_b32 v166, 16, v99
    v_and_b32 v167, s49, v99
    s_waitcnt vmcnt(6)
    v_lshlrev_b32 v170, 16, v100
    v_and_b32 v171, s49, v100
    v_add_f32 v160, v160, v170
    v_add_f32 v161, v161, v171
    v_lshlrev_b32 v170, 16, v101
    v_and_b32 v171, s49, v101
    v_add_f32 v162, v162, v170
    v_add_f32 v163, v163, v171
    v_lshlrev_b32 v170, 16, v102
    v_and_b32 v171, s49, v102
    v_add_f32 v164, v164, v170
    v_add_f32 v165, v165, v171
    v_lshlrev_b32 v170, 16, v103
    v_and_b32 v171, s49, v103
    v_add_f32 v166, v166, v170
    v_add_f32 v167, v167, v171
    s_waitcnt vmcnt(5)
    v_lshlrev_b32 v170, 16, v104
    v_and_b32 v171, s49, v104
    v_add_f32 v160, v160, v170
    v_add_f32 v161, v161, v171
    v_lshlrev_b32 v170, 16, v105
    v_and_b32 v171, s49, v105
    v_add_f32 v162, v162, v170
    v_add_f32 v163, v163, v171
    v_lshlrev_b32 v170, 16, v106
    v_and_b32 v171, s49, v106
    v_add_f32 v164, v164, v170
    v_add_f32 v165, v165, v171
    v_lshlrev_b32 v170, 16, v107
    v_and_b32 v171, s49, v107
    v_add_f32 v166, v166, v170
    v_add_f32 v167, v167, v171
    s_waitcnt vmcnt(4)
    v_lshlrev_b32 v170, 16, v108
    v_and_b32 v171, s49, v108
    v_add_f32 v160, v160, v170
    v_add_f32 v161, v161, v171
    v_lshlrev_b32 v170, 16, v109
    v_and_b32 v171, s49, v109
    v_add_f32 v162, v162, v170
    v_add_f32 v163, v163, v171
    v_lshlrev_b32 v170, 16, v110
    v_and_b32 v171, s49, v110
    v_add_f32 v164, v164, v170
    v_add_f32 v165, v165, v171
    v_lshlrev_b32 v170, 16, v111
    v_and_b32 v171, s49, v111
    v_add_f32 v166, v166, v170
    v_add_f32 v167, v167, v171
    s_waitcnt vmcnt(3)
    v_lshlrev_b32 v170, 16, v112
    v_and_b32 v171, s49, v112
    v_add_f32 v160, v160, v170
    v_add_f32 v161, v161, v171
    v_lshlrev_b32 v170, 16, v113
    v_and_b32 v171, s49, v113
    v_add_f32 v162, v162, v170
    v_add_f32 v163, v163, v171
    v_lshlrev_b32 v170, 16, v114
    v_and_b32 v171, s49, v114
    v_add_f32 v164, v164, v170
    v_add_f32 v165, v165, v171
    v_lshlrev_b32 v170, 16, v115
    v_and_b32 v171, s49, v115
    v_add_f32 v166, v166, v170
    v_add_f32 v167, v167, v171
    s_waitcnt vmcnt(2)
    v_lshlrev_b32 v170, 16, v116
    v_and_b32 v171, s49, v116
    v_add_f32 v160, v160, v170
    v_add_f32 v161, v161, v171
    v_lshlrev_b32 v170, 16, v117
    v_and_b32 v171, s49, v117
    v_add_f32 v162, v162, v170
    v_add_f32 v163, v163, v171
    v_lshlrev_b32 v170, 16, v118
    v_and_b32 v171, s49, v118
    v_add_f32 v164, v164, v170
    v_add_f32 v165, v165, v171
    v_lshlrev_b32 v170, 16, v119
    v_and_b32 v171, s49, v119
    v_add_f32 v166, v166, v170
    v_add_f32 v167, v167, v171
    s_waitcnt vmcnt(1)
    v_lshlrev_b32 v170, 16, v120
    v_and_b32 v171, s49, v120
    v_add_f32 v160, v160, v170
    v_add_f32 v161, v161, v171
    v_lshlrev_b32 v170, 16, v121
    v_and_b32 v171, s49, v121
    v_add_f32 v162, v162, v170
    v_add_f32 v163, v163, v171
    v_lshlrev_b32 v170, 16, v122
    v_and_b32 v171, s49, v122
    v_add_f32 v164, v164, v170
    v_add_f32 v165, v165, v171
    v_lshlrev_b32 v170, 16, v123
    v_and_b32 v171, s49, v123
    v_add_f32 v166, v166, v170
    v_add_f32 v167, v167, v171
    s_waitcnt vmcnt(0)
    v_lshlrev_b32 v170, 16, v124
    v_and_b32 v171, s49, v124
    v_add_f32 v160, v160, v170
    v_add_f32 v161, v161, v171
    v_lshlrev_b32 v170, 16, v125
    v_and_b32 v171, s49, v125
    v_add_f32 v162, v162, v170
    v_add_f32 v163, v163, v171
    v_lshlrev_b32 v170, 16, v126
    v_and_b32 v171, s49, v126
    v_add_f32 v164, v164, v170
    v_add_f32 v165, v165, v171
    v_lshlrev_b32 v170, 16, v127
    v_and_b32 v171, s49, v127
    v_add_f32 v166, v166, v170
    v_add_f32 v167, v167, v171
    v_cvt_pk_bf16_f32 v240, v160, v161
    v_cvt_pk_bf16_f32 v241, v162, v163
    buffer_store_dwordx2 v[240:241], v3, s[28:31], s48 offen offset:0
    v_cvt_pk_bf16_f32 v242, v164, v165
    v_cvt_pk_bf16_f32 v243, v166, v167
    buffer_store_dwordx2 v[242:243], v3, s[28:31], s48 offen offset:16
    s_branch K1_FIN
K1_RARE0:
    s_call_b64 s[48:49], K1_RAREP0
    s_branch K1_CK0
K1_RARE1:
    s_call_b64 s[48:49], K1_RAREP1
    s_branch K1_CK1
K1_RARE2:
    s_call_b64 s[48:49], K1_RAREP0
    s_branch K1_CK2
K1_RARE3:
    s_call_b64 s[48:49], K1_RAREP1
    s_branch K1_CK3
K1_RARE4:
    s_call_b64 s[48:49], K1_RAREP0
    s_branch K1_CK4
K1_RARE5:
    s_call_b64 s[48:49], K1_RAREP1
    s_branch K1_CK5
K1_RARE6:
    s_call_b64 s[48:49], K1_RAREP0
    s_branch K1_CK6
K1_RARE7:
    s_call_b64 s[48:49], K1_RAREP1
    s_branch K1_CK7
K1_RARE8:
    s_call_b64 s[48:49], K1_RAREP1
    s_branch K1_CK8
K1_RAREP0:
    v_max3_f32 v51, v160, v161, v162
    v_max3_f32 v51, v51, v163, v164
    v_max3_f32 v51, v51, v165, v166
    v_max3_f32 v51, v51, v167, v168
    v_max3_f32 v51, v51, v169, v170
    v_max3_f32 v51, v51, v171, v172
    v_max3_f32 v51, v51, v173, v174
    v_max_f32 v51, v51, v175
    v_mov_b32 v52, v51
    s_nop 1
    v_permlane32_swap_b32 v51, v52
    v_max_f32 v51, v51, v52
    v_mul_f32 v51, s52, v51
    v_sub_f32 v51, 0, v51
    v_min_f32 v51, v48, v51
    v_sub_f32 v53, v51, v48
    v_exp_f32 v53, v53
    v_mov_b32 v48, v51
    v_mul_f32 v49, v49, v53
    v_mul_f32 v96, v96, v53
    v_mul_f32 v97, v97, v53
    v_mul_f32 v98, v98, v53
    v_mul_f32 v99, v99, v53
    v_mul_f32 v100, v100, v53
    v_mul_f32 v101, v101, v53
    v_mul_f32 v102, v102, v53
    v_mul_f32 v103, v103, v53
    v_mul_f32 v104, v104, v53
    v_mul_f32 v105, v105, v53
    v_mul_f32 v106, v106, v53
    v_mul_f32 v107, v107, v53
    v_mul_f32 v108, v108, v53
    v_mul_f32 v109, v109, v53
    v_mul_f32 v110, v110, v53
    v_mul_f32 v111, v111, v53
    v_mul_f32 v112, v112, v53
    v_mul_f32 v113, v113, v53
    v_mul_f32 v114, v114, v53
    v_mul_f32 v115, v115, v53
    v_mul_f32 v116, v116, v53
    v_mul_f32 v117, v117, v53
    v_mul_f32 v118, v118, v53
    v_mul_f32 v119, v119, v53
    v_mul_f32 v120, v120, v53
    v_mul_f32 v121, v121, v53
    v_mul_f32 v122, v122, v53
    v_mul_f32 v123, v123, v53
    v_mul_f32 v124, v124, v53
    v_mul_f32 v125, v125, v53
    v_mul_f32 v126, v126, v53
    v_mul_f32 v127, v127, v53
    v_mul_f32 v128, v128, v53
    v_mul_f32 v129, v129, v53
    v_mul_f32 v130, v130, v53
    v_mul_f32 v131, v131, v53
    v_mul_f32 v132, v132, v53
    v_mul_f32 v133, v133, v53
    v_mul_f32 v134, v134, v53
    v_mul_f32 v135, v135, v53
    v_mul_f32 v136, v136, v53
    v_mul_f32 v137, v137, v53
    v_mul_f32 v138, v138, v53
    v_mul_f32 v139, v139, v53
    v_mul_f32 v140, v140, v53
    v_mul_f32 v141, v141, v53
    v_mul_f32 v142, v142, v53
    v_mul_f32 v143, v143, v53
    v_mul_f32 v144, v144, v53
    v_mul_f32 v145, v145, v53
    v_mul_f32 v146, v146, v53
    v_mul_f32 v147, v147, v53
    v_mul_f32 v148, v148, v53
    v_mul_f32 v149, v149, v53
    v_mul_f32 v150, v150, v53
    v_mul_f32 v151, v151, v53
    v_mul_f32 v152, v152, v53
    v_mul_f32 v153, v153, v53
    v_mul_f32 v154, v154, v53
    v_mul_f32 v155, v155, v53
    v_mul_f32 v156, v156, v53
    v_mul_f32 v157, v157, v53
    v_mul_f32 v158, v158, v53
    v_mul_f32 v159, v159, v53
    v_fma_f32 v192, v160, s52, v48
    v_fma_f32 v193, v161, s52, v48
    v_fma_f32 v194, v162, s52, v48
    v_fma_f32 v195, v163, s52, v48
    v_fma_f32 v196, v164, s52, v48
    v_fma_f32 v197, v165, s52, v48
    v_fma_f32 v198, v166, s52, v48
    v_fma_f32 v199, v167, s52, v48
    v_fma_f32 v200, v168, s52, v48
    v_fma_f32 v201, v169, s52, v48
    v_fma_f32 v202, v170, s52, v48
    v_fma_f32 v203, v171, s52, v48
    v_fma_f32 v204, v172, s52, v48
    v_fma_f32 v205, v173, s52, v48
    v_fma_f32 v206, v174, s52, v48
    v_fma_f32 v207, v175, s52, v48
    v_exp_f32 v192, v192
    v_exp_f32 v193, v193
    v_exp_f32 v194, v194
    v_exp_f32 v195, v195
    v_exp_f32 v196, v196
    v_exp_f32 v197, v197
    v_exp_f32 v198, v198
    v_exp_f32 v199, v199
    v_exp_f32 v200, v200
    v_exp_f32 v201, v201
    v_exp_f32 v202, v202
    v_exp_f32 v203, v203
    v_exp_f32 v204, v204
    v_exp_f32 v205, v205
    v_exp_f32 v206, v206
    v_exp_f32 v207, v207
    s_nop 0
    v_add_f32 v50, v192, v193
    v_add_f32 v51, v194, v195
    v_add_f32 v50, v50, v196
    v_add_f32 v51, v51, v197
    v_add_f32 v50, v50, v198
    v_add_f32 v51, v51, v199
    v_add_f32 v50, v50, v200
    v_add_f32 v51, v51, v201
    v_add_f32 v50, v50, v202
    v_add_f32 v51, v51, v203
    v_add_f32 v50, v50, v204
    v_add_f32 v51, v51, v205
    v_add_f32 v50, v50, v206
    v_add_f32 v51, v51, v207
    v_add_f32 v50, v50, v51
    s_setpc_b64 s[48:49]
K1_RAREP1:
    v_max3_f32 v51, v176, v177, v178
    v_max3_f32 v51, v51, v179, v180
    v_max3_f32 v51, v51, v181, v182
    v_max3_f32 v51, v51, v183, v184
    v_max3_f32 v51, v51, v185, v186
    v_max3_f32 v51, v51, v187, v188
    v_max3_f32 v51, v51, v189, v190
    v_max_f32 v51, v51, v191
    v_mov_b32 v52, v51
    s_nop 1
    v_permlane32_swap_b32 v51, v52
    v_max_f32 v51, v51, v52
    v_mul_f32 v51, s52, v51
    v_sub_f32 v51, 0, v51
    v_min_f32 v51, v48, v51
    v_sub_f32 v53, v51, v48
    v_exp_f32 v53, v53
    v_mov_b32 v48, v51
    v_mul_f32 v49, v49, v53
    v_mul_f32 v96, v96, v53
    v_mul_f32 v97, v97, v53
    v_mul_f32 v98, v98, v53
    v_mul_f32 v99, v99, v53
    v_mul_f32 v100, v100, v53
    v_mul_f32 v101, v101, v53
    v_mul_f32 v102, v102, v53
    v_mul_f32 v103, v103, v53
    v_mul_f32 v104, v104, v53
    v_mul_f32 v105, v105, v53
    v_mul_f32 v106, v106, v53
    v_mul_f32 v107, v107, v53
    v_mul_f32 v108, v108, v53
    v_mul_f32 v109, v109, v53
    v_mul_f32 v110, v110, v53
    v_mul_f32 v111, v111, v53
    v_mul_f32 v112, v112, v53
    v_mul_f32 v113, v113, v53
    v_mul_f32 v114, v114, v53
    v_mul_f32 v115, v115, v53
    v_mul_f32 v116, v116, v53
    v_mul_f32 v117, v117, v53
    v_mul_f32 v118, v118, v53
    v_mul_f32 v119, v119, v53
    v_mul_f32 v120, v120, v53
    v_mul_f32 v121, v121, v53
    v_mul_f32 v122, v122, v53
    v_mul_f32 v123, v123, v53
    v_mul_f32 v124, v124, v53
    v_mul_f32 v125, v125, v53
    v_mul_f32 v126, v126, v53
    v_mul_f32 v127, v127, v53
    v_mul_f32 v128, v128, v53
    v_mul_f32 v129, v129, v53
    v_mul_f32 v130, v130, v53
    v_mul_f32 v131, v131, v53
    v_mul_f32 v132, v132, v53
    v_mul_f32 v133, v133, v53
    v_mul_f32 v134, v134, v53
    v_mul_f32 v135, v135, v53
    v_mul_f32 v136, v136, v53
    v_mul_f32 v137, v137, v53
    v_mul_f32 v138, v138, v53
    v_mul_f32 v139, v139, v53
    v_mul_f32 v140, v140, v53
    v_mul_f32 v141, v141, v53
    v_mul_f32 v142, v142, v53
    v_mul_f32 v143, v143, v53
    v_mul_f32 v144, v144, v53
    v_mul_f32 v145, v145, v53
    v_mul_f32 v146, v146, v53
    v_mul_f32 v147, v147, v53
    v_mul_f32 v148, v148, v53
    v_mul_f32 v149, v149, v53
    v_mul_f32 v150, v150, v53
    v_mul_f32 v151, v151, v53
    v_mul_f32 v152, v152, v53
    v_mul_f32 v153, v153, v53
    v_mul_f32 v154, v154, v53
    v_mul_f32 v155, v155, v53
    v_mul_f32 v156, v156, v53
    v_mul_f32 v157, v157, v53
    v_mul_f32 v158, v158, v53
    v_mul_f32 v159, v159, v53
    v_fma_f32 v192, v176, s52, v48
    v_fma_f32 v193, v177, s52, v48
    v_fma_f32 v194, v178, s52, v48
    v_fma_f32 v195, v179, s52, v48
    v_fma_f32 v196, v180, s52, v48
    v_fma_f32 v197, v181, s52, v48
    v_fma_f32 v198, v182, s52, v48
    v_fma_f32 v199, v183, s52, v48
    v_fma_f32 v200, v184, s52, v48
    v_fma_f32 v201, v185, s52, v48
    v_fma_f32 v202, v186, s52, v48
    v_fma_f32 v203, v187, s52, v48
    v_fma_f32 v204, v188, s52, v48
    v_fma_f32 v205, v189, s52, v48
    v_fma_f32 v206, v190, s52, v48
    v_fma_f32 v207, v191, s52, v48
    v_exp_f32 v192, v192
    v_exp_f32 v193, v193
    v_exp_f32 v194, v194
    v_exp_f32 v195, v195
    v_exp_f32 v196, v196
    v_exp_f32 v197, v197
    v_exp_f32 v198, v198
    v_exp_f32 v199, v199
    v_exp_f32 v200, v200
    v_exp_f32 v201, v201
    v_exp_f32 v202, v202
    v_exp_f32 v203, v203
    v_exp_f32 v204, v204
    v_exp_f32 v205, v205
    v_exp_f32 v206, v206
    v_exp_f32 v207, v207
    s_nop 0
    v_add_f32 v50, v192, v193
    v_add_f32 v51, v194, v195
    v_add_f32 v50, v50, v196
    v_add_f32 v51, v51, v197
    v_add_f32 v50, v50, v198
    v_add_f32 v51, v51, v199
    v_add_f32 v50, v50, v200
    v_add_f32 v51, v51, v201
    v_add_f32 v50, v50, v202
    v_add_f32 v51, v51, v203
    v_add_f32 v50, v50, v204
    v_add_f32 v51, v51, v205
    v_add_f32 v50, v50, v206
    v_add_f32 v51, v51, v207
    v_add_f32 v50, v50, v51
    s_setpc_b64 s[48:49]
K1_LOADER:
    v_mov_b32 v20, 0
    v_mov_b32 v21, 0
    v_mov_b32 v22, 0
    v_mov_b32 v23, 0
    ds_write_b128 v18, v[20:23]
    ds_write_b128 v18, v[20:23] offset:16
    ds_write_b128 v18, v[20:23] offset:32
    ds_write_b128 v18, v[20:23] offset:48
    v_xor_b32 v3, v2, v1
    v_xor_b32 v4, 0, v3
    v_lshlrev_b32 v4, 4, v4
    v_lshl_add_u32 v8, v1, 8, v4
    v_xor_b32 v5, 4, v3
    v_lshlrev_b32 v5, 4, v5
    v_lshl_add_u32 v9, v1, 8, v5
    v_xor_b32 v6, 8, v3
    v_lshlrev_b32 v6, 4, v6
    v_lshl_add_u32 v10, v1, 8, v6
    v_xor_b32 v7, 12, v3
    v_lshlrev_b32 v7, 4, v7
    v_lshl_add_u32 v11, v1, 8, v7
    v_lshlrev_b32 v3, 2, v1
    v_xor_b32 v3, v3, v2
    v_lshlrev_b32 v3, 4, v3
    v_lshl_add_u32 v16, v1, 8, v3
    v_lshl_add_u32 v17, v1, 13, v3
    v_lshl_add_u32 v12, v1, 10, v3
    s_lshl_b32 s47, s45, 5
    s_add_u32 s47, s47, s46
    s_lshl_b32 s47, s47, 18
    s_lshl_b32 s55, s46, 8
    s_mov_b32 s59, 0
    s_waitcnt lgkmcnt(0)
    s_barrier
    s_mov_b32 s32, s10
    s_and_b32 s33, s11, 0xffff
    s_mov_b32 s34, 0x400000
    s_mov_b32 s35, 0x20000
    s_mov_b32 s24, s6
    s_and_b32 s25, s7, 0xffff
    s_mov_b32 s26, 0x4000000
    s_mov_b32 s27, 0x20000
    s_mov_b32 s28, s8
    s_and_b32 s29, s9, 0xffff
    s_mov_b32 s30, 0x4000000
    s_mov_b32 s31, 0x20000
    s_mov_b32 s40, s18
    s_and_b32 s41, s19, 0xffff
    s_mov_b32 s42, 0x10000000
    s_mov_b32 s43, 0x20000
    s_mov_b32 s36, s12
    s_and_b32 s37, s13, 0xffff
    s_mov_b32 s38, 0x400000
    s_mov_b32 s39, 0x20000
    v_lshlrev_b32 v24, 4, v0
    v_add_u32 v25, 65536, v24
    s_cmp_eq_u32 s62, 1
    s_cbranch_scc1 K1_LB
    s_add_u32 s49, s55, 0
    s_mov_b32 m0, 131072
    s_nop 0
    buffer_load_dwordx4 v17, s[32:35], s49 offen lds
    s_mov_b32 m0, 132096
    s_add_u32 s49, s49, 32768
    buffer_load_dwordx4 v17, s[32:35], s49 offen lds
    s_mov_b32 m0, 133120
    s_add_u32 s49, s49, 32768
    buffer_load_dwordx4 v17, s[32:35], s49 offen lds
    s_mov_b32 m0, 134144
    s_add_u32 s49, s49, 32768
    buffer_load_dwordx4 v17, s[32:35], s49 offen lds
    s_mov_b32 m0, 135168
    s_add_u32 s49, s49, 32768
    buffer_load_dwordx4 v17, s[32:35], s49 offen lds
    s_mov_b32 m0, 136192
    s_add_u32 s49, s49, 32768
    buffer_load_dwordx4 v17, s[32:35], s49 offen lds
    s_mov_b32 m0, 137216
    s_add_u32 s49, s49, 32768
    buffer_load_dwordx4 v17, s[32:35], s49 offen lds
    s_mov_b32 m0, 138240
    s_add_u32 s49, s49, 32768
    buffer_load_dwordx4 v17, s[32:35], s49 offen lds
    s_mov_b32 m0, 139264
    s_add_u32 s49, s49, 32768
    buffer_load_dwordx4 v17, s[32:35], s49 offen lds
    s_mov_b32 m0, 140288
    s_add_u32 s49, s49, 32768
    buffer_load_dwordx4 v17, s[32:35], s49 offen lds
    s_mov_b32 m0, 141312
    s_add_u32 s49, s49, 32768
    buffer_load_dwordx4 v17, s[32:35], s49 offen lds
    s_mov_b32 m0, 142336
    s_add_u32 s49, s49, 32768
    buffer_load_dwordx4 v17, s[32:35], s49 offen lds
    s_mov_b32 m0, 143360
    s_add_u32 s49, s49, 32768
    buffer_load_dwordx4 v17, s[32:35], s49 offen lds
    s_mov_b32 m0, 144384
    s_add_u32 s49, s49, 32768
    buffer_load_dwordx4 v17, s[32:35], s49 offen lds
    s_mov_b32 m0, 145408
    s_add_u32 s49, s49, 32768
    buffer_load_dwordx4 v17, s[32:35], s49 offen lds
    s_mov_b32 m0, 146432
    s_add_u32 s49, s49, 32768
    buffer_load_dwordx4 v17, s[32:35], s49 offen lds
    s_add_u32 s49, s55, 524288
    s_mov_b32 m0, 147456
    s_nop 0
    buffer_load_dwordx4 v17, s[32:35], s49 offen lds
    s_mov_b32 m0, 148480
    s_add_u32 s49, s49, 32768
    buffer_load_dwordx4 v17, s[32:35], s49 offen lds
    s_mov_b32 m0, 149504
    s_add_u32 s49, s49, 32768
    buffer_load_dwordx4 v17, s[32:35], s49 offen lds
    s_mov_b32 m0, 150528
    s_add_u32 s49, s49, 32768
    buffer_load_dwordx4 v17, s[32:35], s49 offen lds
    s_mov_b32 m0, 151552
    s_add_u32 s49, s49, 32768
    buffer_load_dwordx4 v17, s[32:35], s49 offen lds
    s_mov_b32 m0, 152576
    s_add_u32 s49, s49, 32768
    buffer_load_dwordx4 v17, s[32:35], s49 offen lds
    s_mov_b32 m0, 153600
    s_add_u32 s49, s49, 32768
    buffer_load_dwordx4 v17, s[32:35], s49 offen lds
    s_mov_b32 m0, 154624
    s_add_u32 s49, s49, 32768
    buffer_load_dwordx4 v17, s[32:35], s49 offen lds
    s_mov_b32 m0, 65536
    s_add_u32 s49, s49, 32768
    buffer_load_dwordx4 v17, s[32:35], s49 offen lds
    s_mov_b32 m0, 66560
    s_add_u32 s49, s49, 32768
    buffer_load_dwordx4 v17, s[32:35], s49 offen lds
    s_mov_b32 m0, 67584
    s_add_u32 s49, s49, 32768
    buffer_load_dwordx4 v17, s[32:35], s49 offen lds
    s_mov_b32 m0, 68608
    s_add_u32 s49, s49, 32768
    buffer_load_dwordx4 v17, s[32:35], s49 offen lds
    s_mov_b32 m0, 69632
    s_add_u32 s49, s49, 32768
    buffer_load_dwordx4 v17, s[32:35], s49 offen lds
    s_mov_b32 m0, 70656
    s_add_u32 s49, s49, 32768
    buffer_load_dwordx4 v17, s[32:35], s49 offen lds
    s_mov_b32 m0, 71680
    s_add_u32 s49, s49, 32768
    buffer_load_dwordx4 v17, s[32:35], s49 offen lds
    s_mov_b32 m0, 72704
    s_add_u32 s49, s49, 32768
    buffer_load_dwordx4 v17, s[32:35], s49 offen lds
    s_add_u32 s49, s55, 1048576
    s_mov_b32 m0, 8192
    s_nop 0
    buffer_load_dwordx4 v17, s[32:35], s49 offen lds
    s_mov_b32 m0, 9216
    s_add_u32 s49, s49, 32768
    buffer_load_dwordx4 v17, s[32:35], s49 offen lds
    s_mov_b32 m0, 10240
    s_add_u32 s49, s49, 32768
    buffer_load_dwordx4 v17, s[32:35], s49 offen lds
    s_mov_b32 m0, 11264
    s_add_u32 s49, s49, 32768
    buffer_load_dwordx4 v17, s[32:35], s49 offen lds
    s_mov_b32 m0, 12288
    s_add_u32 s49, s49, 32768
    buffer_load_dwordx4 v17, s[32:35], s49 offen lds
    s_mov_b32 m0, 13312
    s_add_u32 s49, s49, 32768
    buffer_load_dwordx4 v17, s[32:35], s49 offen lds
    s_mov_b32 m0, 14336
    s_add_u32 s49, s49, 32768
    buffer_load_dwordx4 v17, s[32:35], s49 offen lds
    s_mov_b32 m0, 15360
    s_add_u32 s49, s49, 32768
    buffer_load_dwordx4 v17, s[32:35], s49 offen lds
    s_mov_b32 m0, 16384
    s_add_u32 s49, s49, 32768
    buffer_load_dwordx4 v17, s[32:35], s49 offen lds
    s_mov_b32 m0, 17408
    s_add_u32 s49, s49, 32768
    buffer_load_dwordx4 v17, s[32:35], s49 offen lds
    s_mov_b32 m0, 18432
    s_add_u32 s49, s49, 32768
    buffer_load_dwordx4 v17, s[32:35], s49 offen lds
    s_mov_b32 m0, 19456
    s_add_u32 s49, s49, 32768
    buffer_load_dwordx4 v17, s[32:35], s49 offen lds
    s_mov_b32 m0, 20480
    s_add_u32 s49, s49, 32768
    buffer_load_dwordx4 v17, s[32:35], s49 offen lds
    s_mov_b32 m0, 21504
    s_add_u32 s49, s49, 32768
    buffer_load_dwordx4 v17, s[32:35], s49 offen lds
    s_mov_b32 m0, 22528
    s_add_u32 s49, s49, 32768
    buffer_load_dwordx4 v17, s[32:35], s49 offen lds
    s_mov_b32 m0, 23552
    s_add_u32 s49, s49, 32768
    buffer_load_dwordx4 v17, s[32:35], s49 offen lds
    s_waitcnt vmcnt(40)
    s_add_u32 s49, s55, 1572864
    s_mov_b32 m0, 73728
    s_nop 0
    buffer_load_dwordx4 v17, s[32:35], s49 offen lds
    s_mov_b32 m0, 74752
    s_add_u32 s49, s49, 32768
    buffer_load_dwordx4 v17, s[32:35], s49 offen lds
    s_mov_b32 m0, 75776
    s_add_u32 s49, s49, 32768
    buffer_load_dwordx4 v17, s[32:35], s49 offen lds
    s_mov_b32 m0, 76800
    s_add_u32 s49, s49, 32768
    buffer_load_dwordx4 v17, s[32:35], s49 offen lds
    s_mov_b32 m0, 77824
    s_add_u32 s49, s49, 32768
    buffer_load_dwordx4 v17, s[32:35], s49 offen lds
    s_mov_b32 m0, 78848
    s_add_u32 s49, s49, 32768
    buffer_load_dwordx4 v17, s[32:35], s49 offen lds
    s_mov_b32 m0, 79872
    s_add_u32 s49, s49, 32768
    buffer_load_dwordx4 v17, s[32:35], s49 offen lds
    s_mov_b32 m0, 80896
    s_add_u32 s49, s49, 32768
    buffer_load_dwordx4 v17, s[32:35], s49 offen lds
    s_mov_b32 m0, 81920
    s_add_u32 s49, s49, 32768
    buffer_load_dwordx4 v17, s[32:35], s49 offen lds
    s_mov_b32 m0, 82944
    s_add_u32 s49, s49, 32768
    buffer_load_dwordx4 v17, s[32:35], s49 offen lds
    s_mov_b32 m0, 83968
    s_add_u32 s49, s49, 32768
    buffer_load_dwordx4 v17, s[32:35], s49 offen lds
    s_mov_b32 m0, 84992
    s_add_u32 s49, s49, 32768
    buffer_load_dwordx4 v17, s[32:35], s49 offen lds
    s_mov_b32 m0, 86016
    s_add_u32 s49, s49, 32768
    buffer_load_dwordx4 v17, s[32:35], s49 offen lds
    s_mov_b32 m0, 87040
    s_add_u32 s49, s49, 32768
    buffer_load_dwordx4 v17, s[32:35], s49 offen lds
    s_mov_b32 m0, 88064
    s_add_u32 s49, s49, 32768
    buffer_load_dwordx4 v17, s[32:35], s49 offen lds
    s_mov_b32 m0, 89088
    s_add_u32 s49, s49, 32768
    buffer_load_dwordx4 v17, s[32:35], s49 offen lds
    s_waitcnt vmcnt(40)
    v_mov_b32 v26, 1
    ds_write_b32 v18, v26 offset:4
    s_add_u32 s49, s55, 2097152
    s_mov_b32 m0, 24576
    s_nop 0
    buffer_load_dwordx4 v17, s[32:35], s49 offen lds
    s_mov_b32 m0, 25600
    s_add_u32 s49, s49, 32768
    buffer_load_dwordx4 v17, s[32:35], s49 offen lds
    s_mov_b32 m0, 26624
    s_add_u32 s49, s49, 32768
    buffer_load_dwordx4 v17, s[32:35], s49 offen lds
    s_mov_b32 m0, 27648
    s_add_u32 s49, s49, 32768
    buffer_load_dwordx4 v17, s[32:35], s49 offen lds
    s_mov_b32 m0, 28672
    s_add_u32 s49, s49, 32768
    buffer_load_dwordx4 v17, s[32:35], s49 offen lds
    s_mov_b32 m0, 29696
    s_add_u32 s49, s49, 32768
    buffer_load_dwordx4 v17, s[32:35], s49 offen lds
    s_mov_b32 m0, 30720
    s_add_u32 s49, s49, 32768
    buffer_load_dwordx4 v17, s[32:35], s49 offen lds
    s_mov_b32 m0, 31744
    s_add_u32 s49, s49, 32768
    buffer_load_dwordx4 v17, s[32:35], s49 offen lds
    s_mov_b32 m0, 32768
    s_add_u32 s49, s49, 32768
    buffer_load_dwordx4 v17, s[32:35], s49 offen lds
    s_mov_b32 m0, 33792
    s_add_u32 s49, s49, 32768
    buffer_load_dwordx4 v17, s[32:35], s49 offen lds
    s_mov_b32 m0, 34816
    s_add_u32 s49, s49, 32768
    buffer_load_dwordx4 v17, s[32:35], s49 offen lds
    s_mov_b32 m0, 35840
    s_add_u32 s49, s49, 32768
    buffer_load_dwordx4 v17, s[32:35], s49 offen lds
    s_mov_b32 m0, 36864
    s_add_u32 s49, s49, 32768
    buffer_load_dwordx4 v17, s[32:35], s49 offen lds
    s_mov_b32 m0, 37888
    s_add_u32 s49, s49, 32768
    buffer_load_dwordx4 v17, s[32:35], s49 offen lds
    s_mov_b32 m0, 38912
    s_add_u32 s49, s49, 32768
    buffer_load_dwordx4 v17, s[32:35], s49 offen lds
    s_mov_b32 m0, 39936
    s_add_u32 s49, s49, 32768
    buffer_load_dwordx4 v17, s[32:35], s49 offen lds
    s_waitcnt vmcnt(40)
    v_mov_b32 v26, 2
    ds_write_b32 v18, v26 offset:4
    s_add_u32 s49, s55, 2621440
    s_mov_b32 m0, 90112
    s_nop 0
    buffer_load_dwordx4 v17, s[32:35], s49 offen lds
    s_mov_b32 m0, 91136
    s_add_u32 s49, s49, 32768
    buffer_load_dwordx4 v17, s[32:35], s49 offen lds
    s_mov_b32 m0, 92160
    s_add_u32 s49, s49, 32768
    buffer_load_dwordx4 v17, s[32:35], s49 offen lds
    s_mov_b32 m0, 93184
    s_add_u32 s49, s49, 32768
    buffer_load_dwordx4 v17, s[32:35], s49 offen lds
    s_mov_b32 m0, 94208
    s_add_u32 s49, s49, 32768
    buffer_load_dwordx4 v17, s[32:35], s49 offen lds
    s_mov_b32 m0, 95232
    s_add_u32 s49, s49, 32768
    buffer_load_dwordx4 v17, s[32:35], s49 offen lds
    s_mov_b32 m0, 96256
    s_add_u32 s49, s49, 32768
    buffer_load_dwordx4 v17, s[32:35], s49 offen lds
    s_mov_b32 m0, 97280
    s_add_u32 s49, s49, 32768
    buffer_load_dwordx4 v17, s[32:35], s49 offen lds
    s_mov_b32 m0, 98304
    s_add_u32 s49, s49, 32768
    buffer_load_dwordx4 v17, s[32:35], s49 offen lds
    s_mov_b32 m0, 99328
    s_add_u32 s49, s49, 32768
    buffer_load_dwordx4 v17, s[32:35], s49 offen lds
    s_mov_b32 m0, 100352
    s_add_u32 s49, s49, 32768
    buffer_load_dwordx4 v17, s[32:35], s49 offen lds
    s_mov_b32 m0, 101376
    s_add_u32 s49, s49, 32768
    buffer_load_dwordx4 v17, s[32:35], s49 offen lds
    s_mov_b32 m0, 102400
    s_add_u32 s49, s49, 32768
    buffer_load_dwordx4 v17, s[32:35], s49 offen lds
    s_mov_b32 m0, 103424
    s_add_u32 s49, s49, 32768
    buffer_load_dwordx4 v17, s[32:35], s49 offen lds
    s_mov_b32 m0, 104448
    s_add_u32 s49, s49, 32768
    buffer_load_dwordx4 v17, s[32:35], s49 offen lds
    s_mov_b32 m0, 105472
    s_add_u32 s49, s49, 32768
    buffer_load_dwordx4 v17, s[32:35], s49 offen lds
    s_waitcnt vmcnt(40)
    v_mov_b32 v26, 3
    ds_write_b32 v18, v26 offset:4
    s_cmp_ge_u32 s59, 1
    s_cbranch_scc1 K1_P37_OK
K1_P37:
    ds_read_b96 v[28:30], v18 offset:16
    s_waitcnt lgkmcnt(0)
    v_min3_u32 v28, v28, v29, v30
    s_nop 0
    v_readfirstlane_b32 s59, v28
    s_cmp_ge_u32 s59, 1
    s_cbranch_scc0 K1_P37
K1_P37_OK:
    s_add_u32 s49, s55, 3145728
    s_mov_b32 m0, 131072
    s_nop 0
    buffer_load_dwordx4 v17, s[32:35], s49 offen lds
    s_mov_b32 m0, 132096
    s_add_u32 s49, s49, 32768
    buffer_load_dwordx4 v17, s[32:35], s49 offen lds
    s_mov_b32 m0, 133120
    s_add_u32 s49, s49, 32768
    buffer_load_dwordx4 v17, s[32:35], s49 offen lds
    s_mov_b32 m0, 134144
    s_add_u32 s49, s49, 32768
    buffer_load_dwordx4 v17, s[32:35], s49 offen lds
    s_mov_b32 m0, 135168
    s_add_u32 s49, s49, 32768
    buffer_load_dwordx4 v17, s[32:35], s49 offen lds
    s_mov_b32 m0, 136192
    s_add_u32 s49, s49, 32768
    buffer_load_dwordx4 v17, s[32:35], s49 offen lds
    s_mov_b32 m0, 137216
    s_add_u32 s49, s49, 32768
    buffer_load_dwordx4 v17, s[32:35], s49 offen lds
    s_mov_b32 m0, 138240
    s_add_u32 s49, s49, 32768
    buffer_load_dwordx4 v17, s[32:35], s49 offen lds
    s_mov_b32 m0, 139264
    s_add_u32 s49, s49, 32768
    buffer_load_dwordx4 v17, s[32:35], s49 offen lds
    s_mov_b32 m0, 140288
    s_add_u32 s49, s49, 32768
    buffer_load_dwordx4 v17, s[32:35], s49 offen lds
    s_mov_b32 m0, 141312
    s_add_u32 s49, s49, 32768
    buffer_load_dwordx4 v17, s[32:35], s49 offen lds
    s_mov_b32 m0, 142336
    s_add_u32 s49, s49, 32768
    buffer_load_dwordx4 v17, s[32:35], s49 offen lds
    s_mov_b32 m0, 143360
    s_add_u32 s49, s49, 32768
    buffer_load_dwordx4 v17, s[32:35], s49 offen lds
    s_mov_b32 m0, 144384
    s_add_u32 s49, s49, 32768
    buffer_load_dwordx4 v17, s[32:35], s49 offen lds
    s_mov_b32 m0, 145408
    s_add_u32 s49, s49, 32768
    buffer_load_dwordx4 v17, s[32:35], s49 offen lds
    s_mov_b32 m0, 146432
    s_add_u32 s49, s49, 32768
    buffer_load_dwordx4 v17, s[32:35], s49 offen lds
    s_waitcnt vmcnt(40)
    v_mov_b32 v26, 4
    ds_write_b32 v18, v26 offset:4
    s_cmp_ge_u32 s59, 2
    s_cbranch_scc1 K1_P38_OK
K1_P38:
    ds_read_b96 v[28:30], v18 offset:16
    s_waitcnt lgkmcnt(0)
    v_min3_u32 v28, v28, v29, v30
    s_nop 0
    v_readfirstlane_b32 s59, v28
    s_cmp_ge_u32 s59, 2
    s_cbranch_scc0 K1_P38
K1_P38_OK:
    s_add_u32 s49, s55, 3670016
    s_mov_b32 m0, 147456
    s_nop 0
    buffer_load_dwordx4 v17, s[32:35], s49 offen lds
    s_mov_b32 m0, 148480
    s_add_u32 s49, s49, 32768
    buffer_load_dwordx4 v17, s[32:35], s49 offen lds
    s_mov_b32 m0, 149504
    s_add_u32 s49, s49, 32768
    buffer_load_dwordx4 v17, s[32:35], s49 offen lds
    s_mov_b32 m0, 150528
    s_add_u32 s49, s49, 32768
    buffer_load_dwordx4 v17, s[32:35], s49 offen lds
    s_mov_b32 m0, 151552
    s_add_u32 s49, s49, 32768
    buffer_load_dwordx4 v17, s[32:35], s49 offen lds
    s_mov_b32 m0, 152576
    s_add_u32 s49, s49, 32768
    buffer_load_dwordx4 v17, s[32:35], s49 offen lds
    s_mov_b32 m0, 153600
    s_add_u32 s49, s49, 32768
    buffer_load_dwordx4 v17, s[32:35], s49 offen lds
    s_mov_b32 m0, 154624
    s_add_u32 s49, s49, 32768
    buffer_load_dwordx4 v17, s[32:35], s49 offen lds
    s_mov_b32 m0, 65536
    s_add_u32 s49, s49, 32768
    buffer_load_dwordx4 v17, s[32:35], s49 offen lds
    s_mov_b32 m0, 66560
    s_add_u32 s49, s49, 32768
    buffer_load_dwordx4 v17, s[32:35], s49 offen lds
    s_mov_b32 m0, 67584
    s_add_u32 s49, s49, 32768
    buffer_load_dwordx4 v17, s[32:35], s49 offen lds
    s_mov_b32 m0, 68608
    s_add_u32 s49, s49, 32768
    buffer_load_dwordx4 v17, s[32:35], s49 offen lds
    s_mov_b32 m0, 69632
    s_add_u32 s49, s49, 32768
    buffer_load_dwordx4 v17, s[32:35], s49 offen lds
    s_mov_b32 m0, 70656
    s_add_u32 s49, s49, 32768
    buffer_load_dwordx4 v17, s[32:35], s49 offen lds
    s_mov_b32 m0, 71680
    s_add_u32 s49, s49, 32768
    buffer_load_dwordx4 v17, s[32:35], s49 offen lds
    s_mov_b32 m0, 72704
    s_add_u32 s49, s49, 32768
    buffer_load_dwordx4 v17, s[32:35], s49 offen lds
    s_waitcnt vmcnt(40)
    v_mov_b32 v26, 5
    ds_write_b32 v18, v26 offset:4
    s_mov_b32 m0, 0
    s_add_u32 s50, s47, 0
    buffer_load_dwordx4 v8, s[24:27], s50 offen offset:0 nt lds
    buffer_load_dwordx4 v9, s[24:27], s50 offen offset:1024 nt lds
    buffer_load_dwordx4 v10, s[24:27], s50 offen offset:2048 nt lds
    buffer_load_dwordx4 v11, s[24:27], s50 offen offset:3072 nt lds
    s_mov_b32 m0, 4096
    s_add_u32 s50, s47, 4096
    buffer_load_dwordx4 v8, s[24:27], s50 offen offset:0 nt lds
    buffer_load_dwordx4 v9, s[24:27], s50 offen offset:1024 nt lds
    buffer_load_dwordx4 v10, s[24:27], s50 offen offset:2048 nt lds
    buffer_load_dwordx4 v11, s[24:27], s50 offen offset:3072 nt lds
    s_waitcnt vmcnt(40)
    v_mov_b32 v26, 6
    ds_write_b32 v18, v26 offset:4
    s_cmp_ge_u32 s59, 4
    s_cbranch_scc1 K1_P39_OK
K1_P39:
    ds_read_b96 v[28:30], v18 offset:16
    s_waitcnt lgkmcnt(0)
    v_min3_u32 v28, v28, v29, v30
    s_nop 0
    v_readfirstlane_b32 s59, v28
    s_cmp_ge_u32 s59, 4
    s_cbranch_scc0 K1_P39
K1_P39_OK:
    s_mov_b32 m0, 8192
    s_add_u32 s50, s47, 8192
    buffer_load_dwordx4 v8, s[24:27], s50 offen offset:0 nt lds
    buffer_load_dwordx4 v9, s[24:27], s50 offen offset:1024 nt lds
    buffer_load_dwordx4 v10, s[24:27], s50 offen offset:2048 nt lds
    buffer_load_dwordx4 v11, s[24:27], s50 offen offset:3072 nt lds
    s_mov_b32 m0, 12288
    s_add_u32 s50, s47, 12288
    buffer_load_dwordx4 v8, s[24:27], s50 offen offset:0 nt lds
    buffer_load_dwordx4 v9, s[24:27], s50 offen offset:1024 nt lds
    buffer_load_dwordx4 v10, s[24:27], s50 offen offset:2048 nt lds
    buffer_load_dwordx4 v11, s[24:27], s50 offen offset:3072 nt lds
    s_mov_b32 m0, 73728
    s_add_u32 s50, s47, 0
    buffer_load_dwordx4 v16, s[28:31], s50 offen offset:0 nt lds
    buffer_load_dwordx4 v16, s[28:31], s50 offen offset:1024 nt lds
    buffer_load_dwordx4 v16, s[28:31], s50 offen offset:2048 nt lds
    buffer_load_dwordx4 v16, s[28:31], s50 offen offset:3072 nt lds
    s_mov_b32 m0, 77824
    s_add_u32 s50, s47, 4096
    buffer_load_dwordx4 v16, s[28:31], s50 offen offset:0 nt lds
    buffer_load_dwordx4 v16, s[28:31], s50 offen offset:1024 nt lds
    buffer_load_dwordx4 v16, s[28:31], s50 offen offset:2048 nt lds
    buffer_load_dwordx4 v16, s[28:31], s50 offen offset:3072 nt lds
    s_waitcnt vmcnt(40)
    v_mov_b32 v26, 7
    ds_write_b32 v18, v26 offset:4
    s_cmp_ge_u32 s59, 4
    s_cbranch_scc1 K1_P40_OK
K1_P40:
    ds_read_b96 v[28:30], v18 offset:16
    s_waitcnt lgkmcnt(0)
    v_min3_u32 v28, v28, v29, v30
    s_nop 0
    v_readfirstlane_b32 s59, v28
    s_cmp_ge_u32 s59, 4
    s_cbranch_scc0 K1_P40
K1_P40_OK:
    s_mov_b32 m0, 16384
    s_add_u32 s50, s47, 16384
    buffer_load_dwordx4 v8, s[24:27], s50 offen offset:0 nt lds
    buffer_load_dwordx4 v9, s[24:27], s50 offen offset:1024 nt lds
    buffer_load_dwordx4 v10, s[24:27], s50 offen offset:2048 nt lds
    buffer_load_dwordx4 v11, s[24:27], s50 offen offset:3072 nt lds
    s_mov_b32 m0, 20480
    s_add_u32 s50, s47, 20480
    buffer_load_dwordx4 v8, s[24:27], s50 offen offset:0 nt lds
    buffer_load_dwordx4 v9, s[24:27], s50 offen offset:1024 nt lds
    buffer_load_dwordx4 v10, s[24:27], s50 offen offset:2048 nt lds
    buffer_load_dwordx4 v11, s[24:27], s50 offen offset:3072 nt lds
    s_mov_b32 m0, 81920
    s_add_u32 s50, s47, 8192
    buffer_load_dwordx4 v16, s[28:31], s50 offen offset:0 nt lds
    buffer_load_dwordx4 v16, s[28:31], s50 offen offset:1024 nt lds
    buffer_load_dwordx4 v16, s[28:31], s50 offen offset:2048 nt lds
    buffer_load_dwordx4 v16, s[28:31], s50 offen offset:3072 nt lds
    s_mov_b32 m0, 86016
    s_add_u32 s50, s47, 12288
    buffer_load_dwordx4 v16, s[28:31], s50 offen offset:0 nt lds
    buffer_load_dwordx4 v16, s[28:31], s50 offen offset:1024 nt lds
    buffer_load_dwordx4 v16, s[28:31], s50 offen offset:2048 nt lds
    buffer_load_dwordx4 v16, s[28:31], s50 offen offset:3072 nt lds
    s_waitcnt vmcnt(40)
    v_mov_b32 v26, 8
    ds_write_b32 v18, v26 offset:4
    s_cmp_ge_u32 s59, 6
    s_cbranch_scc1 K1_P41_OK
K1_P41:
    ds_read_b96 v[28:30], v18 offset:16
    s_waitcnt lgkmcnt(0)
    v_min3_u32 v28, v28, v29, v30
    s_nop 0
    v_readfirstlane_b32 s59, v28
    s_cmp_ge_u32 s59, 6
    s_cbranch_scc0 K1_P41
K1_P41_OK:
    s_mov_b32 m0, 24576
    s_add_u32 s50, s47, 24576
    buffer_load_dwordx4 v8, s[24:27], s50 offen offset:0 nt lds
    buffer_load_dwordx4 v9, s[24:27], s50 offen offset:1024 nt lds
    buffer_load_dwordx4 v10, s[24:27], s50 offen offset:2048 nt lds
    buffer_load_dwordx4 v11, s[24:27], s50 offen offset:3072 nt lds
    s_mov_b32 m0, 28672
    s_add_u32 s50, s47, 28672
    buffer_load_dwordx4 v8, s[24:27], s50 offen offset:0 nt lds
    buffer_load_dwordx4 v9, s[24:27], s50 offen offset:1024 nt lds
    buffer_load_dwordx4 v10, s[24:27], s50 offen offset:2048 nt lds
    buffer_load_dwordx4 v11, s[24:27], s50 offen offset:3072 nt lds
    s_mov_b32 m0, 90112
    s_add_u32 s50, s47, 16384
    buffer_load_dwordx4 v16, s[28:31], s50 offen offset:0 nt lds
    buffer_load_dwordx4 v16, s[28:31], s50 offen offset:1024 nt lds
    buffer_load_dwordx4 v16, s[28:31], s50 offen offset:2048 nt lds
    buffer_load_dwordx4 v16, s[28:31], s50 offen offset:3072 nt lds
    s_mov_b32 m0, 94208
    s_add_u32 s50, s47, 20480
    buffer_load_dwordx4 v16, s[28:31], s50 offen offset:0 nt lds
    buffer_load_dwordx4 v16, s[28:31], s50 offen offset:1024 nt lds
    buffer_load_dwordx4 v16, s[28:31], s50 offen offset:2048 nt lds
    buffer_load_dwordx4 v16, s[28:31], s50 offen offset:3072 nt lds
    s_waitcnt vmcnt(48)
    v_mov_b32 v26, 1
    ds_write_b32 v18, v26 offset:0
    s_cmp_ge_u32 s59, 6
    s_cbranch_scc1 K1_P42_OK
K1_P42:
    ds_read_b96 v[28:30], v18 offset:16
    s_waitcnt lgkmcnt(0)
    v_min3_u32 v28, v28, v29, v30
    s_nop 0
    v_readfirstlane_b32 s59, v28
    s_cmp_ge_u32 s59, 6
    s_cbranch_scc0 K1_P42
K1_P42_OK:
    s_mov_b32 m0, 32768
    s_add_u32 s50, s47, 32768
    buffer_load_dwordx4 v8, s[24:27], s50 offen offset:0 nt lds
    buffer_load_dwordx4 v9, s[24:27], s50 offen offset:1024 nt lds
    buffer_load_dwordx4 v10, s[24:27], s50 offen offset:2048 nt lds
    buffer_load_dwordx4 v11, s[24:27], s50 offen offset:3072 nt lds
    s_mov_b32 m0, 36864
    s_add_u32 s50, s47, 36864
    buffer_load_dwordx4 v8, s[24:27], s50 offen offset:0 nt lds
    buffer_load_dwordx4 v9, s[24:27], s50 offen offset:1024 nt lds
    buffer_load_dwordx4 v10, s[24:27], s50 offen offset:2048 nt lds
    buffer_load_dwordx4 v11, s[24:27], s50 offen offset:3072 nt lds
    s_mov_b32 m0, 98304
    s_add_u32 s50, s47, 24576
    buffer_load_dwordx4 v16, s[28:31], s50 offen offset:0 nt lds
    buffer_load_dwordx4 v16, s[28:31], s50 offen offset:1024 nt lds
    buffer_load_dwordx4 v16, s[28:31], s50 offen offset:2048 nt lds
    buffer_load_dwordx4 v16, s[28:31], s50 offen offset:3072 nt lds
    s_mov_b32 m0, 102400
    s_add_u32 s50, s47, 28672
    buffer_load_dwordx4 v16, s[28:31], s50 offen offset:0 nt lds
    buffer_load_dwordx4 v16, s[28:31], s50 offen offset:1024 nt lds
    buffer_load_dwordx4 v16, s[28:31], s50 offen offset:2048 nt lds
    buffer_load_dwordx4 v16, s[28:31], s50 offen offset:3072 nt lds
    s_waitcnt vmcnt(48)
    v_mov_b32 v26, 2
    ds_write_b32 v18, v26 offset:0
    s_cmp_ge_u32 s59, 6
    s_cbranch_scc1 K1_P43_OK
K1_P43:
    ds_read_b96 v[28:30], v18 offset:16
    s_waitcnt lgkmcnt(0)
    v_min3_u32 v28, v28, v29, v30
    s_nop 0
    v_readfirstlane_b32 s59, v28
    s_cmp_ge_u32 s59, 6
    s_cbranch_scc0 K1_P43
K1_P43_OK:
    s_mov_b32 m0, 40960
    s_add_u32 s50, s47, 40960
    buffer_load_dwordx4 v8, s[24:27], s50 offen offset:0 nt lds
    buffer_load_dwordx4 v9, s[24:27], s50 offen offset:1024 nt lds
    buffer_load_dwordx4 v10, s[24:27], s50 offen offset:2048 nt lds
    buffer_load_dwordx4 v11, s[24:27], s50 offen offset:3072 nt lds
    s_mov_b32 m0, 45056
    s_add_u32 s50, s47, 45056
    buffer_load_dwordx4 v8, s[24:27], s50 offen offset:0 nt lds
    buffer_load_dwordx4 v9, s[24:27], s50 offen offset:1024 nt lds
    buffer_load_dwordx4 v10, s[24:27], s50 offen offset:2048 nt lds
    buffer_load_dwordx4 v11, s[24:27], s50 offen offset:3072 nt lds
    s_mov_b32 m0, 106496
    s_add_u32 s50, s47, 32768
    buffer_load_dwordx4 v16, s[28:31], s50 offen offset:0 nt lds
    buffer_load_dwordx4 v16, s[28:31], s50 offen offset:1024 nt lds
    buffer_load_dwordx4 v16, s[28:31], s50 offen offset:2048 nt lds
    buffer_load_dwordx4 v16, s[28:31], s50 offen offset:3072 nt lds
    s_mov_b32 m0, 110592
    s_add_u32 s50, s47, 36864
    buffer_load_dwordx4 v16, s[28:31], s50 offen offset:0 nt lds
    buffer_load_dwordx4 v16, s[28:31], s50 offen offset:1024 nt lds
    buffer_load_dwordx4 v16, s[28:31], s50 offen offset:2048 nt lds
    buffer_load_dwordx4 v16, s[28:31], s50 offen offset:3072 nt lds
    s_waitcnt vmcnt(48)
    v_mov_b32 v26, 3
    ds_write_b32 v18, v26 offset:0
    s_cmp_ge_u32 s59, 6
    s_cbranch_scc1 K1_P44_OK
K1_P44:
    ds_read_b96 v[28:30], v18 offset:16
    s_waitcnt lgkmcnt(0)
    v_min3_u32 v28, v28, v29, v30
    s_nop 0
    v_readfirstlane_b32 s59, v28
    s_cmp_ge_u32 s59, 6
    s_cbranch_scc0 K1_P44
K1_P44_OK:
    s_mov_b32 m0, 49152
    s_add_u32 s50, s47, 49152
    buffer_load_dwordx4 v8, s[24:27], s50 offen offset:0 nt lds
    buffer_load_dwordx4 v9, s[24:27], s50 offen offset:1024 nt lds
    buffer_load_dwordx4 v10, s[24:27], s50 offen offset:2048 nt lds
    buffer_load_dwordx4 v11, s[24:27], s50 offen offset:3072 nt lds
    s_mov_b32 m0, 53248
    s_add_u32 s50, s47, 53248
    buffer_load_dwordx4 v8, s[24:27], s50 offen offset:0 nt lds
    buffer_load_dwordx4 v9, s[24:27], s50 offen offset:1024 nt lds
    buffer_load_dwordx4 v10, s[24:27], s50 offen offset:2048 nt lds
    buffer_load_dwordx4 v11, s[24:27], s50 offen offset:3072 nt lds
    s_mov_b32 m0, 114688
    s_add_u32 s50, s47, 40960
    buffer_load_dwordx4 v16, s[28:31], s50 offen offset:0 nt lds
    buffer_load_dwordx4 v16, s[28:31], s50 offen offset:1024 nt lds
    buffer_load_dwordx4 v16, s[28:31], s50 offen offset:2048 nt lds
    buffer_load_dwordx4 v16, s[28:31], s50 offen offset:3072 nt lds
    s_mov_b32 m0, 118784
    s_add_u32 s50, s47, 45056
    buffer_load_dwordx4 v16, s[28:31], s50 offen offset:0 nt lds
    buffer_load_dwordx4 v16, s[28:31], s50 offen offset:1024 nt lds
    buffer_load_dwordx4 v16, s[28:31], s50 offen offset:2048 nt lds
    buffer_load_dwordx4 v16, s[28:31], s50 offen offset:3072 nt lds
    s_waitcnt vmcnt(48)
    v_mov_b32 v26, 4
    ds_write_b32 v18, v26 offset:0
    s_cmp_ge_u32 s59, 6
    s_cbranch_scc1 K1_P45_OK
K1_P45:
    ds_read_b96 v[28:30], v18 offset:16
    s_waitcnt lgkmcnt(0)
    v_min3_u32 v28, v28, v29, v30
    s_nop 0
    v_readfirstlane_b32 s59, v28
    s_cmp_ge_u32 s59, 6
    s_cbranch_scc0 K1_P45
K1_P45_OK:
    s_mov_b32 m0, 57344
    s_add_u32 s50, s47, 57344
    buffer_load_dwordx4 v8, s[24:27], s50 offen offset:0 nt lds
    buffer_load_dwordx4 v9, s[24:27], s50 offen offset:1024 nt lds
    buffer_load_dwordx4 v10, s[24:27], s50 offen offset:2048 nt lds
    buffer_load_dwordx4 v11, s[24:27], s50 offen offset:3072 nt lds
    s_mov_b32 m0, 61440
    s_add_u32 s50, s47, 61440
    buffer_load_dwordx4 v8, s[24:27], s50 offen offset:0 nt lds
    buffer_load_dwordx4 v9, s[24:27], s50 offen offset:1024 nt lds
    buffer_load_dwordx4 v10, s[24:27], s50 offen offset:2048 nt lds
    buffer_load_dwordx4 v11, s[24:27], s50 offen offset:3072 nt lds
    s_mov_b32 m0, 122880
    s_add_u32 s50, s47, 49152
    buffer_load_dwordx4 v16, s[28:31], s50 offen offset:0 nt lds
    buffer_load_dwordx4 v16, s[28:31], s50 offen offset:1024 nt lds
    buffer_load_dwordx4 v16, s[28:31], s50 offen offset:2048 nt lds
    buffer_load_dwordx4 v16, s[28:31], s50 offen offset:3072 nt lds
    s_mov_b32 m0, 126976
    s_add_u32 s50, s47, 53248
    buffer_load_dwordx4 v16, s[28:31], s50 offen offset:0 nt lds
    buffer_load_dwordx4 v16, s[28:31], s50 offen offset:1024 nt lds
    buffer_load_dwordx4 v16, s[28:31], s50 offen offset:2048 nt lds
    buffer_load_dwordx4 v16, s[28:31], s50 offen offset:3072 nt lds
    s_waitcnt vmcnt(48)
    v_mov_b32 v26, 5
    ds_write_b32 v18, v26 offset:0
    s_cmp_ge_u32 s59, 9
    s_cbranch_scc1 K1_P46_OK
K1_P46:
    ds_read_b96 v[28:30], v18 offset:16
    s_waitcnt lgkmcnt(0)
    v_min3_u32 v28, v28, v29, v30
    s_nop 0
    v_readfirstlane_b32 s59, v28
    s_cmp_ge_u32 s59, 9
    s_cbranch_scc0 K1_P46
K1_P46_OK:
    s_mov_b32 m0, 0
    s_add_u32 s50, s47, 65536
    buffer_load_dwordx4 v8, s[24:27], s50 offen offset:0 nt lds
    buffer_load_dwordx4 v9, s[24:27], s50 offen offset:1024 nt lds
    buffer_load_dwordx4 v10, s[24:27], s50 offen offset:2048 nt lds
    buffer_load_dwordx4 v11, s[24:27], s50 offen offset:3072 nt lds
    s_mov_b32 m0, 4096
    s_add_u32 s50, s47, 69632
    buffer_load_dwordx4 v8, s[24:27], s50 offen offset:0 nt lds
    buffer_load_dwordx4 v9, s[24:27], s50 offen offset:1024 nt lds
    buffer_load_dwordx4 v10, s[24:27], s50 offen offset:2048 nt lds
    buffer_load_dwordx4 v11, s[24:27], s50 offen offset:3072 nt lds
    s_mov_b32 m0, 65536
    s_add_u32 s50, s47, 57344
    buffer_load_dwordx4 v16, s[28:31], s50 offen offset:0 nt lds
    buffer_load_dwordx4 v16, s[28:31], s50 offen offset:1024 nt lds
    buffer_load_dwordx4 v16, s[28:31], s50 offen offset:2048 nt lds
    buffer_load_dwordx4 v16, s[28:31], s50 offen offset:3072 nt lds
    s_mov_b32 m0, 69632
    s_add_u32 s50, s47, 61440
    buffer_load_dwordx4 v16, s[28:31], s50 offen offset:0 nt lds
    buffer_load_dwordx4 v16, s[28:31], s50 offen offset:1024 nt lds
    buffer_load_dwordx4 v16, s[28:31], s50 offen offset:2048 nt lds
    buffer_load_dwordx4 v16, s[28:31], s50 offen offset:3072 nt lds
    s_waitcnt vmcnt(48)
    v_mov_b32 v26, 6
    ds_write_b32 v18, v26 offset:0
    s_cmp_ge_u32 s59, 10
    s_cbranch_scc1 K1_P47_OK
K1_P47:
    ds_read_b96 v[28:30], v18 offset:16
    s_waitcnt lgkmcnt(0)
    v_min3_u32 v28, v28, v29, v30
    s_nop 0
    v_readfirstlane_b32 s59, v28
    s_cmp_ge_u32 s59, 10
    s_cbranch_scc0 K1_P47
K1_P47_OK:
    s_mov_b32 m0, 8192
    s_add_u32 s50, s47, 73728
    buffer_load_dwordx4 v8, s[24:27], s50 offen offset:0 nt lds
    buffer_load_dwordx4 v9, s[24:27], s50 offen offset:1024 nt lds
    buffer_load_dwordx4 v10, s[24:27], s50 offen offset:2048 nt lds
    buffer_load_dwordx4 v11, s[24:27], s50 offen offset:3072 nt lds
    s_mov_b32 m0, 12288
    s_add_u32 s50, s47, 77824
    buffer_load_dwordx4 v8, s[24:27], s50 offen offset:0 nt lds
    buffer_load_dwordx4 v9, s[24:27], s50 offen offset:1024 nt lds
    buffer_load_dwordx4 v10, s[24:27], s50 offen offset:2048 nt lds
    buffer_load_dwordx4 v11, s[24:27], s50 offen offset:3072 nt lds
    s_mov_b32 m0, 73728
    s_add_u32 s50, s47, 65536
    buffer_load_dwordx4 v16, s[28:31], s50 offen offset:0 nt lds
    buffer_load_dwordx4 v16, s[28:31], s50 offen offset:1024 nt lds
    buffer_load_dwordx4 v16, s[28:31], s50 offen offset:2048 nt lds
    buffer_load_dwordx4 v16, s[28:31], s50 offen offset:3072 nt lds
    s_mov_b32 m0, 77824
    s_add_u32 s50, s47, 69632
    buffer_load_dwordx4 v16, s[28:31], s50 offen offset:0 nt lds
    buffer_load_dwordx4 v16, s[28:31], s50 offen offset:1024 nt lds
    buffer_load_dwordx4 v16, s[28:31], s50 offen offset:2048 nt lds
    buffer_load_dwordx4 v16, s[28:31], s50 offen offset:3072 nt lds
    s_waitcnt vmcnt(48)
    v_mov_b32 v26, 7
    ds_write_b32 v18, v26 offset:0
    s_cmp_ge_u32 s59, 11
    s_cbranch_scc1 K1_P48_OK
K1_P48:
    ds_read_b96 v[28:30], v18 offset:16
    s_waitcnt lgkmcnt(0)
    v_min3_u32 v28, v28, v29, v30
    s_nop 0
    v_readfirstlane_b32 s59, v28
    s_cmp_ge_u32 s59, 11
    s_cbranch_scc0 K1_P48
K1_P48_OK:
    s_mov_b32 m0, 16384
    s_add_u32 s50, s47, 81920
    buffer_load_dwordx4 v8, s[24:27], s50 offen offset:0 nt lds
    buffer_load_dwordx4 v9, s[24:27], s50 offen offset:1024 nt lds
    buffer_load_dwordx4 v10, s[24:27], s50 offen offset:2048 nt lds
    buffer_load_dwordx4 v11, s[24:27], s50 offen offset:3072 nt lds
    s_mov_b32 m0, 20480
    s_add_u32 s50, s47, 86016
    buffer_load_dwordx4 v8, s[24:27], s50 offen offset:0 nt lds
    buffer_load_dwordx4 v9, s[24:27], s50 offen offset:1024 nt lds
    buffer_load_dwordx4 v10, s[24:27], s50 offen offset:2048 nt lds
    buffer_load_dwordx4 v11, s[24:27], s50 offen offset:3072 nt lds
    s_mov_b32 m0, 81920
    s_add_u32 s50, s47, 73728
    buffer_load_dwordx4 v16, s[28:31], s50 offen offset:0 nt lds
    buffer_load_dwordx4 v16, s[28:31], s50 offen offset:1024 nt lds
    buffer_load_dwordx4 v16, s[28:31], s50 offen offset:2048 nt lds
    buffer_load_dwordx4 v16, s[28:31], s50 offen offset:3072 nt lds
    s_mov_b32 m0, 86016
    s_add_u32 s50, s47, 77824
    buffer_load_dwordx4 v16, s[28:31], s50 offen offset:0 nt lds
    buffer_load_dwordx4 v16, s[28:31], s50 offen offset:1024 nt lds
    buffer_load_dwordx4 v16, s[28:31], s50 offen offset:2048 nt lds
    buffer_load_dwordx4 v16, s[28:31], s50 offen offset:3072 nt lds
    s_waitcnt vmcnt(48)
    v_mov_b32 v26, 8
    ds_write_b32 v18, v26 offset:0
    s_cmp_ge_u32 s59, 12
    s_cbranch_scc1 K1_P49_OK
K1_P49:
    ds_read_b96 v[28:30], v18 offset:16
    s_waitcnt lgkmcnt(0)
    v_min3_u32 v28, v28, v29, v30
    s_nop 0
    v_readfirstlane_b32 s59, v28
    s_cmp_ge_u32 s59, 12
    s_cbranch_scc0 K1_P49
K1_P49_OK:
    s_mov_b32 m0, 24576
    s_add_u32 s50, s47, 90112
    buffer_load_dwordx4 v8, s[24:27], s50 offen offset:0 nt lds
    buffer_load_dwordx4 v9, s[24:27], s50 offen offset:1024 nt lds
    buffer_load_dwordx4 v10, s[24:27], s50 offen offset:2048 nt lds
    buffer_load_dwordx4 v11, s[24:27], s50 offen offset:3072 nt lds
    s_mov_b32 m0, 28672
    s_add_u32 s50, s47, 94208
    buffer_load_dwordx4 v8, s[24:27], s50 offen offset:0 nt lds
    buffer_load_dwordx4 v9, s[24:27], s50 offen offset:1024 nt lds
    buffer_load_dwordx4 v10, s[24:27], s50 offen offset:2048 nt lds
    buffer_load_dwordx4 v11, s[24:27], s50 offen offset:3072 nt lds
    s_mov_b32 m0, 90112
    s_add_u32 s50, s47, 81920
    buffer_load_dwordx4 v16, s[28:31], s50 offen offset:0 nt lds
    buffer_load_dwordx4 v16, s[28:31], s50 offen offset:1024 nt lds
    buffer_load_dwordx4 v16, s[28:31], s50 offen offset:2048 nt lds
    buffer_load_dwordx4 v16, s[28:31], s50 offen offset:3072 nt lds
    s_mov_b32 m0, 94208
    s_add_u32 s50, s47, 86016
    buffer_load_dwordx4 v16, s[28:31], s50 offen offset:0 nt lds
    buffer_load_dwordx4 v16, s[28:31], s50 offen offset:1024 nt lds
    buffer_load_dwordx4 v16, s[28:31], s50 offen offset:2048 nt lds
    buffer_load_dwordx4 v16, s[28:31], s50 offen offset:3072 nt lds
    s_waitcnt vmcnt(48)
    v_mov_b32 v26, 9
    ds_write_b32 v18, v26 offset:0
    s_cmp_ge_u32 s59, 13
    s_cbranch_scc1 K1_P50_OK
K1_P50:
    ds_read_b96 v[28:30], v18 offset:16
    s_waitcnt lgkmcnt(0)
    v_min3_u32 v28, v28, v29, v30
    s_nop 0
    v_readfirstlane_b32 s59, v28
    s_cmp_ge_u32 s59, 13
    s_cbranch_scc0 K1_P50
K1_P50_OK:
    s_mov_b32 m0, 32768
    s_add_u32 s50, s47, 98304
    buffer_load_dwordx4 v8, s[24:27], s50 offen offset:0 nt lds
    buffer_load_dwordx4 v9, s[24:27], s50 offen offset:1024 nt lds
    buffer_load_dwordx4 v10, s[24:27], s50 offen offset:2048 nt lds
    buffer_load_dwordx4 v11, s[24:27], s50 offen offset:3072 nt lds
    s_mov_b32 m0, 36864
    s_add_u32 s50, s47, 102400
    buffer_load_dwordx4 v8, s[24:27], s50 offen offset:0 nt lds
    buffer_load_dwordx4 v9, s[24:27], s50 offen offset:1024 nt lds
    buffer_load_dwordx4 v10, s[24:27], s50 offen offset:2048 nt lds
    buffer_load_dwordx4 v11, s[24:27], s50 offen offset:3072 nt lds
    s_mov_b32 m0, 98304
    s_add_u32 s50, s47, 90112
    buffer_load_dwordx4 v16, s[28:31], s50 offen offset:0 nt lds
    buffer_load_dwordx4 v16, s[28:31], s50 offen offset:1024 nt lds
    buffer_load_dwordx4 v16, s[28:31], s50 offen offset:2048 nt lds
    buffer_load_dwordx4 v16, s[28:31], s50 offen offset:3072 nt lds
    s_mov_b32 m0, 102400
    s_add_u32 s50, s47, 94208
    buffer_load_dwordx4 v16, s[28:31], s50 offen offset:0 nt lds
    buffer_load_dwordx4 v16, s[28:31], s50 offen offset:1024 nt lds
    buffer_load_dwordx4 v16, s[28:31], s50 offen offset:2048 nt lds
    buffer_load_dwordx4 v16, s[28:31], s50 offen offset:3072 nt lds
    s_waitcnt vmcnt(48)
    v_mov_b32 v26, 10
    ds_write_b32 v18, v26 offset:0
    s_cmp_ge_u32 s59, 14
    s_cbranch_scc1 K1_P51_OK
K1_P51:
    ds_read_b96 v[28:30], v18 offset:16
    s_waitcnt lgkmcnt(0)
    v_min3_u32 v28, v28, v29, v30
    s_nop 0
    v_readfirstlane_b32 s59, v28
    s_cmp_ge_u32 s59, 14
    s_cbranch_scc0 K1_P51
K1_P51_OK:
    s_mov_b32 m0, 40960
    s_add_u32 s50, s47, 106496
    buffer_load_dwordx4 v8, s[24:27], s50 offen offset:0 nt lds
    buffer_load_dwordx4 v9, s[24:27], s50 offen offset:1024 nt lds
    buffer_load_dwordx4 v10, s[24:27], s50 offen offset:2048 nt lds
    buffer_load_dwordx4 v11, s[24:27], s50 offen offset:3072 nt lds
    s_mov_b32 m0, 45056
    s_add_u32 s50, s47, 110592
    buffer_load_dwordx4 v8, s[24:27], s50 offen offset:0 nt lds
    buffer_load_dwordx4 v9, s[24:27], s50 offen offset:1024 nt lds
    buffer_load_dwordx4 v10, s[24:27], s50 offen offset:2048 nt lds
    buffer_load_dwordx4 v11, s[24:27], s50 offen offset:3072 nt lds
    s_mov_b32 m0, 106496
    s_add_u32 s50, s47, 98304
    buffer_load_dwordx4 v16, s[28:31], s50 offen offset:0 nt lds
    buffer_load_dwordx4 v16, s[28:31], s50 offen offset:1024 nt lds
    buffer_load_dwordx4 v16, s[28:31], s50 offen offset:2048 nt lds
    buffer_load_dwordx4 v16, s[28:31], s50 offen offset:3072 nt lds
    s_mov_b32 m0, 110592
    s_add_u32 s50, s47, 102400
    buffer_load_dwordx4 v16, s[28:31], s50 offen offset:0 nt lds
    buffer_load_dwordx4 v16, s[28:31], s50 offen offset:1024 nt lds
    buffer_load_dwordx4 v16, s[28:31], s50 offen offset:2048 nt lds
    buffer_load_dwordx4 v16, s[28:31], s50 offen offset:3072 nt lds
    s_waitcnt vmcnt(48)
    v_mov_b32 v26, 11
    ds_write_b32 v18, v26 offset:0
    s_cmp_ge_u32 s59, 15
    s_cbranch_scc1 K1_P52_OK
K1_P52:
    ds_read_b96 v[28:30], v18 offset:16
    s_waitcnt lgkmcnt(0)
    v_min3_u32 v28, v28, v29, v30
    s_nop 0
    v_readfirstlane_b32 s59, v28
    s_cmp_ge_u32 s59, 15
    s_cbranch_scc0 K1_P52
K1_P52_OK:
    s_mov_b32 m0, 49152
    s_add_u32 s50, s47, 114688
    buffer_load_dwordx4 v8, s[24:27], s50 offen offset:0 nt lds
    buffer_load_dwordx4 v9, s[24:27], s50 offen offset:1024 nt lds
    buffer_load_dwordx4 v10, s[24:27], s50 offen offset:2048 nt lds
    buffer_load_dwordx4 v11, s[24:27], s50 offen offset:3072 nt lds
    s_mov_b32 m0, 53248
    s_add_u32 s50, s47, 118784
    buffer_load_dwordx4 v8, s[24:27], s50 offen offset:0 nt lds
    buffer_load_dwordx4 v9, s[24:27], s50 offen offset:1024 nt lds
    buffer_load_dwordx4 v10, s[24:27], s50 offen offset:2048 nt lds
    buffer_load_dwordx4 v11, s[24:27], s50 offen offset:3072 nt lds
    s_mov_b32 m0, 114688
    s_add_u32 s50, s47, 106496
    buffer_load_dwordx4 v16, s[28:31], s50 offen offset:0 nt lds
    buffer_load_dwordx4 v16, s[28:31], s50 offen offset:1024 nt lds
    buffer_load_dwordx4 v16, s[28:31], s50 offen offset:2048 nt lds
    buffer_load_dwordx4 v16, s[28:31], s50 offen offset:3072 nt lds
    s_mov_b32 m0, 118784
    s_add_u32 s50, s47, 110592
    buffer_load_dwordx4 v16, s[28:31], s50 offen offset:0 nt lds
    buffer_load_dwordx4 v16, s[28:31], s50 offen offset:1024 nt lds
    buffer_load_dwordx4 v16, s[28:31], s50 offen offset:2048 nt lds
    buffer_load_dwordx4 v16, s[28:31], s50 offen offset:3072 nt lds
    s_waitcnt vmcnt(48)
    v_mov_b32 v26, 12
    ds_write_b32 v18, v26 offset:0
    s_cmp_ge_u32 s59, 16
    s_cbranch_scc1 K1_P53_OK
K1_P53:
    ds_read_b96 v[28:30], v18 offset:16
    s_waitcnt lgkmcnt(0)
    v_min3_u32 v28, v28, v29, v30
    s_nop 0
    v_readfirstlane_b32 s59, v28
    s_cmp_ge_u32 s59, 16
    s_cbranch_scc0 K1_P53
K1_P53_OK:
    s_mov_b32 m0, 57344
    s_add_u32 s50, s47, 122880
    buffer_load_dwordx4 v8, s[24:27], s50 offen offset:0 nt lds
    buffer_load_dwordx4 v9, s[24:27], s50 offen offset:1024 nt lds
    buffer_load_dwordx4 v10, s[24:27], s50 offen offset:2048 nt lds
    buffer_load_dwordx4 v11, s[24:27], s50 offen offset:3072 nt lds
    s_mov_b32 m0, 61440
    s_add_u32 s50, s47, 126976
    buffer_load_dwordx4 v8, s[24:27], s50 offen offset:0 nt lds
    buffer_load_dwordx4 v9, s[24:27], s50 offen offset:1024 nt lds
    buffer_load_dwordx4 v10, s[24:27], s50 offen offset:2048 nt lds
    buffer_load_dwordx4 v11, s[24:27], s50 offen offset:3072 nt lds
    s_mov_b32 m0, 122880
    s_add_u32 s50, s47, 114688
    buffer_load_dwordx4 v16, s[28:31], s50 offen offset:0 nt lds
    buffer_load_dwordx4 v16, s[28:31], s50 offen offset:1024 nt lds
    buffer_load_dwordx4 v16, s[28:31], s50 offen offset:2048 nt lds
    buffer_load_dwordx4 v16, s[28:31], s50 offen offset:3072 nt lds
    s_mov_b32 m0, 126976
    s_add_u32 s50, s47, 118784
    buffer_load_dwordx4 v16, s[28:31], s50 offen offset:0 nt lds
    buffer_load_dwordx4 v16, s[28:31], s50 offen offset:1024 nt lds
    buffer_load_dwordx4 v16, s[28:31], s50 offen offset:2048 nt lds
    buffer_load_dwordx4 v16, s[28:31], s50 offen offset:3072 nt lds
    s_waitcnt vmcnt(48)
    v_mov_b32 v26, 13
    ds_write_b32 v18, v26 offset:0
    s_cmp_ge_u32 s59, 17
    s_cbranch_scc1 K1_P54_OK
K1_P54:
    ds_read_b96 v[28:30], v18 offset:16
    s_waitcnt lgkmcnt(0)
    v_min3_u32 v28, v28, v29, v30
    s_nop 0
    v_readfirstlane_b32 s59, v28
    s_cmp_ge_u32 s59, 17
    s_cbranch_scc0 K1_P54
K1_P54_OK:
    s_mov_b32 m0, 0
    s_add_u32 s50, s47, 131072
    buffer_load_dwordx4 v8, s[24:27], s50 offen offset:0 nt lds
    buffer_load_dwordx4 v9, s[24:27], s50 offen offset:1024 nt lds
    buffer_load_dwordx4 v10, s[24:27], s50 offen offset:2048 nt lds
    buffer_load_dwordx4 v11, s[24:27], s50 offen offset:3072 nt lds
    s_mov_b32 m0, 4096
    s_add_u32 s50, s47, 135168
    buffer_load_dwordx4 v8, s[24:27], s50 offen offset:0 nt lds
    buffer_load_dwordx4 v9, s[24:27], s50 offen offset:1024 nt lds
    buffer_load_dwordx4 v10, s[24:27], s50 offen offset:2048 nt lds
    buffer_load_dwordx4 v11, s[24:27], s50 offen offset:3072 nt lds
    s_mov_b32 m0, 65536
    s_add_u32 s50, s47, 122880
    buffer_load_dwordx4 v16, s[28:31], s50 offen offset:0 nt lds
    buffer_load_dwordx4 v16, s[28:31], s50 offen offset:1024 nt lds
    buffer_load_dwordx4 v16, s[28:31], s50 offen offset:2048 nt lds
    buffer_load_dwordx4 v16, s[28:31], s50 offen offset:3072 nt lds
    s_mov_b32 m0, 69632
    s_add_u32 s50, s47, 126976
    buffer_load_dwordx4 v16, s[28:31], s50 offen offset:0 nt lds
    buffer_load_dwordx4 v16, s[28:31], s50 offen offset:1024 nt lds
    buffer_load_dwordx4 v16, s[28:31], s50 offen offset:2048 nt lds
    buffer_load_dwordx4 v16, s[28:31], s50 offen offset:3072 nt lds
    s_waitcnt vmcnt(48)
    v_mov_b32 v26, 14
    ds_write_b32 v18, v26 offset:0
    s_cmp_ge_u32 s59, 18
    s_cbranch_scc1 K1_P55_OK
K1_P55:
    ds_read_b96 v[28:30], v18 offset:16
    s_waitcnt lgkmcnt(0)
    v_min3_u32 v28, v28, v29, v30
    s_nop 0
    v_readfirstlane_b32 s59, v28
    s_cmp_ge_u32 s59, 18
    s_cbranch_scc0 K1_P55
K1_P55_OK:
    s_mov_b32 m0, 8192
    s_add_u32 s50, s47, 139264
    buffer_load_dwordx4 v8, s[24:27], s50 offen offset:0 nt lds
    buffer_load_dwordx4 v9, s[24:27], s50 offen offset:1024 nt lds
    buffer_load_dwordx4 v10, s[24:27], s50 offen offset:2048 nt lds
    buffer_load_dwordx4 v11, s[24:27], s50 offen offset:3072 nt lds
    s_mov_b32 m0, 12288
    s_add_u32 s50, s47, 143360
    buffer_load_dwordx4 v8, s[24:27], s50 offen offset:0 nt lds
    buffer_load_dwordx4 v9, s[24:27], s50 offen offset:1024 nt lds
    buffer_load_dwordx4 v10, s[24:27], s50 offen offset:2048 nt lds
    buffer_load_dwordx4 v11, s[24:27], s50 offen offset:3072 nt lds
    s_mov_b32 m0, 73728
    s_add_u32 s50, s47, 131072
    buffer_load_dwordx4 v16, s[28:31], s50 offen offset:0 nt lds
    buffer_load_dwordx4 v16, s[28:31], s50 offen offset:1024 nt lds
    buffer_load_dwordx4 v16, s[28:31], s50 offen offset:2048 nt lds
    buffer_load_dwordx4 v16, s[28:31], s50 offen offset:3072 nt lds
    s_mov_b32 m0, 77824
    s_add_u32 s50, s47, 135168
    buffer_load_dwordx4 v16, s[28:31], s50 offen offset:0 nt lds
    buffer_load_dwordx4 v16, s[28:31], s50 offen offset:1024 nt lds
    buffer_load_dwordx4 v16, s[28:31], s50 offen offset:2048 nt lds
    buffer_load_dwordx4 v16, s[28:31], s50 offen offset:3072 nt lds
    s_waitcnt vmcnt(48)
    v_mov_b32 v26, 15
    ds_write_b32 v18, v26 offset:0
    s_branch K1_LJ
K1_LB:
    s_mov_b32 m0, 0
    s_add_u32 s50, s47, 0
    buffer_load_dwordx4 v8, s[24:27], s50 offen offset:0 nt lds
    buffer_load_dwordx4 v9, s[24:27], s50 offen offset:1024 nt lds
    buffer_load_dwordx4 v10, s[24:27], s50 offen offset:2048 nt lds
    buffer_load_dwordx4 v11, s[24:27], s50 offen offset:3072 nt lds
    s_mov_b32 m0, 4096
    s_add_u32 s50, s47, 4096
    buffer_load_dwordx4 v8, s[24:27], s50 offen offset:0 nt lds
    buffer_load_dwordx4 v9, s[24:27], s50 offen offset:1024 nt lds
    buffer_load_dwordx4 v10, s[24:27], s50 offen offset:2048 nt lds
    buffer_load_dwordx4 v11, s[24:27], s50 offen offset:3072 nt lds
    s_add_u32 s50, s47, 8192
    buffer_load_dwordx4 v[32:35], v8, s[24:27], s50 offen offset:0 nt
    buffer_load_dwordx4 v[36:39], v9, s[24:27], s50 offen offset:1024 nt
    buffer_load_dwordx4 v[40:43], v10, s[24:27], s50 offen offset:2048 nt
    buffer_load_dwordx4 v[44:47], v11, s[24:27], s50 offen offset:3072 nt
    s_add_u32 s50, s47, 12288
    buffer_load_dwordx4 v[48:51], v8, s[24:27], s50 offen offset:0 nt
    buffer_load_dwordx4 v[52:55], v9, s[24:27], s50 offen offset:1024 nt
    buffer_load_dwordx4 v[56:59], v10, s[24:27], s50 offen offset:2048 nt
    buffer_load_dwordx4 v[60:63], v11, s[24:27], s50 offen offset:3072 nt
    s_add_u32 s50, s47, 0
    buffer_load_dwordx4 v[64:67], v16, s[28:31], s50 offen offset:0 nt
    buffer_load_dwordx4 v[68:71], v16, s[28:31], s50 offen offset:1024 nt
    buffer_load_dwordx4 v[72:75], v16, s[28:31], s50 offen offset:2048 nt
    buffer_load_dwordx4 v[76:79], v16, s[28:31], s50 offen offset:3072 nt
    s_add_u32 s50, s47, 4096
    buffer_load_dwordx4 v[80:83], v16, s[28:31], s50 offen offset:0 nt
    buffer_load_dwordx4 v[84:87], v16, s[28:31], s50 offen offset:1024 nt
    buffer_load_dwordx4 v[88:91], v16, s[28:31], s50 offen offset:2048 nt
    buffer_load_dwordx4 v[92:95], v16, s[28:31], s50 offen offset:3072 nt
    s_add_u32 s50, s47, 16384
    buffer_load_dwordx4 v[96:99], v8, s[24:27], s50 offen offset:0 nt
    buffer_load_dwordx4 v[100:103], v9, s[24:27], s50 offen offset:1024 nt
    buffer_load_dwordx4 v[104:107], v10, s[24:27], s50 offen offset:2048 nt
    buffer_load_dwordx4 v[108:111], v11, s[24:27], s50 offen offset:3072 nt
    s_add_u32 s50, s47, 20480
    buffer_load_dwordx4 v[112:115], v8, s[24:27], s50 offen offset:0 nt
    buffer_load_dwordx4 v[116:119], v9, s[24:27], s50 offen offset:1024 nt
    buffer_load_dwordx4 v[120:123], v10, s[24:27], s50 offen offset:2048 nt
    buffer_load_dwordx4 v[124:127], v11, s[24:27], s50 offen offset:3072 nt
    s_add_u32 s50, s47, 8192
    buffer_load_dwordx4 v[128:131], v16, s[28:31], s50 offen offset:0 nt
    buffer_load_dwordx4 v[132:135], v16, s[28:31], s50 offen offset:1024 nt
    buffer_load_dwordx4 v[136:139], v16, s[28:31], s50 offen offset:2048 nt
    buffer_load_dwordx4 v[140:143], v16, s[28:31], s50 offen offset:3072 nt
    s_add_u32 s50, s47, 12288
    buffer_load_dwordx4 v[144:147], v16, s[28:31], s50 offen offset:0 nt
    buffer_load_dwordx4 v[148:151], v16, s[28:31], s50 offen offset:1024 nt
    buffer_load_dwordx4 v[152:155], v16, s[28:31], s50 offen offset:2048 nt
    buffer_load_dwordx4 v[156:159], v16, s[28:31], s50 offen offset:3072 nt
    s_add_u32 s50, s47, 24576
    buffer_load_dwordx4 v[160:163], v8, s[24:27], s50 offen offset:0 nt
    buffer_load_dwordx4 v[164:167], v9, s[24:27], s50 offen offset:1024 nt
    buffer_load_dwordx4 v[168:171], v10, s[24:27], s50 offen offset:2048 nt
    buffer_load_dwordx4 v[172:175], v11, s[24:27], s50 offen offset:3072 nt
    s_add_u32 s50, s47, 28672
    buffer_load_dwordx4 v[176:179], v8, s[24:27], s50 offen offset:0 nt
    buffer_load_dwordx4 v[180:183], v9, s[24:27], s50 offen offset:1024 nt
    buffer_load_dwordx4 v[184:187], v10, s[24:27], s50 offen offset:2048 nt
    buffer_load_dwordx4 v[188:191], v11, s[24:27], s50 offen offset:3072 nt
    s_waitcnt vmcnt(44)
    s_add_u32 s50, s47, 16384
    buffer_load_dwordx4 v[192:195], v16, s[28:31], s50 offen offset:0 nt
    buffer_load_dwordx4 v[196:199], v16, s[28:31], s50 offen offset:1024 nt
    buffer_load_dwordx4 v[200:203], v16, s[28:31], s50 offen offset:2048 nt
    buffer_load_dwordx4 v[204:207], v16, s[28:31], s50 offen offset:3072 nt
    s_waitcnt vmcnt(44)
    s_add_u32 s50, s47, 20480
    buffer_load_dwordx4 v[208:211], v16, s[28:31], s50 offen offset:0 nt
    buffer_load_dwordx4 v[212:215], v16, s[28:31], s50 offen offset:1024 nt
    buffer_load_dwordx4 v[216:219], v16, s[28:31], s50 offen offset:2048 nt
    buffer_load_dwordx4 v[220:223], v16, s[28:31], s50 offen offset:3072 nt
    s_waitcnt vmcnt(44)
    s_add_u32 s50, s47, 32768
    buffer_load_dwordx4 a[0:3], v8, s[24:27], s50 offen offset:0 nt
    buffer_load_dwordx4 a[4:7], v9, s[24:27], s50 offen offset:1024 nt
    buffer_load_dwordx4 a[8:11], v10, s[24:27], s50 offen offset:2048 nt
    buffer_load_dwordx4 a[12:15], v11, s[24:27], s50 offen offset:3072 nt
    s_waitcnt vmcnt(44)
    s_add_u32 s50, s47, 36864
    buffer_load_dwordx4 a[16:19], v8, s[24:27], s50 offen offset:0 nt
    buffer_load_dwordx4 a[20:23], v9, s[24:27], s50 offen offset:1024 nt
    buffer_load_dwordx4 a[24:27], v10, s[24:27], s50 offen offset:2048 nt
    buffer_load_dwordx4 a[28:31], v11, s[24:27], s50 offen offset:3072 nt
    s_waitcnt vmcnt(44)
    s_add_u32 s50, s47, 24576
    buffer_load_dwordx4 a[32:35], v16, s[28:31], s50 offen offset:0 nt
    buffer_load_dwordx4 a[36:39], v16, s[28:31], s50 offen offset:1024 nt
    buffer_load_dwordx4 a[40:43], v16, s[28:31], s50 offen offset:2048 nt
    buffer_load_dwordx4 a[44:47], v16, s[28:31], s50 offen offset:3072 nt
    s_waitcnt vmcnt(44)
    s_add_u32 s50, s47, 28672
    buffer_load_dwordx4 a[48:51], v16, s[28:31], s50 offen offset:0 nt
    buffer_load_dwordx4 a[52:55], v16, s[28:31], s50 offen offset:1024 nt
    buffer_load_dwordx4 a[56:59], v16, s[28:31], s50 offen offset:2048 nt
    buffer_load_dwordx4 a[60:63], v16, s[28:31], s50 offen offset:3072 nt
    s_waitcnt vmcnt(44)
    s_add_u32 s50, s47, 40960
    buffer_load_dwordx4 a[64:67], v8, s[24:27], s50 offen offset:0 nt
    buffer_load_dwordx4 a[68:71], v9, s[24:27], s50 offen offset:1024 nt
    buffer_load_dwordx4 a[72:75], v10, s[24:27], s50 offen offset:2048 nt
    buffer_load_dwordx4 a[76:79], v11, s[24:27], s50 offen offset:3072 nt
    s_waitcnt vmcnt(44)
    s_add_u32 s50, s47, 45056
    buffer_load_dwordx4 a[80:83], v8, s[24:27], s50 offen offset:0 nt
    buffer_load_dwordx4 a[84:87], v9, s[24:27], s50 offen offset:1024 nt
    buffer_load_dwordx4 a[88:91], v10, s[24:27], s50 offen offset:2048 nt
    buffer_load_dwordx4 a[92:95], v11, s[24:27], s50 offen offset:3072 nt
    s_waitcnt vmcnt(44)
    s_add_u32 s50, s47, 32768
    buffer_load_dwordx4 a[96:99], v16, s[28:31], s50 offen offset:0 nt
    buffer_load_dwordx4 a[100:103], v16, s[28:31], s50 offen offset:1024 nt
    buffer_load_dwordx4 a[104:107], v16, s[28:31], s50 offen offset:2048 nt
    buffer_load_dwordx4 a[108:111], v16, s[28:31], s50 offen offset:3072 nt
    s_waitcnt vmcnt(44)
    s_add_u32 s50, s47, 36864
    buffer_load_dwordx4 a[112:115], v16, s[28:31], s50 offen offset:0 nt
    buffer_load_dwordx4 a[116:119], v16, s[28:31], s50 offen offset:1024 nt
    buffer_load_dwordx4 a[120:123], v16, s[28:31], s50 offen offset:2048 nt
    buffer_load_dwordx4 a[124:127], v16, s[28:31], s50 offen offset:3072 nt
    s_waitcnt vmcnt(44)
    s_add_u32 s50, s47, 49152
    buffer_load_dwordx4 a[128:131], v8, s[24:27], s50 offen offset:0 nt
    buffer_load_dwordx4 a[132:135], v9, s[24:27], s50 offen offset:1024 nt
    buffer_load_dwordx4 a[136:139], v10, s[24:27], s50 offen offset:2048 nt
    buffer_load_dwordx4 a[140:143], v11, s[24:27], s50 offen offset:3072 nt
    s_waitcnt vmcnt(44)
    s_add_u32 s50, s47, 53248
    buffer_load_dwordx4 a[144:147], v8, s[24:27], s50 offen offset:0 nt
    buffer_load_dwordx4 a[148:151], v9, s[24:27], s50 offen offset:1024 nt
    buffer_load_dwordx4 a[152:155], v10, s[24:27], s50 offen offset:2048 nt
    buffer_load_dwordx4 a[156:159], v11, s[24:27], s50 offen offset:3072 nt
    s_waitcnt vmcnt(44)
    s_add_u32 s50, s47, 40960
    buffer_load_dwordx4 a[160:163], v16, s[28:31], s50 offen offset:0 nt
    buffer_load_dwordx4 a[164:167], v16, s[28:31], s50 offen offset:1024 nt
    buffer_load_dwordx4 a[168:171], v16, s[28:31], s50 offen offset:2048 nt
    buffer_load_dwordx4 a[172:175], v16, s[28:31], s50 offen offset:3072 nt
    s_waitcnt vmcnt(44)
    s_add_u32 s50, s47, 45056
    buffer_load_dwordx4 a[176:179], v16, s[28:31], s50 offen offset:0 nt
    buffer_load_dwordx4 a[180:183], v16, s[28:31], s50 offen offset:1024 nt
    buffer_load_dwordx4 a[184:187], v16, s[28:31], s50 offen offset:2048 nt
    buffer_load_dwordx4 a[188:191], v16, s[28:31], s50 offen offset:3072 nt
    s_waitcnt vmcnt(44)
    s_add_u32 s50, s47, 57344
    buffer_load_dwordx4 a[192:195], v8, s[24:27], s50 offen offset:0 nt
    buffer_load_dwordx4 a[196:199], v9, s[24:27], s50 offen offset:1024 nt
    buffer_load_dwordx4 a[200:203], v10, s[24:27], s50 offen offset:2048 nt
    buffer_load_dwordx4 a[204:207], v11, s[24:27], s50 offen offset:3072 nt
    s_waitcnt vmcnt(44)
    s_add_u32 s50, s47, 61440
    buffer_load_dwordx4 a[208:211], v8, s[24:27], s50 offen offset:0 nt
    buffer_load_dwordx4 a[212:215], v9, s[24:27], s50 offen offset:1024 nt
    buffer_load_dwordx4 a[216:219], v10, s[24:27], s50 offen offset:2048 nt
    buffer_load_dwordx4 a[220:223], v11, s[24:27], s50 offen offset:3072 nt
    s_waitcnt vmcnt(44)
    s_add_u32 s50, s47, 49152
    buffer_load_dwordx4 a[224:227], v16, s[28:31], s50 offen offset:0 nt
    buffer_load_dwordx4 a[228:231], v16, s[28:31], s50 offen offset:1024 nt
    buffer_load_dwordx4 a[232:235], v16, s[28:31], s50 offen offset:2048 nt
    buffer_load_dwordx4 a[236:239], v16, s[28:31], s50 offen offset:3072 nt
    s_waitcnt vmcnt(44)
    s_add_u32 s50, s47, 53248
    buffer_load_dwordx4 a[240:243], v16, s[28:31], s50 offen offset:0 nt
    buffer_load_dwordx4 a[244:247], v16, s[28:31], s50 offen offset:1024 nt
    buffer_load_dwordx4 a[248:251], v16, s[28:31], s50 offen offset:2048 nt
    buffer_load_dwordx4 a[252:255], v16, s[28:31], s50 offen offset:3072 nt
    v_mov_b32 v26, 1
    ds_write_b32 v18, v26 offset:8
    s_add_u32 s49, s55, 0
    s_mov_b32 m0, 131072
    s_nop 0
    buffer_load_dwordx4 v17, s[32:35], s49 offen lds
    s_mov_b32 m0, 132096
    s_add_u32 s49, s49, 32768
    buffer_load_dwordx4 v17, s[32:35], s49 offen lds
    s_mov_b32 m0, 133120
    s_add_u32 s49, s49, 32768
    buffer_load_dwordx4 v17, s[32:35], s49 offen lds
    s_mov_b32 m0, 134144
    s_add_u32 s49, s49, 32768
    buffer_load_dwordx4 v17, s[32:35], s49 offen lds
    s_mov_b32 m0, 135168
    s_add_u32 s49, s49, 32768
    buffer_load_dwordx4 v17, s[32:35], s49 offen lds
    s_mov_b32 m0, 136192
    s_add_u32 s49, s49, 32768
    buffer_load_dwordx4 v17, s[32:35], s49 offen lds
    s_mov_b32 m0, 137216
    s_add_u32 s49, s49, 32768
    buffer_load_dwordx4 v17, s[32:35], s49 offen lds
    s_mov_b32 m0, 138240
    s_add_u32 s49, s49, 32768
    buffer_load_dwordx4 v17, s[32:35], s49 offen lds
    s_mov_b32 m0, 139264
    s_add_u32 s49, s49, 32768
    buffer_load_dwordx4 v17, s[32:35], s49 offen lds
    s_mov_b32 m0, 140288
    s_add_u32 s49, s49, 32768
    buffer_load_dwordx4 v17, s[32:35], s49 offen lds
    s_mov_b32 m0, 141312
    s_add_u32 s49, s49, 32768
    buffer_load_dwordx4 v17, s[32:35], s49 offen lds
    s_mov_b32 m0, 142336
    s_add_u32 s49, s49, 32768
    buffer_load_dwordx4 v17, s[32:35], s49 offen lds
    s_mov_b32 m0, 143360
    s_add_u32 s49, s49, 32768
    buffer_load_dwordx4 v17, s[32:35], s49 offen lds
    s_mov_b32 m0, 144384
    s_add_u32 s49, s49, 32768
    buffer_load_dwordx4 v17, s[32:35], s49 offen lds
    s_mov_b32 m0, 145408
    s_add_u32 s49, s49, 32768
    buffer_load_dwordx4 v17, s[32:35], s49 offen lds
    s_mov_b32 m0, 146432
    s_add_u32 s49, s49, 32768
    buffer_load_dwordx4 v17, s[32:35], s49 offen lds
    s_add_u32 s49, s55, 524288
    s_mov_b32 m0, 147456
    s_nop 0
    buffer_load_dwordx4 v17, s[32:35], s49 offen lds
    s_mov_b32 m0, 148480
    s_add_u32 s49, s49, 32768
    buffer_load_dwordx4 v17, s[32:35], s49 offen lds
    s_mov_b32 m0, 149504
    s_add_u32 s49, s49, 32768
    buffer_load_dwordx4 v17, s[32:35], s49 offen lds
    s_mov_b32 m0, 150528
    s_add_u32 s49, s49, 32768
    buffer_load_dwordx4 v17, s[32:35], s49 offen lds
    s_mov_b32 m0, 151552
    s_add_u32 s49, s49, 32768
    buffer_load_dwordx4 v17, s[32:35], s49 offen lds
    s_mov_b32 m0, 152576
    s_add_u32 s49, s49, 32768
    buffer_load_dwordx4 v17, s[32:35], s49 offen lds
    s_mov_b32 m0, 153600
    s_add_u32 s49, s49, 32768
    buffer_load_dwordx4 v17, s[32:35], s49 offen lds
    s_mov_b32 m0, 154624
    s_add_u32 s49, s49, 32768
    buffer_load_dwordx4 v17, s[32:35], s49 offen lds
    s_mov_b32 m0, 65536
    s_add_u32 s49, s49, 32768
    buffer_load_dwordx4 v17, s[32:35], s49 offen lds
    s_mov_b32 m0, 66560
    s_add_u32 s49, s49, 32768
    buffer_load_dwordx4 v17, s[32:35], s49 offen lds
    s_mov_b32 m0, 67584
    s_add_u32 s49, s49, 32768
    buffer_load_dwordx4 v17, s[32:35], s49 offen lds
    s_mov_b32 m0, 68608
    s_add_u32 s49, s49, 32768
    buffer_load_dwordx4 v17, s[32:35], s49 offen lds
    s_mov_b32 m0, 69632
    s_add_u32 s49, s49, 32768
    buffer_load_dwordx4 v17, s[32:35], s49 offen lds
    s_mov_b32 m0, 70656
    s_add_u32 s49, s49, 32768
    buffer_load_dwordx4 v17, s[32:35], s49 offen lds
    s_mov_b32 m0, 71680
    s_add_u32 s49, s49, 32768
    buffer_load_dwordx4 v17, s[32:35], s49 offen lds
    s_mov_b32 m0, 72704
    s_add_u32 s49, s49, 32768
    buffer_load_dwordx4 v17, s[32:35], s49 offen lds
    s_add_u32 s49, s55, 1048576
    s_mov_b32 m0, 8192
    s_nop 0
    buffer_load_dwordx4 v17, s[32:35], s49 offen lds
    s_mov_b32 m0, 9216
    s_add_u32 s49, s49, 32768
    buffer_load_dwordx4 v17, s[32:35], s49 offen lds
    s_mov_b32 m0, 10240
    s_add_u32 s49, s49, 32768
    buffer_load_dwordx4 v17, s[32:35], s49 offen lds
    s_mov_b32 m0, 11264
    s_add_u32 s49, s49, 32768
    buffer_load_dwordx4 v17, s[32:35], s49 offen lds
    s_mov_b32 m0, 12288
    s_add_u32 s49, s49, 32768
    buffer_load_dwordx4 v17, s[32:35], s49 offen lds
    s_mov_b32 m0, 13312
    s_add_u32 s49, s49, 32768
    buffer_load_dwordx4 v17, s[32:35], s49 offen lds
    s_mov_b32 m0, 14336
    s_add_u32 s49, s49, 32768
    buffer_load_dwordx4 v17, s[32:35], s49 offen lds
    s_mov_b32 m0, 15360
    s_add_u32 s49, s49, 32768
    buffer_load_dwordx4 v17, s[32:35], s49 offen lds
    s_mov_b32 m0, 16384
    s_add_u32 s49, s49, 32768
    buffer_load_dwordx4 v17, s[32:35], s49 offen lds
    s_mov_b32 m0, 17408
    s_add_u32 s49, s49, 32768
    buffer_load_dwordx4 v17, s[32:35], s49 offen lds
    s_mov_b32 m0, 18432
    s_add_u32 s49, s49, 32768
    buffer_load_dwordx4 v17, s[32:35], s49 offen lds
    s_mov_b32 m0, 19456
    s_add_u32 s49, s49, 32768
    buffer_load_dwordx4 v17, s[32:35], s49 offen lds
    s_mov_b32 m0, 20480
    s_add_u32 s49, s49, 32768
    buffer_load_dwordx4 v17, s[32:35], s49 offen lds
    s_mov_b32 m0, 21504
    s_add_u32 s49, s49, 32768
    buffer_load_dwordx4 v17, s[32:35], s49 offen lds
    s_mov_b32 m0, 22528
    s_add_u32 s49, s49, 32768
    buffer_load_dwordx4 v17, s[32:35], s49 offen lds
    s_mov_b32 m0, 23552
    s_add_u32 s49, s49, 32768
    buffer_load_dwordx4 v17, s[32:35], s49 offen lds
    s_waitcnt vmcnt(40)
    s_add_u32 s49, s55, 1572864
    s_mov_b32 m0, 73728
    s_nop 0
    buffer_load_dwordx4 v17, s[32:35], s49 offen lds
    s_mov_b32 m0, 74752
    s_add_u32 s49, s49, 32768
    buffer_load_dwordx4 v17, s[32:35], s49 offen lds
    s_mov_b32 m0, 75776
    s_add_u32 s49, s49, 32768
    buffer_load_dwordx4 v17, s[32:35], s49 offen lds
    s_mov_b32 m0, 76800
    s_add_u32 s49, s49, 32768
    buffer_load_dwordx4 v17, s[32:35], s49 offen lds
    s_mov_b32 m0, 77824
    s_add_u32 s49, s49, 32768
    buffer_load_dwordx4 v17, s[32:35], s49 offen lds
    s_mov_b32 m0, 78848
    s_add_u32 s49, s49, 32768
    buffer_load_dwordx4 v17, s[32:35], s49 offen lds
    s_mov_b32 m0, 79872
    s_add_u32 s49, s49, 32768
    buffer_load_dwordx4 v17, s[32:35], s49 offen lds
    s_mov_b32 m0, 80896
    s_add_u32 s49, s49, 32768
    buffer_load_dwordx4 v17, s[32:35], s49 offen lds
    s_mov_b32 m0, 81920
    s_add_u32 s49, s49, 32768
    buffer_load_dwordx4 v17, s[32:35], s49 offen lds
    s_mov_b32 m0, 82944
    s_add_u32 s49, s49, 32768
    buffer_load_dwordx4 v17, s[32:35], s49 offen lds
    s_mov_b32 m0, 83968
    s_add_u32 s49, s49, 32768
    buffer_load_dwordx4 v17, s[32:35], s49 offen lds
    s_mov_b32 m0, 84992
    s_add_u32 s49, s49, 32768
    buffer_load_dwordx4 v17, s[32:35], s49 offen lds
    s_mov_b32 m0, 86016
    s_add_u32 s49, s49, 32768
    buffer_load_dwordx4 v17, s[32:35], s49 offen lds
    s_mov_b32 m0, 87040
    s_add_u32 s49, s49, 32768
    buffer_load_dwordx4 v17, s[32:35], s49 offen lds
    s_mov_b32 m0, 88064
    s_add_u32 s49, s49, 32768
    buffer_load_dwordx4 v17, s[32:35], s49 offen lds
    s_mov_b32 m0, 89088
    s_add_u32 s49, s49, 32768
    buffer_load_dwordx4 v17, s[32:35], s49 offen lds
    s_waitcnt vmcnt(40)
    v_mov_b32 v26, 1
    ds_write_b32 v18, v26 offset:4
    s_add_u32 s49, s55, 2097152
    s_mov_b32 m0, 24576
    s_nop 0
    buffer_load_dwordx4 v17, s[32:35], s49 offen lds
    s_mov_b32 m0, 25600
    s_add_u32 s49, s49, 32768
    buffer_load_dwordx4 v17, s[32:35], s49 offen lds
    s_mov_b32 m0, 26624
    s_add_u32 s49, s49, 32768
    buffer_load_dwordx4 v17, s[32:35], s49 offen lds
    s_mov_b32 m0, 27648
    s_add_u32 s49, s49, 32768
    buffer_load_dwordx4 v17, s[32:35], s49 offen lds
    s_mov_b32 m0, 28672
    s_add_u32 s49, s49, 32768
    buffer_load_dwordx4 v17, s[32:35], s49 offen lds
    s_mov_b32 m0, 29696
    s_add_u32 s49, s49, 32768
    buffer_load_dwordx4 v17, s[32:35], s49 offen lds
    s_mov_b32 m0, 30720
    s_add_u32 s49, s49, 32768
    buffer_load_dwordx4 v17, s[32:35], s49 offen lds
    s_mov_b32 m0, 31744
    s_add_u32 s49, s49, 32768
    buffer_load_dwordx4 v17, s[32:35], s49 offen lds
    s_mov_b32 m0, 32768
    s_add_u32 s49, s49, 32768
    buffer_load_dwordx4 v17, s[32:35], s49 offen lds
    s_mov_b32 m0, 33792
    s_add_u32 s49, s49, 32768
    buffer_load_dwordx4 v17, s[32:35], s49 offen lds
    s_mov_b32 m0, 34816
    s_add_u32 s49, s49, 32768
    buffer_load_dwordx4 v17, s[32:35], s49 offen lds
    s_mov_b32 m0, 35840
    s_add_u32 s49, s49, 32768
    buffer_load_dwordx4 v17, s[32:35], s49 offen lds
    s_mov_b32 m0, 36864
    s_add_u32 s49, s49, 32768
    buffer_load_dwordx4 v17, s[32:35], s49 offen lds
    s_mov_b32 m0, 37888
    s_add_u32 s49, s49, 32768
    buffer_load_dwordx4 v17, s[32:35], s49 offen lds
    s_mov_b32 m0, 38912
    s_add_u32 s49, s49, 32768
    buffer_load_dwordx4 v17, s[32:35], s49 offen lds
    s_mov_b32 m0, 39936
    s_add_u32 s49, s49, 32768
    buffer_load_dwordx4 v17, s[32:35], s49 offen lds
    s_waitcnt vmcnt(40)
    v_mov_b32 v26, 2
    ds_write_b32 v18, v26 offset:4
    s_add_u32 s49, s55, 2621440
    s_mov_b32 m0, 90112
    s_nop 0
    buffer_load_dwordx4 v17, s[32:35], s49 offen lds
    s_mov_b32 m0, 91136
    s_add_u32 s49, s49, 32768
    buffer_load_dwordx4 v17, s[32:35], s49 offen lds
    s_mov_b32 m0, 92160
    s_add_u32 s49, s49, 32768
    buffer_load_dwordx4 v17, s[32:35], s49 offen lds
    s_mov_b32 m0, 93184
    s_add_u32 s49, s49, 32768
    buffer_load_dwordx4 v17, s[32:35], s49 offen lds
    s_mov_b32 m0, 94208
    s_add_u32 s49, s49, 32768
    buffer_load_dwordx4 v17, s[32:35], s49 offen lds
    s_mov_b32 m0, 95232
    s_add_u32 s49, s49, 32768
    buffer_load_dwordx4 v17, s[32:35], s49 offen lds
    s_mov_b32 m0, 96256
    s_add_u32 s49, s49, 32768
    buffer_load_dwordx4 v17, s[32:35], s49 offen lds
    s_mov_b32 m0, 97280
    s_add_u32 s49, s49, 32768
    buffer_load_dwordx4 v17, s[32:35], s49 offen lds
    s_mov_b32 m0, 98304
    s_add_u32 s49, s49, 32768
    buffer_load_dwordx4 v17, s[32:35], s49 offen lds
    s_mov_b32 m0, 99328
    s_add_u32 s49, s49, 32768
    buffer_load_dwordx4 v17, s[32:35], s49 offen lds
    s_mov_b32 m0, 100352
    s_add_u32 s49, s49, 32768
    buffer_load_dwordx4 v17, s[32:35], s49 offen lds
    s_mov_b32 m0, 101376
    s_add_u32 s49, s49, 32768
    buffer_load_dwordx4 v17, s[32:35], s49 offen lds
    s_mov_b32 m0, 102400
    s_add_u32 s49, s49, 32768
    buffer_load_dwordx4 v17, s[32:35], s49 offen lds
    s_mov_b32 m0, 103424
    s_add_u32 s49, s49, 32768
    buffer_load_dwordx4 v17, s[32:35], s49 offen lds
    s_mov_b32 m0, 104448
    s_add_u32 s49, s49, 32768
    buffer_load_dwordx4 v17, s[32:35], s49 offen lds
    s_mov_b32 m0, 105472
    s_add_u32 s49, s49, 32768
    buffer_load_dwordx4 v17, s[32:35], s49 offen lds
    s_waitcnt vmcnt(40)
    v_mov_b32 v26, 3
    ds_write_b32 v18, v26 offset:4
    s_cmp_ge_u32 s59, 1
    s_cbranch_scc1 K1_P56_OK
K1_P56:
    ds_read_b96 v[28:30], v18 offset:16
    s_waitcnt lgkmcnt(0)
    v_min3_u32 v28, v28, v29, v30
    s_nop 0
    v_readfirstlane_b32 s59, v28
    s_cmp_ge_u32 s59, 1
    s_cbranch_scc0 K1_P56
K1_P56_OK:
    s_add_u32 s49, s55, 3145728
    s_mov_b32 m0, 131072
    s_nop 0
    buffer_load_dwordx4 v17, s[32:35], s49 offen lds
    s_mov_b32 m0, 132096
    s_add_u32 s49, s49, 32768
    buffer_load_dwordx4 v17, s[32:35], s49 offen lds
    s_mov_b32 m0, 133120
    s_add_u32 s49, s49, 32768
    buffer_load_dwordx4 v17, s[32:35], s49 offen lds
    s_mov_b32 m0, 134144
    s_add_u32 s49, s49, 32768
    buffer_load_dwordx4 v17, s[32:35], s49 offen lds
    s_mov_b32 m0, 135168
    s_add_u32 s49, s49, 32768
    buffer_load_dwordx4 v17, s[32:35], s49 offen lds
    s_mov_b32 m0, 136192
    s_add_u32 s49, s49, 32768
    buffer_load_dwordx4 v17, s[32:35], s49 offen lds
    s_mov_b32 m0, 137216
    s_add_u32 s49, s49, 32768
    buffer_load_dwordx4 v17, s[32:35], s49 offen lds
    s_mov_b32 m0, 138240
    s_add_u32 s49, s49, 32768
    buffer_load_dwordx4 v17, s[32:35], s49 offen lds
    s_mov_b32 m0, 139264
    s_add_u32 s49, s49, 32768
    buffer_load_dwordx4 v17, s[32:35], s49 offen lds
    s_mov_b32 m0, 140288
    s_add_u32 s49, s49, 32768
    buffer_load_dwordx4 v17, s[32:35], s49 offen lds
    s_mov_b32 m0, 141312
    s_add_u32 s49, s49, 32768
    buffer_load_dwordx4 v17, s[32:35], s49 offen lds
    s_mov_b32 m0, 142336
    s_add_u32 s49, s49, 32768
    buffer_load_dwordx4 v17, s[32:35], s49 offen lds
    s_mov_b32 m0, 143360
    s_add_u32 s49, s49, 32768
    buffer_load_dwordx4 v17, s[32:35], s49 offen lds
    s_mov_b32 m0, 144384
    s_add_u32 s49, s49, 32768
    buffer_load_dwordx4 v17, s[32:35], s49 offen lds
    s_mov_b32 m0, 145408
    s_add_u32 s49, s49, 32768
    buffer_load_dwordx4 v17, s[32:35], s49 offen lds
    s_mov_b32 m0, 146432
    s_add_u32 s49, s49, 32768
    buffer_load_dwordx4 v17, s[32:35], s49 offen lds
    s_waitcnt vmcnt(40)
    v_mov_b32 v26, 4
    ds_write_b32 v18, v26 offset:4
    s_cmp_ge_u32 s59, 2
    s_cbranch_scc1 K1_P57_OK
K1_P57:
    ds_read_b96 v[28:30], v18 offset:16
    s_waitcnt lgkmcnt(0)
    v_min3_u32 v28, v28, v29, v30
    s_nop 0
    v_readfirstlane_b32 s59, v28
    s_cmp_ge_u32 s59, 2
    s_cbranch_scc0 K1_P57
K1_P57_OK:
    s_add_u32 s49, s55, 3670016
    s_mov_b32 m0, 147456
    s_nop 0
    buffer_load_dwordx4 v17, s[32:35], s49 offen lds
    s_mov_b32 m0, 148480
    s_add_u32 s49, s49, 32768
    buffer_load_dwordx4 v17, s[32:35], s49 offen lds
    s_mov_b32 m0, 149504
    s_add_u32 s49, s49, 32768
    buffer_load_dwordx4 v17, s[32:35], s49 offen lds
    s_mov_b32 m0, 150528
    s_add_u32 s49, s49, 32768
    buffer_load_dwordx4 v17, s[32:35], s49 offen lds
    s_mov_b32 m0, 151552
    s_add_u32 s49, s49, 32768
    buffer_load_dwordx4 v17, s[32:35], s49 offen lds
    s_mov_b32 m0, 152576
    s_add_u32 s49, s49, 32768
    buffer_load_dwordx4 v17, s[32:35], s49 offen lds
    s_mov_b32 m0, 153600
    s_add_u32 s49, s49, 32768
    buffer_load_dwordx4 v17, s[32:35], s49 offen lds
    s_mov_b32 m0, 154624
    s_add_u32 s49, s49, 32768
    buffer_load_dwordx4 v17, s[32:35], s49 offen lds
    s_mov_b32 m0, 65536
    s_add_u32 s49, s49, 32768
    buffer_load_dwordx4 v17, s[32:35], s49 offen lds
    s_mov_b32 m0, 66560
    s_add_u32 s49, s49, 32768
    buffer_load_dwordx4 v17, s[32:35], s49 offen lds
    s_mov_b32 m0, 67584
    s_add_u32 s49, s49, 32768
    buffer_load_dwordx4 v17, s[32:35], s49 offen lds
    s_mov_b32 m0, 68608
    s_add_u32 s49, s49, 32768
    buffer_load_dwordx4 v17, s[32:35], s49 offen lds
    s_mov_b32 m0, 69632
    s_add_u32 s49, s49, 32768
    buffer_load_dwordx4 v17, s[32:35], s49 offen lds
    s_mov_b32 m0, 70656
    s_add_u32 s49, s49, 32768
    buffer_load_dwordx4 v17, s[32:35], s49 offen lds
    s_mov_b32 m0, 71680
    s_add_u32 s49, s49, 32768
    buffer_load_dwordx4 v17, s[32:35], s49 offen lds
    s_mov_b32 m0, 72704
    s_add_u32 s49, s49, 32768
    buffer_load_dwordx4 v17, s[32:35], s49 offen lds
    s_waitcnt vmcnt(40)
    v_mov_b32 v26, 5
    ds_write_b32 v18, v26 offset:4
    v_mov_b32 v26, 1
    ds_write_b32 v18, v26 offset:0
    s_waitcnt vmcnt(32)
    v_mov_b32 v26, 6
    ds_write_b32 v18, v26 offset:4
    s_waitcnt vmcnt(16)
    v_mov_b32 v26, 7
    ds_write_b32 v18, v26 offset:4
    s_waitcnt vmcnt(0)
    v_mov_b32 v26, 8
    ds_write_b32 v18, v26 offset:4
    s_cmp_ge_u32 s59, 4
    s_cbranch_scc1 K1_P58_OK
K1_P58:
    ds_read_b96 v[28:30], v18 offset:16
    s_waitcnt lgkmcnt(0)
    v_min3_u32 v28, v28, v29, v30
    s_nop 0
    v_readfirstlane_b32 s59, v28
    s_cmp_ge_u32 s59, 4
    s_cbranch_scc0 K1_P58
K1_P58_OK:
    ds_write_b128 v24, v[32:35] offset:8192
    ds_write_b128 v24, v[36:39] offset:9216
    ds_write_b128 v24, v[40:43] offset:10240
    ds_write_b128 v24, v[44:47] offset:11264
    ds_write_b128 v24, v[48:51] offset:12288
    ds_write_b128 v24, v[52:55] offset:13312
    ds_write_b128 v24, v[56:59] offset:14336
    ds_write_b128 v24, v[60:63] offset:15360
    ds_write_b128 v25, v[64:67] offset:8192
    ds_write_b128 v25, v[68:71] offset:9216
    ds_write_b128 v25, v[72:75] offset:10240
    ds_write_b128 v25, v[76:79] offset:11264
    ds_write_b128 v25, v[80:83] offset:12288
    ds_write_b128 v25, v[84:87] offset:13312
    ds_write_b128 v25, v[88:91] offset:14336
    ds_write_b128 v25, v[92:95] offset:15360
    s_waitcnt lgkmcnt(0)
    v_mov_b32 v26, 2
    ds_write_b32 v18, v26 offset:0
    s_add_u32 s50, s47, 65536
    buffer_load_dwordx4 v[32:35], v8, s[24:27], s50 offen offset:0 nt
    buffer_load_dwordx4 v[36:39], v9, s[24:27], s50 offen offset:1024 nt
    buffer_load_dwordx4 v[40:43], v10, s[24:27], s50 offen offset:2048 nt
    buffer_load_dwordx4 v[44:47], v11, s[24:27], s50 offen offset:3072 nt
    s_add_u32 s50, s47, 69632
    buffer_load_dwordx4 v[48:51], v8, s[24:27], s50 offen offset:0 nt
    buffer_load_dwordx4 v[52:55], v9, s[24:27], s50 offen offset:1024 nt
    buffer_load_dwordx4 v[56:59], v10, s[24:27], s50 offen offset:2048 nt
    buffer_load_dwordx4 v[60:63], v11, s[24:27], s50 offen offset:3072 nt
    s_add_u32 s50, s47, 57344
    buffer_load_dwordx4 v[64:67], v16, s[28:31], s50 offen offset:0 nt
    buffer_load_dwordx4 v[68:71], v16, s[28:31], s50 offen offset:1024 nt
    buffer_load_dwordx4 v[72:75], v16, s[28:31], s50 offen offset:2048 nt
    buffer_load_dwordx4 v[76:79], v16, s[28:31], s50 offen offset:3072 nt
    s_add_u32 s50, s47, 61440
    buffer_load_dwordx4 v[80:83], v16, s[28:31], s50 offen offset:0 nt
    buffer_load_dwordx4 v[84:87], v16, s[28:31], s50 offen offset:1024 nt
    buffer_load_dwordx4 v[88:91], v16, s[28:31], s50 offen offset:2048 nt
    buffer_load_dwordx4 v[92:95], v16, s[28:31], s50 offen offset:3072 nt
    s_cmp_ge_u32 s59, 4
    s_cbranch_scc1 K1_P59_OK
K1_P59:
    ds_read_b96 v[28:30], v18 offset:16
    s_waitcnt lgkmcnt(0)
    v_min3_u32 v28, v28, v29, v30
    s_nop 0
    v_readfirstlane_b32 s59, v28
    s_cmp_ge_u32 s59, 4
    s_cbranch_scc0 K1_P59
K1_P59_OK:
    ds_write_b128 v24, v[96:99] offset:16384
    ds_write_b128 v24, v[100:103] offset:17408
    ds_write_b128 v24, v[104:107] offset:18432
    ds_write_b128 v24, v[108:111] offset:19456
    ds_write_b128 v24, v[112:115] offset:20480
    ds_write_b128 v24, v[116:119] offset:21504
    ds_write_b128 v24, v[120:123] offset:22528
    ds_write_b128 v24, v[124:127] offset:23552
    ds_write_b128 v25, v[128:131] offset:16384
    ds_write_b128 v25, v[132:135] offset:17408
    ds_write_b128 v25, v[136:139] offset:18432
    ds_write_b128 v25, v[140:143] offset:19456
    ds_write_b128 v25, v[144:147] offset:20480
    ds_write_b128 v25, v[148:151] offset:21504
    ds_write_b128 v25, v[152:155] offset:22528
    ds_write_b128 v25, v[156:159] offset:23552
    s_waitcnt lgkmcnt(0)
    v_mov_b32 v26, 3
    ds_write_b32 v18, v26 offset:0
    s_add_u32 s50, s47, 73728
    buffer_load_dwordx4 v[96:99], v8, s[24:27], s50 offen offset:0 nt
    buffer_load_dwordx4 v[100:103], v9, s[24:27], s50 offen offset:1024 nt
    buffer_load_dwordx4 v[104:107], v10, s[24:27], s50 offen offset:2048 nt
    buffer_load_dwordx4 v[108:111], v11, s[24:27], s50 offen offset:3072 nt
    s_add_u32 s50, s47, 77824
    buffer_load_dwordx4 v[112:115], v8, s[24:27], s50 offen offset:0 nt
    buffer_load_dwordx4 v[116:119], v9, s[24:27], s50 offen offset:1024 nt
    buffer_load_dwordx4 v[120:123], v10, s[24:27], s50 offen offset:2048 nt
    buffer_load_dwordx4 v[124:127], v11, s[24:27], s50 offen offset:3072 nt
    s_add_u32 s50, s47, 65536
    buffer_load_dwordx4 v[128:131], v16, s[28:31], s50 offen offset:0 nt
    buffer_load_dwordx4 v[132:135], v16, s[28:31], s50 offen offset:1024 nt
    buffer_load_dwordx4 v[136:139], v16, s[28:31], s50 offen offset:2048 nt
    buffer_load_dwordx4 v[140:143], v16, s[28:31], s50 offen offset:3072 nt
    s_add_u32 s50, s47, 69632
    buffer_load_dwordx4 v[144:147], v16, s[28:31], s50 offen offset:0 nt
    buffer_load_dwordx4 v[148:151], v16, s[28:31], s50 offen offset:1024 nt
    buffer_load_dwordx4 v[152:155], v16, s[28:31], s50 offen offset:2048 nt
    buffer_load_dwordx4 v[156:159], v16, s[28:31], s50 offen offset:3072 nt
    s_cmp_ge_u32 s59, 6
    s_cbranch_scc1 K1_P60_OK
K1_P60:
    ds_read_b96 v[28:30], v18 offset:16
    s_waitcnt lgkmcnt(0)
    v_min3_u32 v28, v28, v29, v30
    s_nop 0
    v_readfirstlane_b32 s59, v28
    s_cmp_ge_u32 s59, 6
    s_cbranch_scc0 K1_P60
K1_P60_OK:
    ds_write_b128 v24, v[160:163] offset:24576
    ds_write_b128 v24, v[164:167] offset:25600
    ds_write_b128 v24, v[168:171] offset:26624
    ds_write_b128 v24, v[172:175] offset:27648
    ds_write_b128 v24, v[176:179] offset:28672
    ds_write_b128 v24, v[180:183] offset:29696
    ds_write_b128 v24, v[184:187] offset:30720
    ds_write_b128 v24, v[188:191] offset:31744
    ds_write_b128 v25, v[192:195] offset:24576
    ds_write_b128 v25, v[196:199] offset:25600
    ds_write_b128 v25, v[200:203] offset:26624
    ds_write_b128 v25, v[204:207] offset:27648
    ds_write_b128 v25, v[208:211] offset:28672
    ds_write_b128 v25, v[212:215] offset:29696
    ds_write_b128 v25, v[216:219] offset:30720
    ds_write_b128 v25, v[220:223] offset:31744
    s_waitcnt lgkmcnt(0)
    v_mov_b32 v26, 4
    ds_write_b32 v18, v26 offset:0
    s_add_u32 s50, s47, 81920
    buffer_load_dwordx4 v[160:163], v8, s[24:27], s50 offen offset:0 nt
    buffer_load_dwordx4 v[164:167], v9, s[24:27], s50 offen offset:1024 nt
    buffer_load_dwordx4 v[168:171], v10, s[24:27], s50 offen offset:2048 nt
    buffer_load_dwordx4 v[172:175], v11, s[24:27], s50 offen offset:3072 nt
    s_add_u32 s50, s47, 86016
    buffer_load_dwordx4 v[176:179], v8, s[24:27], s50 offen offset:0 nt
    buffer_load_dwordx4 v[180:183], v9, s[24:27], s50 offen offset:1024 nt
    buffer_load_dwordx4 v[184:187], v10, s[24:27], s50 offen offset:2048 nt
    buffer_load_dwordx4 v[188:191], v11, s[24:27], s50 offen offset:3072 nt
    s_add_u32 s50, s47, 73728
    buffer_load_dwordx4 v[192:195], v16, s[28:31], s50 offen offset:0 nt
    buffer_load_dwordx4 v[196:199], v16, s[28:31], s50 offen offset:1024 nt
    buffer_load_dwordx4 v[200:203], v16, s[28:31], s50 offen offset:2048 nt
    buffer_load_dwordx4 v[204:207], v16, s[28:31], s50 offen offset:3072 nt
    s_add_u32 s50, s47, 77824
    buffer_load_dwordx4 v[208:211], v16, s[28:31], s50 offen offset:0 nt
    buffer_load_dwordx4 v[212:215], v16, s[28:31], s50 offen offset:1024 nt
    buffer_load_dwordx4 v[216:219], v16, s[28:31], s50 offen offset:2048 nt
    buffer_load_dwordx4 v[220:223], v16, s[28:31], s50 offen offset:3072 nt
    s_cmp_ge_u32 s59, 6
    s_cbranch_scc1 K1_P61_OK
K1_P61:
    ds_read_b96 v[28:30], v18 offset:16
    s_waitcnt lgkmcnt(0)
    v_min3_u32 v28, v28, v29, v30
    s_nop 0
    v_readfirstlane_b32 s59, v28
    s_cmp_ge_u32 s59, 6
    s_cbranch_scc0 K1_P61
K1_P61_OK:
    ds_write_b128 v24, a[0:3] offset:32768
    ds_write_b128 v24, a[4:7] offset:33792
    ds_write_b128 v24, a[8:11] offset:34816
    ds_write_b128 v24, a[12:15] offset:35840
    ds_write_b128 v24, a[16:19] offset:36864
    ds_write_b128 v24, a[20:23] offset:37888
    ds_write_b128 v24, a[24:27] offset:38912
    ds_write_b128 v24, a[28:31] offset:39936
    ds_write_b128 v25, a[32:35] offset:32768
    ds_write_b128 v25, a[36:39] offset:33792
    ds_write_b128 v25, a[40:43] offset:34816
    ds_write_b128 v25, a[44:47] offset:35840
    ds_write_b128 v25, a[48:51] offset:36864
    ds_write_b128 v25, a[52:55] offset:37888
    ds_write_b128 v25, a[56:59] offset:38912
    ds_write_b128 v25, a[60:63] offset:39936
    s_waitcnt lgkmcnt(0)
    v_mov_b32 v26, 5
    ds_write_b32 v18, v26 offset:0
    s_add_u32 s50, s47, 90112
    buffer_load_dwordx4 a[0:3], v8, s[24:27], s50 offen offset:0 nt
    buffer_load_dwordx4 a[4:7], v9, s[24:27], s50 offen offset:1024 nt
    buffer_load_dwordx4 a[8:11], v10, s[24:27], s50 offen offset:2048 nt
    buffer_load_dwordx4 a[12:15], v11, s[24:27], s50 offen offset:3072 nt
    s_add_u32 s50, s47, 94208
    buffer_load_dwordx4 a[16:19], v8, s[24:27], s50 offen offset:0 nt
    buffer_load_dwordx4 a[20:23], v9, s[24:27], s50 offen offset:1024 nt
    buffer_load_dwordx4 a[24:27], v10, s[24:27], s50 offen offset:2048 nt
    buffer_load_dwordx4 a[28:31], v11, s[24:27], s50 offen offset:3072 nt
    s_add_u32 s50, s47, 81920
    buffer_load_dwordx4 a[32:35], v16, s[28:31], s50 offen offset:0 nt
    buffer_load_dwordx4 a[36:39], v16, s[28:31], s50 offen offset:1024 nt
    buffer_load_dwordx4 a[40:43], v16, s[28:31], s50 offen offset:2048 nt
    buffer_load_dwordx4 a[44:47], v16, s[28:31], s50 offen offset:3072 nt
    s_add_u32 s50, s47, 86016
    buffer_load_dwordx4 a[48:51], v16, s[28:31], s50 offen offset:0 nt
    buffer_load_dwordx4 a[52:55], v16, s[28:31], s50 offen offset:1024 nt
    buffer_load_dwordx4 a[56:59], v16, s[28:31], s50 offen offset:2048 nt
    buffer_load_dwordx4 a[60:63], v16, s[28:31], s50 offen offset:3072 nt
    s_cmp_ge_u32 s59, 6
    s_cbranch_scc1 K1_P62_OK
K1_P62:
    ds_read_b96 v[28:30], v18 offset:16
    s_waitcnt lgkmcnt(0)
    v_min3_u32 v28, v28, v29, v30
    s_nop 0
    v_readfirstlane_b32 s59, v28
    s_cmp_ge_u32 s59, 6
    s_cbranch_scc0 K1_P62
K1_P62_OK:
    ds_write_b128 v24, a[64:67] offset:40960
    ds_write_b128 v24, a[68:71] offset:41984
    ds_write_b128 v24, a[72:75] offset:43008
    ds_write_b128 v24, a[76:79] offset:44032
    ds_write_b128 v24, a[80:83] offset:45056
    ds_write_b128 v24, a[84:87] offset:46080
    ds_write_b128 v24, a[88:91] offset:47104
    ds_write_b128 v24, a[92:95] offset:48128
    ds_write_b128 v25, a[96:99] offset:40960
    ds_write_b128 v25, a[100:103] offset:41984
    ds_write_b128 v25, a[104:107] offset:43008
    ds_write_b128 v25, a[108:111] offset:44032
    ds_write_b128 v25, a[112:115] offset:45056
    ds_write_b128 v25, a[116:119] offset:46080
    ds_write_b128 v25, a[120:123] offset:47104
    ds_write_b128 v25, a[124:127] offset:48128
    s_waitcnt lgkmcnt(0)
    v_mov_b32 v26, 6
    ds_write_b32 v18, v26 offset:0
    s_add_u32 s50, s47, 98304
    buffer_load_dwordx4 a[64:67], v8, s[24:27], s50 offen offset:0 nt
    buffer_load_dwordx4 a[68:71], v9, s[24:27], s50 offen offset:1024 nt
    buffer_load_dwordx4 a[72:75], v10, s[24:27], s50 offen offset:2048 nt
    buffer_load_dwordx4 a[76:79], v11, s[24:27], s50 offen offset:3072 nt
    s_add_u32 s50, s47, 102400
    buffer_load_dwordx4 a[80:83], v8, s[24:27], s50 offen offset:0 nt
    buffer_load_dwordx4 a[84:87], v9, s[24:27], s50 offen offset:1024 nt
    buffer_load_dwordx4 a[88:91], v10, s[24:27], s50 offen offset:2048 nt
    buffer_load_dwordx4 a[92:95], v11, s[24:27], s50 offen offset:3072 nt
    s_add_u32 s50, s47, 90112
    buffer_load_dwordx4 a[96:99], v16, s[28:31], s50 offen offset:0 nt
    buffer_load_dwordx4 a[100:103], v16, s[28:31], s50 offen offset:1024 nt
    buffer_load_dwordx4 a[104:107], v16, s[28:31], s50 offen offset:2048 nt
    buffer_load_dwordx4 a[108:111], v16, s[28:31], s50 offen offset:3072 nt
    s_add_u32 s50, s47, 94208
    buffer_load_dwordx4 a[112:115], v16, s[28:31], s50 offen offset:0 nt
    buffer_load_dwordx4 a[116:119], v16, s[28:31], s50 offen offset:1024 nt
    buffer_load_dwordx4 a[120:123], v16, s[28:31], s50 offen offset:2048 nt
    buffer_load_dwordx4 a[124:127], v16, s[28:31], s50 offen offset:3072 nt
    s_cmp_ge_u32 s59, 6
    s_cbranch_scc1 K1_P63_OK
K1_P63:
    ds_read_b96 v[28:30], v18 offset:16
    s_waitcnt lgkmcnt(0)
    v_min3_u32 v28, v28, v29, v30
    s_nop 0
    v_readfirstlane_b32 s59, v28
    s_cmp_ge_u32 s59, 6
    s_cbranch_scc0 K1_P63
K1_P63_OK:
    ds_write_b128 v24, a[128:131] offset:49152
    ds_write_b128 v24, a[132:135] offset:50176
    ds_write_b128 v24, a[136:139] offset:51200
    ds_write_b128 v24, a[140:143] offset:52224
    ds_write_b128 v24, a[144:147] offset:53248
    ds_write_b128 v24, a[148:151] offset:54272
    ds_write_b128 v24, a[152:155] offset:55296
    ds_write_b128 v24, a[156:159] offset:56320
    ds_write_b128 v25, a[160:163] offset:49152
    ds_write_b128 v25, a[164:167] offset:50176
    ds_write_b128 v25, a[168:171] offset:51200
    ds_write_b128 v25, a[172:175] offset:52224
    ds_write_b128 v25, a[176:179] offset:53248
    ds_write_b128 v25, a[180:183] offset:54272
    ds_write_b128 v25, a[184:187] offset:55296
    ds_write_b128 v25, a[188:191] offset:56320
    s_waitcnt lgkmcnt(0)
    v_mov_b32 v26, 7
    ds_write_b32 v18, v26 offset:0
    s_add_u32 s50, s47, 106496
    buffer_load_dwordx4 a[128:131], v8, s[24:27], s50 offen offset:0 nt
    buffer_load_dwordx4 a[132:135], v9, s[24:27], s50 offen offset:1024 nt
    buffer_load_dwordx4 a[136:139], v10, s[24:27], s50 offen offset:2048 nt
    buffer_load_dwordx4 a[140:143], v11, s[24:27], s50 offen offset:3072 nt
    s_add_u32 s50, s47, 110592
    buffer_load_dwordx4 a[144:147], v8, s[24:27], s50 offen offset:0 nt
    buffer_load_dwordx4 a[148:151], v9, s[24:27], s50 offen offset:1024 nt
    buffer_load_dwordx4 a[152:155], v10, s[24:27], s50 offen offset:2048 nt
    buffer_load_dwordx4 a[156:159], v11, s[24:27], s50 offen offset:3072 nt
    s_add_u32 s50, s47, 98304
    buffer_load_dwordx4 a[160:163], v16, s[28:31], s50 offen offset:0 nt
    buffer_load_dwordx4 a[164:167], v16, s[28:31], s50 offen offset:1024 nt
    buffer_load_dwordx4 a[168:171], v16, s[28:31], s50 offen offset:2048 nt
    buffer_load_dwordx4 a[172:175], v16, s[28:31], s50 offen offset:3072 nt
    s_add_u32 s50, s47, 102400
    buffer_load_dwordx4 a[176:179], v16, s[28:31], s50 offen offset:0 nt
    buffer_load_dwordx4 a[180:183], v16, s[28:31], s50 offen offset:1024 nt
    buffer_load_dwordx4 a[184:187], v16, s[28:31], s50 offen offset:2048 nt
    buffer_load_dwordx4 a[188:191], v16, s[28:31], s50 offen offset:3072 nt
    s_cmp_ge_u32 s59, 6
    s_cbranch_scc1 K1_P64_OK
K1_P64:
    ds_read_b96 v[28:30], v18 offset:16
    s_waitcnt lgkmcnt(0)
    v_min3_u32 v28, v28, v29, v30
    s_nop 0
    v_readfirstlane_b32 s59, v28
    s_cmp_ge_u32 s59, 6
    s_cbranch_scc0 K1_P64
K1_P64_OK:
    ds_write_b128 v24, a[192:195] offset:57344
    ds_write_b128 v24, a[196:199] offset:58368
    ds_write_b128 v24, a[200:203] offset:59392
    ds_write_b128 v24, a[204:207] offset:60416
    ds_write_b128 v24, a[208:211] offset:61440
    ds_write_b128 v24, a[212:215] offset:62464
    ds_write_b128 v24, a[216:219] offset:63488
    ds_write_b128 v24, a[220:223] offset:64512
    ds_write_b128 v25, a[224:227] offset:57344
    ds_write_b128 v25, a[228:231] offset:58368
    ds_write_b128 v25, a[232:235] offset:59392
    ds_write_b128 v25, a[236:239] offset:60416
    ds_write_b128 v25, a[240:243] offset:61440
    ds_write_b128 v25, a[244:247] offset:62464
    ds_write_b128 v25, a[248:251] offset:63488
    ds_write_b128 v25, a[252:255] offset:64512
    s_waitcnt lgkmcnt(0)
    v_mov_b32 v26, 8
    ds_write_b32 v18, v26 offset:0
    s_add_u32 s50, s47, 114688
    buffer_load_dwordx4 a[192:195], v8, s[24:27], s50 offen offset:0 nt
    buffer_load_dwordx4 a[196:199], v9, s[24:27], s50 offen offset:1024 nt
    buffer_load_dwordx4 a[200:203], v10, s[24:27], s50 offen offset:2048 nt
    buffer_load_dwordx4 a[204:207], v11, s[24:27], s50 offen offset:3072 nt
    s_add_u32 s50, s47, 118784
    buffer_load_dwordx4 a[208:211], v8, s[24:27], s50 offen offset:0 nt
    buffer_load_dwordx4 a[212:215], v9, s[24:27], s50 offen offset:1024 nt
    buffer_load_dwordx4 a[216:219], v10, s[24:27], s50 offen offset:2048 nt
    buffer_load_dwordx4 a[220:223], v11, s[24:27], s50 offen offset:3072 nt
    s_add_u32 s50, s47, 106496
    buffer_load_dwordx4 a[224:227], v16, s[28:31], s50 offen offset:0 nt
    buffer_load_dwordx4 a[228:231], v16, s[28:31], s50 offen offset:1024 nt
    buffer_load_dwordx4 a[232:235], v16, s[28:31], s50 offen offset:2048 nt
    buffer_load_dwordx4 a[236:239], v16, s[28:31], s50 offen offset:3072 nt
    s_add_u32 s50, s47, 110592
    buffer_load_dwordx4 a[240:243], v16, s[28:31], s50 offen offset:0 nt
    buffer_load_dwordx4 a[244:247], v16, s[28:31], s50 offen offset:1024 nt
    buffer_load_dwordx4 a[248:251], v16, s[28:31], s50 offen offset:2048 nt
    buffer_load_dwordx4 a[252:255], v16, s[28:31], s50 offen offset:3072 nt
    s_cmp_ge_u32 s59, 9
    s_cbranch_scc1 K1_P65_OK
K1_P65:
    ds_read_b96 v[28:30], v18 offset:16
    s_waitcnt lgkmcnt(0)
    v_min3_u32 v28, v28, v29, v30
    s_nop 0
    v_readfirstlane_b32 s59, v28
    s_cmp_ge_u32 s59, 9
    s_cbranch_scc0 K1_P65
K1_P65_OK:
    s_waitcnt vmcnt(63)
    ds_write_b128 v24, v[32:35] offset:0
    ds_write_b128 v24, v[36:39] offset:1024
    ds_write_b128 v24, v[40:43] offset:2048
    ds_write_b128 v24, v[44:47] offset:3072
    ds_write_b128 v24, v[48:51] offset:4096
    ds_write_b128 v24, v[52:55] offset:5120
    ds_write_b128 v24, v[56:59] offset:6144
    ds_write_b128 v24, v[60:63] offset:7168
    ds_write_b128 v25, v[64:67] offset:0
    ds_write_b128 v25, v[68:71] offset:1024
    ds_write_b128 v25, v[72:75] offset:2048
    ds_write_b128 v25, v[76:79] offset:3072
    ds_write_b128 v25, v[80:83] offset:4096
    ds_write_b128 v25, v[84:87] offset:5120
    ds_write_b128 v25, v[88:91] offset:6144
    ds_write_b128 v25, v[92:95] offset:7168
    s_waitcnt lgkmcnt(0)
    v_mov_b32 v26, 9
    ds_write_b32 v18, v26 offset:0
    s_cmp_ge_u32 s59, 10
    s_cbranch_scc1 K1_P66_OK
K1_P66:
    ds_read_b96 v[28:30], v18 offset:16
    s_waitcnt lgkmcnt(0)
    v_min3_u32 v28, v28, v29, v30
    s_nop 0
    v_readfirstlane_b32 s59, v28
    s_cmp_ge_u32 s59, 10
    s_cbranch_scc0 K1_P66
K1_P66_OK:
    ds_write_b128 v24, v[96:99] offset:8192
    ds_write_b128 v24, v[100:103] offset:9216
    ds_write_b128 v24, v[104:107] offset:10240
    ds_write_b128 v24, v[108:111] offset:11264
    ds_write_b128 v24, v[112:115] offset:12288
    ds_write_b128 v24, v[116:119] offset:13312
    ds_write_b128 v24, v[120:123] offset:14336
    ds_write_b128 v24, v[124:127] offset:15360
    ds_write_b128 v25, v[128:131] offset:8192
    ds_write_b128 v25, v[132:135] offset:9216
    ds_write_b128 v25, v[136:139] offset:10240
    ds_write_b128 v25, v[140:143] offset:11264
    ds_write_b128 v25, v[144:147] offset:12288
    ds_write_b128 v25, v[148:151] offset:13312
    ds_write_b128 v25, v[152:155] offset:14336
    ds_write_b128 v25, v[156:159] offset:15360
    s_waitcnt lgkmcnt(0)
    v_mov_b32 v26, 10
    ds_write_b32 v18, v26 offset:0
    s_cmp_ge_u32 s59, 11
    s_cbranch_scc1 K1_P67_OK
K1_P67:
    ds_read_b96 v[28:30], v18 offset:16
    s_waitcnt lgkmcnt(0)
    v_min3_u32 v28, v28, v29, v30
    s_nop 0
    v_readfirstlane_b32 s59, v28
    s_cmp_ge_u32 s59, 11
    s_cbranch_scc0 K1_P67
K1_P67_OK:
    ds_write_b128 v24, v[160:163] offset:16384
    ds_write_b128 v24, v[164:167] offset:17408
    ds_write_b128 v24, v[168:171] offset:18432
    ds_write_b128 v24, v[172:175] offset:19456
    ds_write_b128 v24, v[176:179] offset:20480
    ds_write_b128 v24, v[180:183] offset:21504
    ds_write_b128 v24, v[184:187] offset:22528
    ds_write_b128 v24, v[188:191] offset:23552
    ds_write_b128 v25, v[192:195] offset:16384
    ds_write_b128 v25, v[196:199] offset:17408
    ds_write_b128 v25, v[200:203] offset:18432
    ds_write_b128 v25, v[204:207] offset:19456
    ds_write_b128 v25, v[208:211] offset:20480
    ds_write_b128 v25, v[212:215] offset:21504
    ds_write_b128 v25, v[216:219] offset:22528
    ds_write_b128 v25, v[220:223] offset:23552
    s_waitcnt lgkmcnt(0)
    v_mov_b32 v26, 11
    ds_write_b32 v18, v26 offset:0
    s_cmp_ge_u32 s59, 12
    s_cbranch_scc1 K1_P68_OK
K1_P68:
    ds_read_b96 v[28:30], v18 offset:16
    s_waitcnt lgkmcnt(0)
    v_min3_u32 v28, v28, v29, v30
    s_nop 0
    v_readfirstlane_b32 s59, v28
    s_cmp_ge_u32 s59, 12
    s_cbranch_scc0 K1_P68
K1_P68_OK:
    s_waitcnt vmcnt(48)
    ds_write_b128 v24, a[0:3] offset:24576
    ds_write_b128 v24, a[4:7] offset:25600
    ds_write_b128 v24, a[8:11] offset:26624
    ds_write_b128 v24, a[12:15] offset:27648
    ds_write_b128 v24, a[16:19] offset:28672
    ds_write_b128 v24, a[20:23] offset:29696
    ds_write_b128 v24, a[24:27] offset:30720
    ds_write_b128 v24, a[28:31] offset:31744
    ds_write_b128 v25, a[32:35] offset:24576
    ds_write_b128 v25, a[36:39] offset:25600
    ds_write_b128 v25, a[40:43] offset:26624
    ds_write_b128 v25, a[44:47] offset:27648
    ds_write_b128 v25, a[48:51] offset:28672
    ds_write_b128 v25, a[52:55] offset:29696
    ds_write_b128 v25, a[56:59] offset:30720
    ds_write_b128 v25, a[60:63] offset:31744
    s_waitcnt lgkmcnt(0)
    v_mov_b32 v26, 12
    ds_write_b32 v18, v26 offset:0
    s_cmp_ge_u32 s59, 13
    s_cbranch_scc1 K1_P69_OK
K1_P69:
    ds_read_b96 v[28:30], v18 offset:16
    s_waitcnt lgkmcnt(0)
    v_min3_u32 v28, v28, v29, v30
    s_nop 0
    v_readfirstlane_b32 s59, v28
    s_cmp_ge_u32 s59, 13
    s_cbranch_scc0 K1_P69
K1_P69_OK:
    s_waitcnt vmcnt(32)
    ds_write_b128 v24, a[64:67] offset:32768
    ds_write_b128 v24, a[68:71] offset:33792
    ds_write_b128 v24, a[72:75] offset:34816
    ds_write_b128 v24, a[76:79] offset:35840
    ds_write_b128 v24, a[80:83] offset:36864
    ds_write_b128 v24, a[84:87] offset:37888
    ds_write_b128 v24, a[88:91] offset:38912
    ds_write_b128 v24, a[92:95] offset:39936
    ds_write_b128 v25, a[96:99] offset:32768
    ds_write_b128 v25, a[100:103] offset:33792
    ds_write_b128 v25, a[104:107] offset:34816
    ds_write_b128 v25, a[108:111] offset:35840
    ds_write_b128 v25, a[112:115] offset:36864
    ds_write_b128 v25, a[116:119] offset:37888
    ds_write_b128 v25, a[120:123] offset:38912
    ds_write_b128 v25, a[124:127] offset:39936
    s_waitcnt lgkmcnt(0)
    v_mov_b32 v26, 13
    ds_write_b32 v18, v26 offset:0
    s_cmp_ge_u32 s59, 16
    s_cbranch_scc1 K1_P70_OK
K1_P70:
    ds_read_b96 v[28:30], v18 offset:16
    s_waitcnt lgkmcnt(0)
    v_min3_u32 v28, v28, v29, v30
    s_nop 0
    v_readfirstlane_b32 s59, v28
    s_cmp_ge_u32 s59, 16
    s_cbranch_scc0 K1_P70
K1_P70_OK:
    s_mov_b32 m0, 57344
    s_add_u32 s50, s47, 122880
    buffer_load_dwordx4 v8, s[24:27], s50 offen offset:0 nt lds
    buffer_load_dwordx4 v9, s[24:27], s50 offen offset:1024 nt lds
    buffer_load_dwordx4 v10, s[24:27], s50 offen offset:2048 nt lds
    buffer_load_dwordx4 v11, s[24:27], s50 offen offset:3072 nt lds
    s_mov_b32 m0, 61440
    s_add_u32 s50, s47, 126976
    buffer_load_dwordx4 v8, s[24:27], s50 offen offset:0 nt lds
    buffer_load_dwordx4 v9, s[24:27], s50 offen offset:1024 nt lds
    buffer_load_dwordx4 v10, s[24:27], s50 offen offset:2048 nt lds
    buffer_load_dwordx4 v11, s[24:27], s50 offen offset:3072 nt lds
    s_mov_b32 m0, 122880
    s_add_u32 s50, s47, 114688
    buffer_load_dwordx4 v16, s[28:31], s50 offen offset:0 nt lds
    buffer_load_dwordx4 v16, s[28:31], s50 offen offset:1024 nt lds
    buffer_load_dwordx4 v16, s[28:31], s50 offen offset:2048 nt lds
    buffer_load_dwordx4 v16, s[28:31], s50 offen offset:3072 nt lds
    s_mov_b32 m0, 126976
    s_add_u32 s50, s47, 118784
    buffer_load_dwordx4 v16, s[28:31], s50 offen offset:0 nt lds
    buffer_load_dwordx4 v16, s[28:31], s50 offen offset:1024 nt lds
    buffer_load_dwordx4 v16, s[28:31], s50 offen offset:2048 nt lds
    buffer_load_dwordx4 v16, s[28:31], s50 offen offset:3072 nt lds
    s_cmp_ge_u32 s59, 14
    s_cbranch_scc1 K1_P71_OK
K1_P71:
    ds_read_b96 v[28:30], v18 offset:16
    s_waitcnt lgkmcnt(0)
    v_min3_u32 v28, v28, v29, v30
    s_nop 0
    v_readfirstlane_b32 s59, v28
    s_cmp_ge_u32 s59, 14
    s_cbranch_scc0 K1_P71
K1_P71_OK:
    s_waitcnt vmcnt(32)
    ds_write_b128 v24, a[128:131] offset:40960
    ds_write_b128 v24, a[132:135] offset:41984
    ds_write_b128 v24, a[136:139] offset:43008
    ds_write_b128 v24, a[140:143] offset:44032
    ds_write_b128 v24, a[144:147] offset:45056
    ds_write_b128 v24, a[148:151] offset:46080
    ds_write_b128 v24, a[152:155] offset:47104
    ds_write_b128 v24, a[156:159] offset:48128
    ds_write_b128 v25, a[160:163] offset:40960
    ds_write_b128 v25, a[164:167] offset:41984
    ds_write_b128 v25, a[168:171] offset:43008
    ds_write_b128 v25, a[172:175] offset:44032
    ds_write_b128 v25, a[176:179] offset:45056
    ds_write_b128 v25, a[180:183] offset:46080
    ds_write_b128 v25, a[184:187] offset:47104
    ds_write_b128 v25, a[188:191] offset:48128
    s_waitcnt lgkmcnt(0)
    v_mov_b32 v26, 14
    ds_write_b32 v18, v26 offset:0
    s_cmp_ge_u32 s59, 17
    s_cbranch_scc1 K1_P72_OK
K1_P72:
    ds_read_b96 v[28:30], v18 offset:16
    s_waitcnt lgkmcnt(0)
    v_min3_u32 v28, v28, v29, v30
    s_nop 0
    v_readfirstlane_b32 s59, v28
    s_cmp_ge_u32 s59, 17
    s_cbranch_scc0 K1_P72
K1_P72_OK:
    s_mov_b32 m0, 0
    s_add_u32 s50, s47, 131072
    buffer_load_dwordx4 v8, s[24:27], s50 offen offset:0 nt lds
    buffer_load_dwordx4 v9, s[24:27], s50 offen offset:1024 nt lds
    buffer_load_dwordx4 v10, s[24:27], s50 offen offset:2048 nt lds
    buffer_load_dwordx4 v11, s[24:27], s50 offen offset:3072 nt lds
    s_mov_b32 m0, 4096
    s_add_u32 s50, s47, 135168
    buffer_load_dwordx4 v8, s[24:27], s50 offen offset:0 nt lds
    buffer_load_dwordx4 v9, s[24:27], s50 offen offset:1024 nt lds
    buffer_load_dwordx4 v10, s[24:27], s50 offen offset:2048 nt lds
    buffer_load_dwordx4 v11, s[24:27], s50 offen offset:3072 nt lds
    s_mov_b32 m0, 65536
    s_add_u32 s50, s47, 122880
    buffer_load_dwordx4 v16, s[28:31], s50 offen offset:0 nt lds
    buffer_load_dwordx4 v16, s[28:31], s50 offen offset:1024 nt lds
    buffer_load_dwordx4 v16, s[28:31], s50 offen offset:2048 nt lds
    buffer_load_dwordx4 v16, s[28:31], s50 offen offset:3072 nt lds
    s_mov_b32 m0, 69632
    s_add_u32 s50, s47, 126976
    buffer_load_dwordx4 v16, s[28:31], s50 offen offset:0 nt lds
    buffer_load_dwordx4 v16, s[28:31], s50 offen offset:1024 nt lds
    buffer_load_dwordx4 v16, s[28:31], s50 offen offset:2048 nt lds
    buffer_load_dwordx4 v16, s[28:31], s50 offen offset:3072 nt lds
    s_cmp_ge_u32 s59, 15
    s_cbranch_scc1 K1_P73_OK
K1_P73:
    ds_read_b96 v[28:30], v18 offset:16
    s_waitcnt lgkmcnt(0)
    v_min3_u32 v28, v28, v29, v30
    s_nop 0
    v_readfirstlane_b32 s59, v28
    s_cmp_ge_u32 s59, 15
    s_cbranch_scc0 K1_P73
K1_P73_OK:
    s_waitcnt vmcnt(32)
    ds_write_b128 v24, a[192:195] offset:49152
    ds_write_b128 v24, a[196:199] offset:50176
    ds_write_b128 v24, a[200:203] offset:51200
    ds_write_b128 v24, a[204:207] offset:52224
    ds_write_b128 v24, a[208:211] offset:53248
    ds_write_b128 v24, a[212:215] offset:54272
    ds_write_b128 v24, a[216:219] offset:55296
    ds_write_b128 v24, a[220:223] offset:56320
    ds_write_b128 v25, a[224:227] offset:49152
    ds_write_b128 v25, a[228:231] offset:50176
    ds_write_b128 v25, a[232:235] offset:51200
    ds_write_b128 v25, a[236:239] offset:52224
    ds_write_b128 v25, a[240:243] offset:53248
    ds_write_b128 v25, a[244:247] offset:54272
    ds_write_b128 v25, a[248:251] offset:55296
    ds_write_b128 v25, a[252:255] offset:56320
    s_waitcnt lgkmcnt(0)
    v_mov_b32 v26, 15
    ds_write_b32 v18, v26 offset:0
    s_cmp_ge_u32 s59, 18
    s_cbranch_scc1 K1_P74_OK
K1_P74:
    ds_read_b96 v[28:30], v18 offset:16
    s_waitcnt lgkmcnt(0)
    v_min3_u32 v28, v28, v29, v30
    s_nop 0
    v_readfirstlane_b32 s59, v28
    s_cmp_ge_u32 s59, 18
    s_cbranch_scc0 K1_P74
K1_P74_OK:
    s_mov_b32 m0, 8192
    s_add_u32 s50, s47, 139264
    buffer_load_dwordx4 v8, s[24:27], s50 offen offset:0 nt lds
    buffer_load_dwordx4 v9, s[24:27], s50 offen offset:1024 nt lds
    buffer_load_dwordx4 v10, s[24:27], s50 offen offset:2048 nt lds
    buffer_load_dwordx4 v11, s[24:27], s50 offen offset:3072 nt lds
    s_mov_b32 m0, 12288
    s_add_u32 s50, s47, 143360
    buffer_load_dwordx4 v8, s[24:27], s50 offen offset:0 nt lds
    buffer_load_dwordx4 v9, s[24:27], s50 offen offset:1024 nt lds
    buffer_load_dwordx4 v10, s[24:27], s50 offen offset:2048 nt lds
    buffer_load_dwordx4 v11, s[24:27], s50 offen offset:3072 nt lds
    s_mov_b32 m0, 73728
    s_add_u32 s50, s47, 131072
    buffer_load_dwordx4 v16, s[28:31], s50 offen offset:0 nt lds
    buffer_load_dwordx4 v16, s[28:31], s50 offen offset:1024 nt lds
    buffer_load_dwordx4 v16, s[28:31], s50 offen offset:2048 nt lds
    buffer_load_dwordx4 v16, s[28:31], s50 offen offset:3072 nt lds
    s_mov_b32 m0, 77824
    s_add_u32 s50, s47, 135168
    buffer_load_dwordx4 v16, s[28:31], s50 offen offset:0 nt lds
    buffer_load_dwordx4 v16, s[28:31], s50 offen offset:1024 nt lds
    buffer_load_dwordx4 v16, s[28:31], s50 offen offset:2048 nt lds
    buffer_load_dwordx4 v16, s[28:31], s50 offen offset:3072 nt lds
K1_LJ:
    s_waitcnt vmcnt(32)
    v_mov_b32 v26, 16
    ds_write_b32 v18, v26 offset:0
    s_cmp_ge_u32 s59, 19
    s_cbranch_scc1 K1_P75_OK
K1_P75:
    ds_read_b96 v[28:30], v18 offset:16
    s_waitcnt lgkmcnt(0)
    v_min3_u32 v28, v28, v29, v30
    s_nop 0
    v_readfirstlane_b32 s59, v28
    s_cmp_ge_u32 s59, 19
    s_cbranch_scc0 K1_P75
K1_P75_OK:
    s_mov_b32 m0, 16384
    s_add_u32 s50, s47, 147456
    buffer_load_dwordx4 v8, s[24:27], s50 offen offset:0 nt lds
    buffer_load_dwordx4 v9, s[24:27], s50 offen offset:1024 nt lds
    buffer_load_dwordx4 v10, s[24:27], s50 offen offset:2048 nt lds
    buffer_load_dwordx4 v11, s[24:27], s50 offen offset:3072 nt lds
    s_mov_b32 m0, 20480
    s_add_u32 s50, s47, 151552
    buffer_load_dwordx4 v8, s[24:27], s50 offen offset:0 nt lds
    buffer_load_dwordx4 v9, s[24:27], s50 offen offset:1024 nt lds
    buffer_load_dwordx4 v10, s[24:27], s50 offen offset:2048 nt lds
    buffer_load_dwordx4 v11, s[24:27], s50 offen offset:3072 nt lds
    s_mov_b32 m0, 81920
    s_add_u32 s50, s47, 139264
    buffer_load_dwordx4 v16, s[28:31], s50 offen offset:0 nt lds
    buffer_load_dwordx4 v16, s[28:31], s50 offen offset:1024 nt lds
    buffer_load_dwordx4 v16, s[28:31], s50 offen offset:2048 nt lds
    buffer_load_dwordx4 v16, s[28:31], s50 offen offset:3072 nt lds
    s_mov_b32 m0, 86016
    s_add_u32 s50, s47, 143360
    buffer_load_dwordx4 v16, s[28:31], s50 offen offset:0 nt lds
    buffer_load_dwordx4 v16, s[28:31], s50 offen offset:1024 nt lds
    buffer_load_dwordx4 v16, s[28:31], s50 offen offset:2048 nt lds
    buffer_load_dwordx4 v16, s[28:31], s50 offen offset:3072 nt lds
    s_waitcnt vmcnt(32)
    v_mov_b32 v26, 17
    ds_write_b32 v18, v26 offset:0
    s_cmp_ge_u32 s59, 20
    s_cbranch_scc1 K1_P76_OK
K1_P76:
    ds_read_b96 v[28:30], v18 offset:16
    s_waitcnt lgkmcnt(0)
    v_min3_u32 v28, v28, v29, v30
    s_nop 0
    v_readfirstlane_b32 s59, v28
    s_cmp_ge_u32 s59, 20
    s_cbranch_scc0 K1_P76
K1_P76_OK:
    s_mov_b32 m0, 24576
    s_add_u32 s50, s47, 155648
    buffer_load_dwordx4 v8, s[24:27], s50 offen offset:0 nt lds
    buffer_load_dwordx4 v9, s[24:27], s50 offen offset:1024 nt lds
    buffer_load_dwordx4 v10, s[24:27], s50 offen offset:2048 nt lds
    buffer_load_dwordx4 v11, s[24:27], s50 offen offset:3072 nt lds
    s_mov_b32 m0, 28672
    s_add_u32 s50, s47, 159744
    buffer_load_dwordx4 v8, s[24:27], s50 offen offset:0 nt lds
    buffer_load_dwordx4 v9, s[24:27], s50 offen offset:1024 nt lds
    buffer_load_dwordx4 v10, s[24:27], s50 offen offset:2048 nt lds
    buffer_load_dwordx4 v11, s[24:27], s50 offen offset:3072 nt lds
    s_mov_b32 m0, 90112
    s_add_u32 s50, s47, 147456
    buffer_load_dwordx4 v16, s[28:31], s50 offen offset:0 nt lds
    buffer_load_dwordx4 v16, s[28:31], s50 offen offset:1024 nt lds
    buffer_load_dwordx4 v16, s[28:31], s50 offen offset:2048 nt lds
    buffer_load_dwordx4 v16, s[28:31], s50 offen offset:3072 nt lds
    s_mov_b32 m0, 94208
    s_add_u32 s50, s47, 151552
    buffer_load_dwordx4 v16, s[28:31], s50 offen offset:0 nt lds
    buffer_load_dwordx4 v16, s[28:31], s50 offen offset:1024 nt lds
    buffer_load_dwordx4 v16, s[28:31], s50 offen offset:2048 nt lds
    buffer_load_dwordx4 v16, s[28:31], s50 offen offset:3072 nt lds
    s_waitcnt vmcnt(32)
    v_mov_b32 v26, 18
    ds_write_b32 v18, v26 offset:0
    s_cmp_ge_u32 s59, 21
    s_cbranch_scc1 K1_P77_OK
K1_P77:
    ds_read_b96 v[28:30], v18 offset:16
    s_waitcnt lgkmcnt(0)
    v_min3_u32 v28, v28, v29, v30
    s_nop 0
    v_readfirstlane_b32 s59, v28
    s_cmp_ge_u32 s59, 21
    s_cbranch_scc0 K1_P77
K1_P77_OK:
    s_mov_b32 m0, 32768
    s_add_u32 s50, s47, 163840
    buffer_load_dwordx4 v8, s[24:27], s50 offen offset:0 nt lds
    buffer_load_dwordx4 v9, s[24:27], s50 offen offset:1024 nt lds
    buffer_load_dwordx4 v10, s[24:27], s50 offen offset:2048 nt lds
    buffer_load_dwordx4 v11, s[24:27], s50 offen offset:3072 nt lds
    s_mov_b32 m0, 36864
    s_add_u32 s50, s47, 167936
    buffer_load_dwordx4 v8, s[24:27], s50 offen offset:0 nt lds
    buffer_load_dwordx4 v9, s[24:27], s50 offen offset:1024 nt lds
    buffer_load_dwordx4 v10, s[24:27], s50 offen offset:2048 nt lds
    buffer_load_dwordx4 v11, s[24:27], s50 offen offset:3072 nt lds
    s_mov_b32 m0, 98304
    s_add_u32 s50, s47, 155648
    buffer_load_dwordx4 v16, s[28:31], s50 offen offset:0 nt lds
    buffer_load_dwordx4 v16, s[28:31], s50 offen offset:1024 nt lds
    buffer_load_dwordx4 v16, s[28:31], s50 offen offset:2048 nt lds
    buffer_load_dwordx4 v16, s[28:31], s50 offen offset:3072 nt lds
    s_mov_b32 m0, 102400
    s_add_u32 s50, s47, 159744
    buffer_load_dwordx4 v16, s[28:31], s50 offen offset:0 nt lds
    buffer_load_dwordx4 v16, s[28:31], s50 offen offset:1024 nt lds
    buffer_load_dwordx4 v16, s[28:31], s50 offen offset:2048 nt lds
    buffer_load_dwordx4 v16, s[28:31], s50 offen offset:3072 nt lds
    s_waitcnt vmcnt(32)
    v_mov_b32 v26, 19
    ds_write_b32 v18, v26 offset:0
    s_cmp_ge_u32 s59, 22
    s_cbranch_scc1 K1_P78_OK
K1_P78:
    ds_read_b96 v[28:30], v18 offset:16
    s_waitcnt lgkmcnt(0)
    v_min3_u32 v28, v28, v29, v30
    s_nop 0
    v_readfirstlane_b32 s59, v28
    s_cmp_ge_u32 s59, 22
    s_cbranch_scc0 K1_P78
K1_P78_OK:
    s_mov_b32 m0, 40960
    s_add_u32 s50, s47, 172032
    buffer_load_dwordx4 v8, s[24:27], s50 offen offset:0 nt lds
    buffer_load_dwordx4 v9, s[24:27], s50 offen offset:1024 nt lds
    buffer_load_dwordx4 v10, s[24:27], s50 offen offset:2048 nt lds
    buffer_load_dwordx4 v11, s[24:27], s50 offen offset:3072 nt lds
    s_mov_b32 m0, 45056
    s_add_u32 s50, s47, 176128
    buffer_load_dwordx4 v8, s[24:27], s50 offen offset:0 nt lds
    buffer_load_dwordx4 v9, s[24:27], s50 offen offset:1024 nt lds
    buffer_load_dwordx4 v10, s[24:27], s50 offen offset:2048 nt lds
    buffer_load_dwordx4 v11, s[24:27], s50 offen offset:3072 nt lds
    s_mov_b32 m0, 106496
    s_add_u32 s50, s47, 163840
    buffer_load_dwordx4 v16, s[28:31], s50 offen offset:0 nt lds
    buffer_load_dwordx4 v16, s[28:31], s50 offen offset:1024 nt lds
    buffer_load_dwordx4 v16, s[28:31], s50 offen offset:2048 nt lds
    buffer_load_dwordx4 v16, s[28:31], s50 offen offset:3072 nt lds
    s_mov_b32 m0, 110592
    s_add_u32 s50, s47, 167936
    buffer_load_dwordx4 v16, s[28:31], s50 offen offset:0 nt lds
    buffer_load_dwordx4 v16, s[28:31], s50 offen offset:1024 nt lds
    buffer_load_dwordx4 v16, s[28:31], s50 offen offset:2048 nt lds
    buffer_load_dwordx4 v16, s[28:31], s50 offen offset:3072 nt lds
    s_waitcnt vmcnt(32)
    v_mov_b32 v26, 20
    ds_write_b32 v18, v26 offset:0
    s_cmp_ge_u32 s59, 23
    s_cbranch_scc1 K1_P79_OK
K1_P79:
    ds_read_b96 v[28:30], v18 offset:16
    s_waitcnt lgkmcnt(0)
    v_min3_u32 v28, v28, v29, v30
    s_nop 0
    v_readfirstlane_b32 s59, v28
    s_cmp_ge_u32 s59, 23
    s_cbranch_scc0 K1_P79
K1_P79_OK:
    s_mov_b32 m0, 49152
    s_add_u32 s50, s47, 180224
    buffer_load_dwordx4 v8, s[24:27], s50 offen offset:0 nt lds
    buffer_load_dwordx4 v9, s[24:27], s50 offen offset:1024 nt lds
    buffer_load_dwordx4 v10, s[24:27], s50 offen offset:2048 nt lds
    buffer_load_dwordx4 v11, s[24:27], s50 offen offset:3072 nt lds
    s_mov_b32 m0, 53248
    s_add_u32 s50, s47, 184320
    buffer_load_dwordx4 v8, s[24:27], s50 offen offset:0 nt lds
    buffer_load_dwordx4 v9, s[24:27], s50 offen offset:1024 nt lds
    buffer_load_dwordx4 v10, s[24:27], s50 offen offset:2048 nt lds
    buffer_load_dwordx4 v11, s[24:27], s50 offen offset:3072 nt lds
    s_mov_b32 m0, 114688
    s_add_u32 s50, s47, 172032
    buffer_load_dwordx4 v16, s[28:31], s50 offen offset:0 nt lds
    buffer_load_dwordx4 v16, s[28:31], s50 offen offset:1024 nt lds
    buffer_load_dwordx4 v16, s[28:31], s50 offen offset:2048 nt lds
    buffer_load_dwordx4 v16, s[28:31], s50 offen offset:3072 nt lds
    s_mov_b32 m0, 118784
    s_add_u32 s50, s47, 176128
    buffer_load_dwordx4 v16, s[28:31], s50 offen offset:0 nt lds
    buffer_load_dwordx4 v16, s[28:31], s50 offen offset:1024 nt lds
    buffer_load_dwordx4 v16, s[28:31], s50 offen offset:2048 nt lds
    buffer_load_dwordx4 v16, s[28:31], s50 offen offset:3072 nt lds
    s_waitcnt vmcnt(32)
    v_mov_b32 v26, 21
    ds_write_b32 v18, v26 offset:0
    s_cmp_ge_u32 s59, 24
    s_cbranch_scc1 K1_P80_OK
K1_P80:
    ds_read_b96 v[28:30], v18 offset:16
    s_waitcnt lgkmcnt(0)
    v_min3_u32 v28, v28, v29, v30
    s_nop 0
    v_readfirstlane_b32 s59, v28
    s_cmp_ge_u32 s59, 24
    s_cbranch_scc0 K1_P80
K1_P80_OK:
    s_mov_b32 m0, 57344
    s_add_u32 s50, s47, 188416
    buffer_load_dwordx4 v8, s[24:27], s50 offen offset:0 nt lds
    buffer_load_dwordx4 v9, s[24:27], s50 offen offset:1024 nt lds
    buffer_load_dwordx4 v10, s[24:27], s50 offen offset:2048 nt lds
    buffer_load_dwordx4 v11, s[24:27], s50 offen offset:3072 nt lds
    s_mov_b32 m0, 61440
    s_add_u32 s50, s47, 192512
    buffer_load_dwordx4 v8, s[24:27], s50 offen offset:0 nt lds
    buffer_load_dwordx4 v9, s[24:27], s50 offen offset:1024 nt lds
    buffer_load_dwordx4 v10, s[24:27], s50 offen offset:2048 nt lds
    buffer_load_dwordx4 v11, s[24:27], s50 offen offset:3072 nt lds
    s_mov_b32 m0, 122880
    s_add_u32 s50, s47, 180224
    buffer_load_dwordx4 v16, s[28:31], s50 offen offset:0 nt lds
    buffer_load_dwordx4 v16, s[28:31], s50 offen offset:1024 nt lds
    buffer_load_dwordx4 v16, s[28:31], s50 offen offset:2048 nt lds
    buffer_load_dwordx4 v16, s[28:31], s50 offen offset:3072 nt lds
    s_mov_b32 m0, 126976
    s_add_u32 s50, s47, 184320
    buffer_load_dwordx4 v16, s[28:31], s50 offen offset:0 nt lds
    buffer_load_dwordx4 v16, s[28:31], s50 offen offset:1024 nt lds
    buffer_load_dwordx4 v16, s[28:31], s50 offen offset:2048 nt lds
    buffer_load_dwordx4 v16, s[28:31], s50 offen offset:3072 nt lds
    s_waitcnt vmcnt(32)
    v_mov_b32 v26, 22
    ds_write_b32 v18, v26 offset:0
    s_cmp_ge_u32 s59, 25
    s_cbranch_scc1 K1_P81_OK
K1_P81:
    ds_read_b96 v[28:30], v18 offset:16
    s_waitcnt lgkmcnt(0)
    v_min3_u32 v28, v28, v29, v30
    s_nop 0
    v_readfirstlane_b32 s59, v28
    s_cmp_ge_u32 s59, 25
    s_cbranch_scc0 K1_P81
K1_P81_OK:
    s_mov_b32 m0, 0
    s_add_u32 s50, s47, 196608
    buffer_load_dwordx4 v8, s[24:27], s50 offen offset:0 nt lds
    buffer_load_dwordx4 v9, s[24:27], s50 offen offset:1024 nt lds
    buffer_load_dwordx4 v10, s[24:27], s50 offen offset:2048 nt lds
    buffer_load_dwordx4 v11, s[24:27], s50 offen offset:3072 nt lds
    s_mov_b32 m0, 4096
    s_add_u32 s50, s47, 200704
    buffer_load_dwordx4 v8, s[24:27], s50 offen offset:0 nt lds
    buffer_load_dwordx4 v9, s[24:27], s50 offen offset:1024 nt lds
    buffer_load_dwordx4 v10, s[24:27], s50 offen offset:2048 nt lds
    buffer_load_dwordx4 v11, s[24:27], s50 offen offset:3072 nt lds
    s_mov_b32 m0, 65536
    s_add_u32 s50, s47, 188416
    buffer_load_dwordx4 v16, s[28:31], s50 offen offset:0 nt lds
    buffer_load_dwordx4 v16, s[28:31], s50 offen offset:1024 nt lds
    buffer_load_dwordx4 v16, s[28:31], s50 offen offset:2048 nt lds
    buffer_load_dwordx4 v16, s[28:31], s50 offen offset:3072 nt lds
    s_mov_b32 m0, 69632
    s_add_u32 s50, s47, 192512
    buffer_load_dwordx4 v16, s[28:31], s50 offen offset:0 nt lds
    buffer_load_dwordx4 v16, s[28:31], s50 offen offset:1024 nt lds
    buffer_load_dwordx4 v16, s[28:31], s50 offen offset:2048 nt lds
    buffer_load_dwordx4 v16, s[28:31], s50 offen offset:3072 nt lds
    s_waitcnt vmcnt(32)
    v_mov_b32 v26, 23
    ds_write_b32 v18, v26 offset:0
    s_cmp_ge_u32 s59, 26
    s_cbranch_scc1 K1_P82_OK
K1_P82:
    ds_read_b96 v[28:30], v18 offset:16
    s_waitcnt lgkmcnt(0)
    v_min3_u32 v28, v28, v29, v30
    s_nop 0
    v_readfirstlane_b32 s59, v28
    s_cmp_ge_u32 s59, 26
    s_cbranch_scc0 K1_P82
K1_P82_OK:
    s_mov_b32 m0, 8192
    s_add_u32 s50, s47, 204800
    buffer_load_dwordx4 v8, s[24:27], s50 offen offset:0 nt lds
    buffer_load_dwordx4 v9, s[24:27], s50 offen offset:1024 nt lds
    buffer_load_dwordx4 v10, s[24:27], s50 offen offset:2048 nt lds
    buffer_load_dwordx4 v11, s[24:27], s50 offen offset:3072 nt lds
    s_mov_b32 m0, 12288
    s_add_u32 s50, s47, 208896
    buffer_load_dwordx4 v8, s[24:27], s50 offen offset:0 nt lds
    buffer_load_dwordx4 v9, s[24:27], s50 offen offset:1024 nt lds
    buffer_load_dwordx4 v10, s[24:27], s50 offen offset:2048 nt lds
    buffer_load_dwordx4 v11, s[24:27], s50 offen offset:3072 nt lds
    s_mov_b32 m0, 73728
    s_add_u32 s50, s47, 196608
    buffer_load_dwordx4 v16, s[28:31], s50 offen offset:0 nt lds
    buffer_load_dwordx4 v16, s[28:31], s50 offen offset:1024 nt lds
    buffer_load_dwordx4 v16, s[28:31], s50 offen offset:2048 nt lds
    buffer_load_dwordx4 v16, s[28:31], s50 offen offset:3072 nt lds
    s_mov_b32 m0, 77824
    s_add_u32 s50, s47, 200704
    buffer_load_dwordx4 v16, s[28:31], s50 offen offset:0 nt lds
    buffer_load_dwordx4 v16, s[28:31], s50 offen offset:1024 nt lds
    buffer_load_dwordx4 v16, s[28:31], s50 offen offset:2048 nt lds
    buffer_load_dwordx4 v16, s[28:31], s50 offen offset:3072 nt lds
    s_waitcnt vmcnt(32)
    v_mov_b32 v26, 24
    ds_write_b32 v18, v26 offset:0
    s_cmp_ge_u32 s59, 27
    s_cbranch_scc1 K1_P83_OK
K1_P83:
    ds_read_b96 v[28:30], v18 offset:16
    s_waitcnt lgkmcnt(0)
    v_min3_u32 v28, v28, v29, v30
    s_nop 0
    v_readfirstlane_b32 s59, v28
    s_cmp_ge_u32 s59, 27
    s_cbranch_scc0 K1_P83
K1_P83_OK:
    s_mov_b32 m0, 16384
    s_add_u32 s50, s47, 212992
    buffer_load_dwordx4 v8, s[24:27], s50 offen offset:0 nt lds
    buffer_load_dwordx4 v9, s[24:27], s50 offen offset:1024 nt lds
    buffer_load_dwordx4 v10, s[24:27], s50 offen offset:2048 nt lds
    buffer_load_dwordx4 v11, s[24:27], s50 offen offset:3072 nt lds
    s_mov_b32 m0, 20480
    s_add_u32 s50, s47, 217088
    buffer_load_dwordx4 v8, s[24:27], s50 offen offset:0 nt lds
    buffer_load_dwordx4 v9, s[24:27], s50 offen offset:1024 nt lds
    buffer_load_dwordx4 v10, s[24:27], s50 offen offset:2048 nt lds
    buffer_load_dwordx4 v11, s[24:27], s50 offen offset:3072 nt lds
    s_mov_b32 m0, 81920
    s_add_u32 s50, s47, 204800
    buffer_load_dwordx4 v16, s[28:31], s50 offen offset:0 nt lds
    buffer_load_dwordx4 v16, s[28:31], s50 offen offset:1024 nt lds
    buffer_load_dwordx4 v16, s[28:31], s50 offen offset:2048 nt lds
    buffer_load_dwordx4 v16, s[28:31], s50 offen offset:3072 nt lds
    s_mov_b32 m0, 86016
    s_add_u32 s50, s47, 208896
    buffer_load_dwordx4 v16, s[28:31], s50 offen offset:0 nt lds
    buffer_load_dwordx4 v16, s[28:31], s50 offen offset:1024 nt lds
    buffer_load_dwordx4 v16, s[28:31], s50 offen offset:2048 nt lds
    buffer_load_dwordx4 v16, s[28:31], s50 offen offset:3072 nt lds
    s_waitcnt vmcnt(32)
    v_mov_b32 v26, 25
    ds_write_b32 v18, v26 offset:0
    s_cmp_ge_u32 s59, 28
    s_cbranch_scc1 K1_P84_OK
K1_P84:
    ds_read_b96 v[28:30], v18 offset:16
    s_waitcnt lgkmcnt(0)
    v_min3_u32 v28, v28, v29, v30
    s_nop 0
    v_readfirstlane_b32 s59, v28
    s_cmp_ge_u32 s59, 28
    s_cbranch_scc0 K1_P84
K1_P84_OK:
    s_mov_b32 m0, 24576
    s_add_u32 s50, s47, 221184
    buffer_load_dwordx4 v8, s[24:27], s50 offen offset:0 nt lds
    buffer_load_dwordx4 v9, s[24:27], s50 offen offset:1024 nt lds
    buffer_load_dwordx4 v10, s[24:27], s50 offen offset:2048 nt lds
    buffer_load_dwordx4 v11, s[24:27], s50 offen offset:3072 nt lds
    s_mov_b32 m0, 28672
    s_add_u32 s50, s47, 225280
    buffer_load_dwordx4 v8, s[24:27], s50 offen offset:0 nt lds
    buffer_load_dwordx4 v9, s[24:27], s50 offen offset:1024 nt lds
    buffer_load_dwordx4 v10, s[24:27], s50 offen offset:2048 nt lds
    buffer_load_dwordx4 v11, s[24:27], s50 offen offset:3072 nt lds
    s_mov_b32 m0, 90112
    s_add_u32 s50, s47, 212992
    buffer_load_dwordx4 v16, s[28:31], s50 offen offset:0 nt lds
    buffer_load_dwordx4 v16, s[28:31], s50 offen offset:1024 nt lds
    buffer_load_dwordx4 v16, s[28:31], s50 offen offset:2048 nt lds
    buffer_load_dwordx4 v16, s[28:31], s50 offen offset:3072 nt lds
    s_mov_b32 m0, 94208
    s_add_u32 s50, s47, 217088
    buffer_load_dwordx4 v16, s[28:31], s50 offen offset:0 nt lds
    buffer_load_dwordx4 v16, s[28:31], s50 offen offset:1024 nt lds
    buffer_load_dwordx4 v16, s[28:31], s50 offen offset:2048 nt lds
    buffer_load_dwordx4 v16, s[28:31], s50 offen offset:3072 nt lds
    s_waitcnt vmcnt(32)
    v_mov_b32 v26, 26
    ds_write_b32 v18, v26 offset:0
    s_cmp_ge_u32 s59, 29
    s_cbranch_scc1 K1_P85_OK
K1_P85:
    ds_read_b96 v[28:30], v18 offset:16
    s_waitcnt lgkmcnt(0)
    v_min3_u32 v28, v28, v29, v30
    s_nop 0
    v_readfirstlane_b32 s59, v28
    s_cmp_ge_u32 s59, 29
    s_cbranch_scc0 K1_P85
K1_P85_OK:
    s_mov_b32 m0, 32768
    s_add_u32 s50, s47, 229376
    buffer_load_dwordx4 v8, s[24:27], s50 offen offset:0 nt lds
    buffer_load_dwordx4 v9, s[24:27], s50 offen offset:1024 nt lds
    buffer_load_dwordx4 v10, s[24:27], s50 offen offset:2048 nt lds
    buffer_load_dwordx4 v11, s[24:27], s50 offen offset:3072 nt lds
    s_mov_b32 m0, 36864
    s_add_u32 s50, s47, 233472
    buffer_load_dwordx4 v8, s[24:27], s50 offen offset:0 nt lds
    buffer_load_dwordx4 v9, s[24:27], s50 offen offset:1024 nt lds
    buffer_load_dwordx4 v10, s[24:27], s50 offen offset:2048 nt lds
    buffer_load_dwordx4 v11, s[24:27], s50 offen offset:3072 nt lds
    s_mov_b32 m0, 98304
    s_add_u32 s50, s47, 221184
    buffer_load_dwordx4 v16, s[28:31], s50 offen offset:0 nt lds
    buffer_load_dwordx4 v16, s[28:31], s50 offen offset:1024 nt lds
    buffer_load_dwordx4 v16, s[28:31], s50 offen offset:2048 nt lds
    buffer_load_dwordx4 v16, s[28:31], s50 offen offset:3072 nt lds
    s_mov_b32 m0, 102400
    s_add_u32 s50, s47, 225280
    buffer_load_dwordx4 v16, s[28:31], s50 offen offset:0 nt lds
    buffer_load_dwordx4 v16, s[28:31], s50 offen offset:1024 nt lds
    buffer_load_dwordx4 v16, s[28:31], s50 offen offset:2048 nt lds
    buffer_load_dwordx4 v16, s[28:31], s50 offen offset:3072 nt lds
    s_waitcnt vmcnt(32)
    v_mov_b32 v26, 27
    ds_write_b32 v18, v26 offset:0
    s_cmp_ge_u32 s59, 30
    s_cbranch_scc1 K1_P86_OK
K1_P86:
    ds_read_b96 v[28:30], v18 offset:16
    s_waitcnt lgkmcnt(0)
    v_min3_u32 v28, v28, v29, v30
    s_nop 0
    v_readfirstlane_b32 s59, v28
    s_cmp_ge_u32 s59, 30
    s_cbranch_scc0 K1_P86
K1_P86_OK:
    s_mov_b32 m0, 40960
    s_add_u32 s50, s47, 237568
    buffer_load_dwordx4 v8, s[24:27], s50 offen offset:0 nt lds
    buffer_load_dwordx4 v9, s[24:27], s50 offen offset:1024 nt lds
    buffer_load_dwordx4 v10, s[24:27], s50 offen offset:2048 nt lds
    buffer_load_dwordx4 v11, s[24:27], s50 offen offset:3072 nt lds
    s_mov_b32 m0, 45056
    s_add_u32 s50, s47, 241664
    buffer_load_dwordx4 v8, s[24:27], s50 offen offset:0 nt lds
    buffer_load_dwordx4 v9, s[24:27], s50 offen offset:1024 nt lds
    buffer_load_dwordx4 v10, s[24:27], s50 offen offset:2048 nt lds
    buffer_load_dwordx4 v11, s[24:27], s50 offen offset:3072 nt lds
    s_mov_b32 m0, 106496
    s_add_u32 s50, s47, 229376
    buffer_load_dwordx4 v16, s[28:31], s50 offen offset:0 nt lds
    buffer_load_dwordx4 v16, s[28:31], s50 offen offset:1024 nt lds
    buffer_load_dwordx4 v16, s[28:31], s50 offen offset:2048 nt lds
    buffer_load_dwordx4 v16, s[28:31], s50 offen offset:3072 nt lds
    s_mov_b32 m0, 110592
    s_add_u32 s50, s47, 233472
    buffer_load_dwordx4 v16, s[28:31], s50 offen offset:0 nt lds
    buffer_load_dwordx4 v16, s[28:31], s50 offen offset:1024 nt lds
    buffer_load_dwordx4 v16, s[28:31], s50 offen offset:2048 nt lds
    buffer_load_dwordx4 v16, s[28:31], s50 offen offset:3072 nt lds
    s_waitcnt vmcnt(32)
    v_mov_b32 v26, 28
    ds_write_b32 v18, v26 offset:0
    s_cmp_ge_u32 s59, 31
    s_cbranch_scc1 K1_P87_OK
K1_P87:
    ds_read_b96 v[28:30], v18 offset:16
    s_waitcnt lgkmcnt(0)
    v_min3_u32 v28, v28, v29, v30
    s_nop 0
    v_readfirstlane_b32 s59, v28
    s_cmp_ge_u32 s59, 31
    s_cbranch_scc0 K1_P87
K1_P87_OK:
    s_mov_b32 m0, 49152
    s_add_u32 s50, s47, 245760
    buffer_load_dwordx4 v8, s[24:27], s50 offen offset:0 nt lds
    buffer_load_dwordx4 v9, s[24:27], s50 offen offset:1024 nt lds
    buffer_load_dwordx4 v10, s[24:27], s50 offen offset:2048 nt lds
    buffer_load_dwordx4 v11, s[24:27], s50 offen offset:3072 nt lds
    s_mov_b32 m0, 53248
    s_add_u32 s50, s47, 249856
    buffer_load_dwordx4 v8, s[24:27], s50 offen offset:0 nt lds
    buffer_load_dwordx4 v9, s[24:27], s50 offen offset:1024 nt lds
    buffer_load_dwordx4 v10, s[24:27], s50 offen offset:2048 nt lds
    buffer_load_dwordx4 v11, s[24:27], s50 offen offset:3072 nt lds
    s_mov_b32 m0, 114688
    s_add_u32 s50, s47, 237568
    buffer_load_dwordx4 v16, s[28:31], s50 offen offset:0 nt lds
    buffer_load_dwordx4 v16, s[28:31], s50 offen offset:1024 nt lds
    buffer_load_dwordx4 v16, s[28:31], s50 offen offset:2048 nt lds
    buffer_load_dwordx4 v16, s[28:31], s50 offen offset:3072 nt lds
    s_mov_b32 m0, 118784
    s_add_u32 s50, s47, 241664
    buffer_load_dwordx4 v16, s[28:31], s50 offen offset:0 nt lds
    buffer_load_dwordx4 v16, s[28:31], s50 offen offset:1024 nt lds
    buffer_load_dwordx4 v16, s[28:31], s50 offen offset:2048 nt lds
    buffer_load_dwordx4 v16, s[28:31], s50 offen offset:3072 nt lds
    s_waitcnt vmcnt(32)
    v_mov_b32 v26, 29
    ds_write_b32 v18, v26 offset:0
    s_cmp_ge_u32 s59, 32
    s_cbranch_scc1 K1_P88_OK
K1_P88:
    ds_read_b96 v[28:30], v18 offset:16
    s_waitcnt lgkmcnt(0)
    v_min3_u32 v28, v28, v29, v30
    s_nop 0
    v_readfirstlane_b32 s59, v28
    s_cmp_ge_u32 s59, 32
    s_cbranch_scc0 K1_P88
K1_P88_OK:
    s_mov_b32 m0, 57344
    s_add_u32 s50, s47, 253952
    buffer_load_dwordx4 v8, s[24:27], s50 offen offset:0 nt lds
    buffer_load_dwordx4 v9, s[24:27], s50 offen offset:1024 nt lds
    buffer_load_dwordx4 v10, s[24:27], s50 offen offset:2048 nt lds
    buffer_load_dwordx4 v11, s[24:27], s50 offen offset:3072 nt lds
    s_mov_b32 m0, 61440
    s_add_u32 s50, s47, 258048
    buffer_load_dwordx4 v8, s[24:27], s50 offen offset:0 nt lds
    buffer_load_dwordx4 v9, s[24:27], s50 offen offset:1024 nt lds
    buffer_load_dwordx4 v10, s[24:27], s50 offen offset:2048 nt lds
    buffer_load_dwordx4 v11, s[24:27], s50 offen offset:3072 nt lds
    s_mov_b32 m0, 122880
    s_add_u32 s50, s47, 245760
    buffer_load_dwordx4 v16, s[28:31], s50 offen offset:0 nt lds
    buffer_load_dwordx4 v16, s[28:31], s50 offen offset:1024 nt lds
    buffer_load_dwordx4 v16, s[28:31], s50 offen offset:2048 nt lds
    buffer_load_dwordx4 v16, s[28:31], s50 offen offset:3072 nt lds
    s_mov_b32 m0, 126976
    s_add_u32 s50, s47, 249856
    buffer_load_dwordx4 v16, s[28:31], s50 offen offset:0 nt lds
    buffer_load_dwordx4 v16, s[28:31], s50 offen offset:1024 nt lds
    buffer_load_dwordx4 v16, s[28:31], s50 offen offset:2048 nt lds
    buffer_load_dwordx4 v16, s[28:31], s50 offen offset:3072 nt lds
    s_waitcnt vmcnt(32)
    v_mov_b32 v26, 30
    ds_write_b32 v18, v26 offset:0
    s_cmp_ge_u32 s59, 33
    s_cbranch_scc1 K1_P89_OK
K1_P89:
    ds_read_b96 v[28:30], v18 offset:16
    s_waitcnt lgkmcnt(0)
    v_min3_u32 v28, v28, v29, v30
    s_nop 0
    v_readfirstlane_b32 s59, v28
    s_cmp_ge_u32 s59, 33
    s_cbranch_scc0 K1_P89
K1_P89_OK:
    s_mov_b32 m0, 65536
    s_add_u32 s50, s47, 253952
    buffer_load_dwordx4 v16, s[28:31], s50 offen offset:0 nt lds
    buffer_load_dwordx4 v16, s[28:31], s50 offen offset:1024 nt lds
    buffer_load_dwordx4 v16, s[28:31], s50 offen offset:2048 nt lds
    buffer_load_dwordx4 v16, s[28:31], s50 offen offset:3072 nt lds
    s_mov_b32 m0, 69632
    s_add_u32 s50, s47, 258048
    buffer_load_dwordx4 v16, s[28:31], s50 offen offset:0 nt lds
    buffer_load_dwordx4 v16, s[28:31], s50 offen offset:1024 nt lds
    buffer_load_dwordx4 v16, s[28:31], s50 offen offset:2048 nt lds
    buffer_load_dwordx4 v16, s[28:31], s50 offen offset:3072 nt lds
    s_mov_b32 s92, s16
    s_and_b32 s93, s17, 0xffff
    s_mov_b32 s94, 0x100
    s_mov_b32 s95, 0x20000
    v_lshlrev_b32 v21, 2, v0
    s_mov_b32 s86, 0
    s_mov_b32 s51, 0x01010101
    buffer_load_dword v22, v21, s[92:95], 0 offen sc1
    s_add_u32 s57, s81, 0
    s_and_b32 s57, s57, 3
    s_lshl_b32 s48, s80, 2
    s_add_u32 s57, s57, s48
    s_lshl_b32 s57, s57, 17
    s_lshl_b32 s48, s81, 8
    s_add_u32 s57, s57, s48
    s_mov_b32 m0, 131072
    s_nop 0
    buffer_load_dwordx4 v12, s[36:39], s57 offen lds
    s_add_u32 s57, s57, 4096
    s_mov_b32 m0, 132096
    s_nop 0
    buffer_load_dwordx4 v12, s[36:39], s57 offen lds
    s_add_u32 s57, s57, 4096
    s_mov_b32 m0, 133120
    s_nop 0
    buffer_load_dwordx4 v12, s[36:39], s57 offen lds
    s_add_u32 s57, s57, 4096
    s_mov_b32 m0, 134144
    s_nop 0
    buffer_load_dwordx4 v12, s[36:39], s57 offen lds
    s_add_u32 s57, s57, 4096
    s_mov_b32 m0, 135168
    s_nop 0
    buffer_load_dwordx4 v12, s[36:39], s57 offen lds
    s_add_u32 s57, s57, 4096
    s_mov_b32 m0, 136192
    s_nop 0
    buffer_load_dwordx4 v12, s[36:39], s57 offen lds
    s_add_u32 s57, s57, 4096
    s_mov_b32 m0, 137216
    s_nop 0
    buffer_load_dwordx4 v12, s[36:39], s57 offen lds
    s_add_u32 s57, s57, 4096
    s_mov_b32 m0, 138240
    s_nop 0
    buffer_load_dwordx4 v12, s[36:39], s57 offen lds
    s_add_u32 s57, s57, 4096
    s_mov_b32 m0, 139264
    s_nop 0
    buffer_load_dwordx4 v12, s[36:39], s57 offen lds
    s_add_u32 s57, s57, 4096
    s_mov_b32 m0, 140288
    s_nop 0
    buffer_load_dwordx4 v12, s[36:39], s57 offen lds
    s_add_u32 s57, s57, 4096
    s_mov_b32 m0, 141312
    s_nop 0
    buffer_load_dwordx4 v12, s[36:39], s57 offen lds
    s_add_u32 s57, s57, 4096
    s_mov_b32 m0, 142336
    s_nop 0
    buffer_load_dwordx4 v12, s[36:39], s57 offen lds
    s_add_u32 s57, s57, 4096
    s_mov_b32 m0, 143360
    s_nop 0
    buffer_load_dwordx4 v12, s[36:39], s57 offen lds
    s_add_u32 s57, s57, 4096
    s_mov_b32 m0, 144384
    s_nop 0
    buffer_load_dwordx4 v12, s[36:39], s57 offen lds
    s_add_u32 s57, s57, 4096
    s_mov_b32 m0, 145408
    s_nop 0
    buffer_load_dwordx4 v12, s[36:39], s57 offen lds
    s_add_u32 s57, s57, 4096
    s_mov_b32 m0, 146432
    s_nop 0
    buffer_load_dwordx4 v12, s[36:39], s57 offen lds
    s_add_u32 s57, s57, 4096
    s_waitcnt vmcnt(41)
    v_mov_b32 v26, 31
    ds_write_b32 v18, v26 offset:0
    s_cmp_ge_u32 s59, 34
    s_cbranch_scc1 K1_P90_OK
K1_P90:
    ds_read_b96 v[28:30], v18 offset:16
    s_waitcnt lgkmcnt(0)
    v_min3_u32 v28, v28, v29, v30
    s_nop 0
    v_readfirstlane_b32 s59, v28
    s_cmp_ge_u32 s59, 34
    s_cbranch_scc0 K1_P90
K1_P90_OK:
    s_mov_b32 m0, 0
    s_nop 0
    buffer_load_dwordx4 v12, s[36:39], s57 offen lds
    s_add_u32 s57, s57, 4096
    s_mov_b32 m0, 1024
    s_nop 0
    buffer_load_dwordx4 v12, s[36:39], s57 offen lds
    s_add_u32 s57, s57, 4096
    s_mov_b32 m0, 2048
    s_nop 0
    buffer_load_dwordx4 v12, s[36:39], s57 offen lds
    s_add_u32 s57, s57, 4096
    s_mov_b32 m0, 3072
    s_nop 0
    buffer_load_dwordx4 v12, s[36:39], s57 offen lds
    s_add_u32 s57, s57, 4096
    s_mov_b32 m0, 4096
    s_nop 0
    buffer_load_dwordx4 v12, s[36:39], s57 offen lds
    s_add_u32 s57, s57, 4096
    s_mov_b32 m0, 5120
    s_nop 0
    buffer_load_dwordx4 v12, s[36:39], s57 offen lds
    s_add_u32 s57, s57, 4096
    s_mov_b32 m0, 6144
    s_nop 0
    buffer_load_dwordx4 v12, s[36:39], s57 offen lds
    s_add_u32 s57, s57, 4096
    s_mov_b32 m0, 7168
    s_nop 0
    buffer_load_dwordx4 v12, s[36:39], s57 offen lds
    s_add_u32 s57, s57, 4096
    s_mov_b32 m0, 8192
    s_nop 0
    buffer_load_dwordx4 v12, s[36:39], s57 offen lds
    s_add_u32 s57, s57, 4096
    s_mov_b32 m0, 9216
    s_nop 0
    buffer_load_dwordx4 v12, s[36:39], s57 offen lds
    s_add_u32 s57, s57, 4096
    s_mov_b32 m0, 10240
    s_nop 0
    buffer_load_dwordx4 v12, s[36:39], s57 offen lds
    s_add_u32 s57, s57, 4096
    s_mov_b32 m0, 11264
    s_nop 0
    buffer_load_dwordx4 v12, s[36:39], s57 offen lds
    s_add_u32 s57, s57, 4096
    s_mov_b32 m0, 12288
    s_nop 0
    buffer_load_dwordx4 v12, s[36:39], s57 offen lds
    s_add_u32 s57, s57, 4096
    s_mov_b32 m0, 13312
    s_nop 0
    buffer_load_dwordx4 v12, s[36:39], s57 offen lds
    s_add_u32 s57, s57, 4096
    s_mov_b32 m0, 14336
    s_nop 0
    buffer_load_dwordx4 v12, s[36:39], s57 offen lds
    s_add_u32 s57, s57, 4096
    s_mov_b32 m0, 15360
    s_nop 0
    buffer_load_dwordx4 v12, s[36:39], s57 offen lds
    s_add_u32 s57, s57, 4096
    s_waitcnt vmcnt(41)
    v_mov_b32 v26, 32
    ds_write_b32 v18, v26 offset:0
    s_add_u32 s57, s81, 1
    s_and_b32 s57, s57, 3
    s_lshl_b32 s48, s80, 2
    s_add_u32 s57, s57, s48
    s_lshl_b32 s57, s57, 17
    s_lshl_b32 s48, s81, 8
    s_add_u32 s57, s57, s48
    s_cmp_ge_u32 s59, 35
    s_cbranch_scc1 K1_P91_OK
K1_P91:
    ds_read_b96 v[28:30], v18 offset:16
    s_waitcnt lgkmcnt(0)
    v_min3_u32 v28, v28, v29, v30
    s_nop 0
    v_readfirstlane_b32 s59, v28
    s_cmp_ge_u32 s59, 35
    s_cbranch_scc0 K1_P91
K1_P91_OK:
    s_mov_b32 m0, 73728
    s_nop 0
    buffer_load_dwordx4 v12, s[36:39], s57 offen lds
    s_add_u32 s57, s57, 4096
    s_mov_b32 m0, 74752
    s_nop 0
    buffer_load_dwordx4 v12, s[36:39], s57 offen lds
    s_add_u32 s57, s57, 4096
    s_mov_b32 m0, 75776
    s_nop 0
    buffer_load_dwordx4 v12, s[36:39], s57 offen lds
    s_add_u32 s57, s57, 4096
    s_mov_b32 m0, 76800
    s_nop 0
    buffer_load_dwordx4 v12, s[36:39], s57 offen lds
    s_add_u32 s57, s57, 4096
    s_mov_b32 m0, 77824
    s_nop 0
    buffer_load_dwordx4 v12, s[36:39], s57 offen lds
    s_add_u32 s57, s57, 4096
    s_mov_b32 m0, 78848
    s_nop 0
    buffer_load_dwordx4 v12, s[36:39], s57 offen lds
    s_add_u32 s57, s57, 4096
    s_mov_b32 m0, 79872
    s_nop 0
    buffer_load_dwordx4 v12, s[36:39], s57 offen lds
    s_add_u32 s57, s57, 4096
    s_mov_b32 m0, 80896
    s_nop 0
    buffer_load_dwordx4 v12, s[36:39], s57 offen lds
    s_add_u32 s57, s57, 4096
    s_mov_b32 m0, 81920
    s_nop 0
    buffer_load_dwordx4 v12, s[36:39], s57 offen lds
    s_add_u32 s57, s57, 4096
    s_mov_b32 m0, 82944
    s_nop 0
    buffer_load_dwordx4 v12, s[36:39], s57 offen lds
    s_add_u32 s57, s57, 4096
    s_mov_b32 m0, 83968
    s_nop 0
    buffer_load_dwordx4 v12, s[36:39], s57 offen lds
    s_add_u32 s57, s57, 4096
    s_mov_b32 m0, 84992
    s_nop 0
    buffer_load_dwordx4 v12, s[36:39], s57 offen lds
    s_add_u32 s57, s57, 4096
    s_mov_b32 m0, 86016
    s_nop 0
    buffer_load_dwordx4 v12, s[36:39], s57 offen lds
    s_add_u32 s57, s57, 4096
    s_mov_b32 m0, 87040
    s_nop 0
    buffer_load_dwordx4 v12, s[36:39], s57 offen lds
    s_add_u32 s57, s57, 4096
    s_mov_b32 m0, 88064
    s_nop 0
    buffer_load_dwordx4 v12, s[36:39], s57 offen lds
    s_add_u32 s57, s57, 4096
    s_mov_b32 m0, 89088
    s_nop 0
    buffer_load_dwordx4 v12, s[36:39], s57 offen lds
    s_add_u32 s57, s57, 4096
    s_waitcnt vmcnt(49)
    v_mov_b32 v26, 33
    ds_write_b32 v18, v26 offset:0
    s_waitcnt vmcnt(48)
K1_ALLW:
    v_cmp_ne_u32 vcc, s51, v22
    s_cbranch_vccz K1_ALLOK
    s_sleep 8
    buffer_load_dword v22, v21, s[92:95], 0 offen sc1
    s_waitcnt vmcnt(0)
    s_add_u32 s86, s86, 1
    s_cmp_lt_u32 s86, 262144
    s_cbranch_scc1 K1_ALLW
K1_ALLOK:
    v_mov_b32 v26, 1
    ds_write_b32 v18, v26 offset:44
    s_cmp_ge_u32 s59, 36
    s_cbranch_scc1 K1_P92_OK
K1_P92:
    ds_read_b96 v[28:30], v18 offset:16
    s_waitcnt lgkmcnt(0)
    v_min3_u32 v28, v28, v29, v30
    s_nop 0
    v_readfirstlane_b32 s59, v28
    s_cmp_ge_u32 s59, 36
    s_cbranch_scc0 K1_P92
K1_P92_OK:
    s_mov_b32 m0, 16384
    s_nop 0
    buffer_load_dwordx4 v12, s[36:39], s57 offen lds
    s_add_u32 s57, s57, 4096
    s_mov_b32 m0, 17408
    s_nop 0
    buffer_load_dwordx4 v12, s[36:39], s57 offen lds
    s_add_u32 s57, s57, 4096
    s_mov_b32 m0, 18432
    s_nop 0
    buffer_load_dwordx4 v12, s[36:39], s57 offen lds
    s_add_u32 s57, s57, 4096
    s_mov_b32 m0, 19456
    s_nop 0
    buffer_load_dwordx4 v12, s[36:39], s57 offen lds
    s_add_u32 s57, s57, 4096
    s_mov_b32 m0, 20480
    s_nop 0
    buffer_load_dwordx4 v12, s[36:39], s57 offen lds
    s_add_u32 s57, s57, 4096
    s_mov_b32 m0, 21504
    s_nop 0
    buffer_load_dwordx4 v12, s[36:39], s57 offen lds
    s_add_u32 s57, s57, 4096
    s_mov_b32 m0, 22528
    s_nop 0
    buffer_load_dwordx4 v12, s[36:39], s57 offen lds
    s_add_u32 s57, s57, 4096
    s_mov_b32 m0, 23552
    s_nop 0
    buffer_load_dwordx4 v12, s[36:39], s57 offen lds
    s_add_u32 s57, s57, 4096
    s_mov_b32 m0, 24576
    s_nop 0
    buffer_load_dwordx4 v12, s[36:39], s57 offen lds
    s_add_u32 s57, s57, 4096
    s_mov_b32 m0, 25600
    s_nop 0
    buffer_load_dwordx4 v12, s[36:39], s57 offen lds
    s_add_u32 s57, s57, 4096
    s_mov_b32 m0, 26624
    s_nop 0
    buffer_load_dwordx4 v12, s[36:39], s57 offen lds
    s_add_u32 s57, s57, 4096
    s_mov_b32 m0, 27648
    s_nop 0
    buffer_load_dwordx4 v12, s[36:39], s57 offen lds
    s_add_u32 s57, s57, 4096
    s_mov_b32 m0, 28672
    s_nop 0
    buffer_load_dwordx4 v12, s[36:39], s57 offen lds
    s_add_u32 s57, s57, 4096
    s_mov_b32 m0, 29696
    s_nop 0
    buffer_load_dwordx4 v12, s[36:39], s57 offen lds
    s_add_u32 s57, s57, 4096
    s_mov_b32 m0, 30720
    s_nop 0
    buffer_load_dwordx4 v12, s[36:39], s57 offen lds
    s_add_u32 s57, s57, 4096
    s_mov_b32 m0, 31744
    s_nop 0
    buffer_load_dwordx4 v12, s[36:39], s57 offen lds
    s_add_u32 s57, s57, 4096
    s_waitcnt vmcnt(32)
    v_mov_b32 v26, 2
    ds_write_b32 v18, v26 offset:36
    s_add_u32 s57, s81, 2
    s_and_b32 s57, s57, 3
    s_lshl_b32 s48, s80, 2
    s_add_u32 s57, s57, s48
    s_lshl_b32 s57, s57, 17
    s_lshl_b32 s48, s81, 8
    s_add_u32 s57, s57, s48
    s_cmp_ge_u32 s59, 37
    s_cbranch_scc1 K1_P93_OK
K1_P93:
    ds_read_b96 v[28:30], v18 offset:16
    s_waitcnt lgkmcnt(0)
    v_min3_u32 v28, v28, v29, v30
    s_nop 0
    v_readfirstlane_b32 s59, v28
    s_cmp_ge_u32 s59, 37
    s_cbranch_scc0 K1_P93
K1_P93_OK:
    s_mov_b32 m0, 90112
    s_nop 0
    buffer_load_dwordx4 v12, s[36:39], s57 offen lds
    s_add_u32 s57, s57, 4096
    s_mov_b32 m0, 91136
    s_nop 0
    buffer_load_dwordx4 v12, s[36:39], s57 offen lds
    s_add_u32 s57, s57, 4096
    s_mov_b32 m0, 92160
    s_nop 0
    buffer_load_dwordx4 v12, s[36:39], s57 offen lds
    s_add_u32 s57, s57, 4096
    s_mov_b32 m0, 93184
    s_nop 0
    buffer_load_dwordx4 v12, s[36:39], s57 offen lds
    s_add_u32 s57, s57, 4096
    s_mov_b32 m0, 94208
    s_nop 0
    buffer_load_dwordx4 v12, s[36:39], s57 offen lds
    s_add_u32 s57, s57, 4096
    s_mov_b32 m0, 95232
    s_nop 0
    buffer_load_dwordx4 v12, s[36:39], s57 offen lds
    s_add_u32 s57, s57, 4096
    s_mov_b32 m0, 96256
    s_nop 0
    buffer_load_dwordx4 v12, s[36:39], s57 offen lds
    s_add_u32 s57, s57, 4096
    s_mov_b32 m0, 97280
    s_nop 0
    buffer_load_dwordx4 v12, s[36:39], s57 offen lds
    s_add_u32 s57, s57, 4096
    s_mov_b32 m0, 98304
    s_nop 0
    buffer_load_dwordx4 v12, s[36:39], s57 offen lds
    s_add_u32 s57, s57, 4096
    s_mov_b32 m0, 99328
    s_nop 0
    buffer_load_dwordx4 v12, s[36:39], s57 offen lds
    s_add_u32 s57, s57, 4096
    s_mov_b32 m0, 100352
    s_nop 0
    buffer_load_dwordx4 v12, s[36:39], s57 offen lds
    s_add_u32 s57, s57, 4096
    s_mov_b32 m0, 101376
    s_nop 0
    buffer_load_dwordx4 v12, s[36:39], s57 offen lds
    s_add_u32 s57, s57, 4096
    s_mov_b32 m0, 102400
    s_nop 0
    buffer_load_dwordx4 v12, s[36:39], s57 offen lds
    s_add_u32 s57, s57, 4096
    s_mov_b32 m0, 103424
    s_nop 0
    buffer_load_dwordx4 v12, s[36:39], s57 offen lds
    s_add_u32 s57, s57, 4096
    s_mov_b32 m0, 104448
    s_nop 0
    buffer_load_dwordx4 v12, s[36:39], s57 offen lds
    s_add_u32 s57, s57, 4096
    s_mov_b32 m0, 105472
    s_nop 0
    buffer_load_dwordx4 v12, s[36:39], s57 offen lds
    s_add_u32 s57, s57, 4096
    s_waitcnt vmcnt(32)
    v_mov_b32 v26, 3
    ds_write_b32 v18, v26 offset:36
    s_cmp_ge_u32 s59, 41
    s_cbranch_scc1 K1_P94_OK
K1_P94:
    ds_read_b96 v[28:30], v18 offset:16
    s_waitcnt lgkmcnt(0)
    v_min3_u32 v28, v28, v29, v30
    s_nop 0
    v_readfirstlane_b32 s59, v28
    s_cmp_ge_u32 s59, 41
    s_cbranch_scc0 K1_P94
K1_P94_OK:
    s_mov_b32 m0, 32768
    s_nop 0
    buffer_load_dwordx4 v12, s[36:39], s57 offen lds
    s_add_u32 s57, s57, 4096
    s_mov_b32 m0, 33792
    s_nop 0
    buffer_load_dwordx4 v12, s[36:39], s57 offen lds
    s_add_u32 s57, s57, 4096
    s_mov_b32 m0, 34816
    s_nop 0
    buffer_load_dwordx4 v12, s[36:39], s57 offen lds
    s_add_u32 s57, s57, 4096
    s_mov_b32 m0, 35840
    s_nop 0
    buffer_load_dwordx4 v12, s[36:39], s57 offen lds
    s_add_u32 s57, s57, 4096
    s_mov_b32 m0, 36864
    s_nop 0
    buffer_load_dwordx4 v12, s[36:39], s57 offen lds
    s_add_u32 s57, s57, 4096
    s_mov_b32 m0, 37888
    s_nop 0
    buffer_load_dwordx4 v12, s[36:39], s57 offen lds
    s_add_u32 s57, s57, 4096
    s_mov_b32 m0, 38912
    s_nop 0
    buffer_load_dwordx4 v12, s[36:39], s57 offen lds
    s_add_u32 s57, s57, 4096
    s_mov_b32 m0, 39936
    s_nop 0
    buffer_load_dwordx4 v12, s[36:39], s57 offen lds
    s_add_u32 s57, s57, 4096
    s_mov_b32 m0, 40960
    s_nop 0
    buffer_load_dwordx4 v12, s[36:39], s57 offen lds
    s_add_u32 s57, s57, 4096
    s_mov_b32 m0, 41984
    s_nop 0
    buffer_load_dwordx4 v12, s[36:39], s57 offen lds
    s_add_u32 s57, s57, 4096
    s_mov_b32 m0, 43008
    s_nop 0
    buffer_load_dwordx4 v12, s[36:39], s57 offen lds
    s_add_u32 s57, s57, 4096
    s_mov_b32 m0, 44032
    s_nop 0
    buffer_load_dwordx4 v12, s[36:39], s57 offen lds
    s_add_u32 s57, s57, 4096
    s_mov_b32 m0, 45056
    s_nop 0
    buffer_load_dwordx4 v12, s[36:39], s57 offen lds
    s_add_u32 s57, s57, 4096
    s_mov_b32 m0, 46080
    s_nop 0
    buffer_load_dwordx4 v12, s[36:39], s57 offen lds
    s_add_u32 s57, s57, 4096
    s_mov_b32 m0, 47104
    s_nop 0
    buffer_load_dwordx4 v12, s[36:39], s57 offen lds
    s_add_u32 s57, s57, 4096
    s_mov_b32 m0, 48128
    s_nop 0
    buffer_load_dwordx4 v12, s[36:39], s57 offen lds
    s_add_u32 s57, s57, 4096
    s_waitcnt vmcnt(32)
    v_mov_b32 v26, 4
    ds_write_b32 v18, v26 offset:36
    s_add_u32 s57, s81, 3
    s_and_b32 s57, s57, 3
    s_lshl_b32 s48, s80, 2
    s_add_u32 s57, s57, s48
    s_lshl_b32 s57, s57, 17
    s_lshl_b32 s48, s81, 8
    s_add_u32 s57, s57, s48
    s_cmp_ge_u32 s59, 41
    s_cbranch_scc1 K1_P95_OK
K1_P95:
    ds_read_b96 v[28:30], v18 offset:16
    s_waitcnt lgkmcnt(0)
    v_min3_u32 v28, v28, v29, v30
    s_nop 0
    v_readfirstlane_b32 s59, v28
    s_cmp_ge_u32 s59, 41
    s_cbranch_scc0 K1_P95
K1_P95_OK:
    s_mov_b32 m0, 106496
    s_nop 0
    buffer_load_dwordx4 v12, s[36:39], s57 offen lds
    s_add_u32 s57, s57, 4096
    s_mov_b32 m0, 107520
    s_nop 0
    buffer_load_dwordx4 v12, s[36:39], s57 offen lds
    s_add_u32 s57, s57, 4096
    s_mov_b32 m0, 108544
    s_nop 0
    buffer_load_dwordx4 v12, s[36:39], s57 offen lds
    s_add_u32 s57, s57, 4096
    s_mov_b32 m0, 109568
    s_nop 0
    buffer_load_dwordx4 v12, s[36:39], s57 offen lds
    s_add_u32 s57, s57, 4096
    s_mov_b32 m0, 110592
    s_nop 0
    buffer_load_dwordx4 v12, s[36:39], s57 offen lds
    s_add_u32 s57, s57, 4096
    s_mov_b32 m0, 111616
    s_nop 0
    buffer_load_dwordx4 v12, s[36:39], s57 offen lds
    s_add_u32 s57, s57, 4096
    s_mov_b32 m0, 112640
    s_nop 0
    buffer_load_dwordx4 v12, s[36:39], s57 offen lds
    s_add_u32 s57, s57, 4096
    s_mov_b32 m0, 113664
    s_nop 0
    buffer_load_dwordx4 v12, s[36:39], s57 offen lds
    s_add_u32 s57, s57, 4096
    s_mov_b32 m0, 114688
    s_nop 0
    buffer_load_dwordx4 v12, s[36:39], s57 offen lds
    s_add_u32 s57, s57, 4096
    s_mov_b32 m0, 115712
    s_nop 0
    buffer_load_dwordx4 v12, s[36:39], s57 offen lds
    s_add_u32 s57, s57, 4096
    s_mov_b32 m0, 116736
    s_nop 0
    buffer_load_dwordx4 v12, s[36:39], s57 offen lds
    s_add_u32 s57, s57, 4096
    s_mov_b32 m0, 117760
    s_nop 0
    buffer_load_dwordx4 v12, s[36:39], s57 offen lds
    s_add_u32 s57, s57, 4096
    s_mov_b32 m0, 118784
    s_nop 0
    buffer_load_dwordx4 v12, s[36:39], s57 offen lds
    s_add_u32 s57, s57, 4096
    s_mov_b32 m0, 119808
    s_nop 0
    buffer_load_dwordx4 v12, s[36:39], s57 offen lds
    s_add_u32 s57, s57, 4096
    s_mov_b32 m0, 120832
    s_nop 0
    buffer_load_dwordx4 v12, s[36:39], s57 offen lds
    s_add_u32 s57, s57, 4096
    s_mov_b32 m0, 121856
    s_nop 0
    buffer_load_dwordx4 v12, s[36:39], s57 offen lds
    s_add_u32 s57, s57, 4096
    s_waitcnt vmcnt(32)
    v_mov_b32 v26, 5
    ds_write_b32 v18, v26 offset:36
    s_cmp_ge_u32 s59, 41
    s_cbranch_scc1 K1_P96_OK
K1_P96:
    ds_read_b96 v[28:30], v18 offset:16
    s_waitcnt lgkmcnt(0)
    v_min3_u32 v28, v28, v29, v30
    s_nop 0
    v_readfirstlane_b32 s59, v28
    s_cmp_ge_u32 s59, 41
    s_cbranch_scc0 K1_P96
K1_P96_OK:
    s_mov_b32 m0, 49152
    s_nop 0
    buffer_load_dwordx4 v12, s[36:39], s57 offen lds
    s_add_u32 s57, s57, 4096
    s_mov_b32 m0, 50176
    s_nop 0
    buffer_load_dwordx4 v12, s[36:39], s57 offen lds
    s_add_u32 s57, s57, 4096
    s_mov_b32 m0, 51200
    s_nop 0
    buffer_load_dwordx4 v12, s[36:39], s57 offen lds
    s_add_u32 s57, s57, 4096
    s_mov_b32 m0, 52224
    s_nop 0
    buffer_load_dwordx4 v12, s[36:39], s57 offen lds
    s_add_u32 s57, s57, 4096
    s_mov_b32 m0, 53248
    s_nop 0
    buffer_load_dwordx4 v12, s[36:39], s57 offen lds
    s_add_u32 s57, s57, 4096
    s_mov_b32 m0, 54272
    s_nop 0
    buffer_load_dwordx4 v12, s[36:39], s57 offen lds
    s_add_u32 s57, s57, 4096
    s_mov_b32 m0, 55296
    s_nop 0
    buffer_load_dwordx4 v12, s[36:39], s57 offen lds
    s_add_u32 s57, s57, 4096
    s_mov_b32 m0, 56320
    s_nop 0
    buffer_load_dwordx4 v12, s[36:39], s57 offen lds
    s_add_u32 s57, s57, 4096
    s_mov_b32 m0, 57344
    s_nop 0
    buffer_load_dwordx4 v12, s[36:39], s57 offen lds
    s_add_u32 s57, s57, 4096
    s_mov_b32 m0, 58368
    s_nop 0
    buffer_load_dwordx4 v12, s[36:39], s57 offen lds
    s_add_u32 s57, s57, 4096
    s_mov_b32 m0, 59392
    s_nop 0
    buffer_load_dwordx4 v12, s[36:39], s57 offen lds
    s_add_u32 s57, s57, 4096
    s_mov_b32 m0, 60416
    s_nop 0
    buffer_load_dwordx4 v12, s[36:39], s57 offen lds
    s_add_u32 s57, s57, 4096
    s_mov_b32 m0, 61440
    s_nop 0
    buffer_load_dwordx4 v12, s[36:39], s57 offen lds
    s_add_u32 s57, s57, 4096
    s_mov_b32 m0, 62464
    s_nop 0
    buffer_load_dwordx4 v12, s[36:39], s57 offen lds
    s_add_u32 s57, s57, 4096
    s_mov_b32 m0, 63488
    s_nop 0
    buffer_load_dwordx4 v12, s[36:39], s57 offen lds
    s_add_u32 s57, s57, 4096
    s_mov_b32 m0, 64512
    s_nop 0
    buffer_load_dwordx4 v12, s[36:39], s57 offen lds
    s_add_u32 s57, s57, 4096
    s_waitcnt vmcnt(32)
    v_mov_b32 v26, 6
    ds_write_b32 v18, v26 offset:36
    buffer_load_ubyte v20, v0, s[40:43], s85 offen sc1
    s_waitcnt vmcnt(17)
    v_mov_b32 v26, 7
    ds_write_b32 v18, v26 offset:36
    s_waitcnt vmcnt(1)
    v_mov_b32 v26, 8
    ds_write_b32 v18, v26 offset:36
    s_waitcnt vmcnt(0)
    v_cmp_ne_u32 vcc, 0, v20
    s_nop 1
    v_mov_b32 v23, vcc_lo
    ds_write_b32 v18, v23 offset:48
    s_mov_b32 s86, 0
    s_mov_b32 s50, 0x77777777
K1_PZ:
    buffer_load_ubyte v22, v0, s[40:43], s85 offen sc1
    s_waitcnt vmcnt(0)
    v_cmp_ne_u32 vcc, 0, v22
    s_nop 1
    v_mov_b32 v22, vcc_lo
    v_mov_b32 v23, vcc_hi
    s_and_b32 s48, vcc_lo, s50
    s_and_b32 s49, vcc_hi, 0x7777
    ds_write_b64 v18, v[22:23] offset:48
    s_cmp_eq_u32 s48, s50
    s_cselect_b32 s48, s49, 0
    s_cmp_eq_u32 s48, 0x7777
    s_cbranch_scc1 K1_FIN
    s_add_u32 s86, s86, 1
    s_cmp_lt_u32 s86, 262144
    s_cbranch_scc1 K1_PZ
    v_mov_b32 v22, -1
    v_mov_b32 v23, -1
    ds_write_b64 v18, v[22:23] offset:48
K1_FIN:
K1_END:
    s_endpgm
.section .rodata,"a"
.p2align 6
.amdhsa_kernel standalone__gqa_block_cached__near_ridge_kernel
  .amdhsa_next_free_vgpr 512
  .amdhsa_next_free_sgpr 96
  .amdhsa_accum_offset 256
  .amdhsa_group_segment_fixed_size 0
  .amdhsa_kernarg_size 64
  .amdhsa_user_sgpr_count 2
  .amdhsa_user_sgpr_kernarg_segment_ptr 1
  .amdhsa_system_sgpr_workgroup_id_x 1
.end_amdhsa_kernel
```
